```python
import torch

def _softmax(x, axis=-1):
    return torch.softmax(x, dim=axis)
def _gelu(x):
    return torch.nn.functional.gelu(x, approximate="tanh")
def _silu(x):
    return torch.nn.functional.silu(x)
def _sigmoid(x):
    return torch.sigmoid(x)
def _layernorm(x, axis=-1, eps=1e-5):
    m = x.mean(dim=axis, keepdim=True)
    v = x.var(dim=axis, keepdim=True, unbiased=False)
    return (x - m) / torch.sqrt(v + eps)
def _scatter_add(tgt, idx, src, axis=0):
    return tgt.clone().index_add_(axis, idx, src)
def _segment_sum(src, seg, n):
    out = torch.zeros((n,) + src.shape[1:], dtype=src.dtype)
    return out.index_add_(0, seg, src)
def _pad(x, pw):
    flat = tuple(v for pair in reversed(pw) for v in pair)
    return torch.nn.functional.pad(x, flat)

kernel_name = 'concat_heads__mha_block_cached__mha_block_cached__near_ridge'

def setup_inputs():

    _w = (lambda a: (lambda t: t.to(torch.bfloat16) if t.is_floating_point() else t)(torch.as_tensor(a)))
    def _A_setup():
        B, Sq, D = 16, 160, 640
        H, Sk, Dh = 32, 1024, 128
        return {
            "x": _w((lambda *s: torch.randn(*s, dtype=torch.bfloat16) * 0.8)(B, Sq, D)),
            "k_cache": _w((lambda *s: torch.randn(*s, dtype=torch.bfloat16) * 0.8)(B, H, Sk, Dh)),
            "v_cache": _w((lambda *s: torch.randn(*s, dtype=torch.bfloat16) * 0.05)(B, H, Sk, Dh)),
            "wq": _w((lambda *s: torch.randn(*s, dtype=torch.bfloat16) * 0.8)(D, H * Dh) * (D ** -0.5)),
            "wo": _w((lambda *s: torch.randn(*s, dtype=torch.bfloat16) * 0.05)(H * Dh, D) * ((H * Dh) ** -0.5)),
        }
    _A_in = _A_setup()

    def _B_setup():
        B, Sq, D = 16, 160, 640
        H, Sk, Dh = 32, 1024, 128
        return {
            "x": _w((lambda *s: torch.randn(*s, dtype=torch.bfloat16) * 0.8)(B, Sq, D)),
            "k_cache": _w((lambda *s: torch.randn(*s, dtype=torch.bfloat16) * 0.8)(B, H, Sk, Dh)),
            "v_cache": _w((lambda *s: torch.randn(*s, dtype=torch.bfloat16) * 0.05)(B, H, Sk, Dh)),
            "wq": _w((lambda *s: torch.randn(*s, dtype=torch.bfloat16) * 0.8)(D, H * Dh) * (D ** -0.5)),
            "wo": _w((lambda *s: torch.randn(*s, dtype=torch.bfloat16) * 0.05)(H * Dh, D) * ((H * Dh) ** -0.5)),
        }
    _B_in = _B_setup()

    return {
        "A_x": _A_in["x"],
        "A_k_cache": _A_in["k_cache"],
        "A_v_cache": _A_in["v_cache"],
        "A_wq": _A_in["wq"],
        "A_wo": _A_in["wo"],
        "B_x": _B_in["x"],
        "B_k_cache": _B_in["k_cache"],
        "B_v_cache": _B_in["v_cache"],
        "B_wq": _B_in["wq"],
        "B_wo": _B_in["wo"],
    }

def reference(A_x, A_k_cache, A_v_cache, A_wq, A_wo, B_x, B_k_cache, B_v_cache, B_wq, B_wo):
    def _A_ref(x, k_cache, v_cache, wq, wo):
        B, Sq, D = x.shape
        H, Dh = 32, 128
        q = (lambda x, *d: x.permute(*d))((x @ wq).reshape(B, Sq, H, Dh), 0, 2, 1, 3)
        scores = torch.einsum("bhqd,bhkd->bhqk", q, k_cache) * (Dh ** -0.5)
        p = _softmax(scores, axis=-1)
        o = torch.einsum("bhqk,bhkd->bhqd", p, v_cache)
        return (lambda x, *d: x.permute(*d))(o, 0, 2, 1, 3).reshape(B, Sq, H * Dh) @ wo

    def _B_ref(x, k_cache, v_cache, wq, wo):
        B, Sq, D = x.shape
        H, Dh = 32, 128
        q = (lambda x, *d: x.permute(*d))((x @ wq).reshape(B, Sq, H, Dh), 0, 2, 1, 3)
        scores = torch.einsum("bhqd,bhkd->bhqk", q, k_cache) * (Dh ** -0.5)
        p = _softmax(scores, axis=-1)
        o = torch.einsum("bhqk,bhkd->bhqd", p, v_cache)
        return (lambda x, *d: x.permute(*d))(o, 0, 2, 1, 3).reshape(B, Sq, H * Dh) @ wo

    a = _A_ref(A_x, A_k_cache, A_v_cache, A_wq, A_wo)
    b = _B_ref(B_x, B_k_cache, B_v_cache, B_wq, B_wo)
    return torch.concatenate([a, b], axis=-1)
```

```asm
; @launch kernel=mha_attn_kernel grid=(256,1,1) block=(256,1,1) lds=163840
; @launch kernel=mha_oproj_kernel grid=(256,1,1) block=(256,1,1) lds=81920
.amdgcn_target "amdgcn-amd-amdhsa--gfx950"
.text
.globl mha_attn_kernel
.p2align 8
.type mha_attn_kernel,@function
mha_attn_kernel:
    s_cmp_ge_u32 s2, 256
    s_cbranch_scc1 L1_done
    s_load_dwordx8 s[52:59], s[0:1], 0
    s_load_dwordx8 s[60:67], s[0:1], 40
    s_load_dwordx2 s[4:5], s[0:1], 96
    s_load_dwordx2 s[84:85], s[0:1], 32
    s_load_dwordx2 s[86:87], s[0:1], 72
    v_lshrrev_b32 v1, 6, v0
    v_and_b32 v2, 63, v0
    v_readfirstlane_b32 s28, v1
    s_and_b32 s3, s2, 7
    s_lshr_b32 s6, s2, 3
    s_lshr_b32 s29, s28, 1
    s_and_b32 s30, s28, 1
    s_lshr_b32 s51, s6, 2
    s_and_b32 s6, s6, 3
    s_mov_b32 s82, s6
    s_mov_b32 s96, 0
    s_and_b32 s7, s3, 3
    s_lshl_b32 s7, s7, 3
    s_lshl_b32 s6, s6, 1
    s_add_u32 s7, s7, s6
    s_add_u32 s33, s7, s29
    s_lshr_b32 s3, s3, 2
    s_mov_b32 s71, s3
    s_waitcnt lgkmcnt(0)
    s_cmp_eq_u32 s3, 0
    s_cselect_b32 s52, s52, s60
    s_cselect_b32 s53, s53, s61
    s_cselect_b32 s54, s54, s62
    s_cselect_b32 s55, s55, s63
    s_cselect_b32 s56, s56, s64
    s_cselect_b32 s57, s57, s65
    s_cselect_b32 s58, s58, s66
    s_cselect_b32 s59, s59, s67
    s_mov_b32 s8, s52
    s_and_b32 s9, s53, 0xffff
    s_mov_b32 s10, 3276800
    s_mov_b32 s11, 0x20000
    s_mov_b32 s16, s54
    s_and_b32 s17, s55, 0xffff
    s_mov_b32 s18, 134217728
    s_mov_b32 s19, 0x20000
    s_mov_b32 s20, s56
    s_and_b32 s21, s57, 0xffff
    s_mov_b32 s22, 134217728
    s_mov_b32 s23, 0x20000
    s_mov_b32 s12, s58
    s_and_b32 s13, s59, 0xffff
    s_mov_b32 s14, 5242880
    s_mov_b32 s15, 0x20000
    s_mov_b32 s24, s4
    s_and_b32 s25, s5, 0xffff
    s_mov_b32 s26, 88080384
    s_mov_b32 s27, 0x20000
    s_cmp_lt_u32 s2, 128
    s_cselect_b32 s84, s84, s86
    s_cselect_b32 s85, s85, s87
    s_mov_b32 s88, s84
    s_and_b32 s89, s85, 0xffff
    s_mov_b32 s90, 5242880
    s_mov_b32 s91, 0x20000
    s_mov_b32 s44, 0x3e0293ee
    s_mov_b32 s45, 0x3e0293ee
    s_lshl_b32 s6, s29, 13
    s_lshl_b32 s7, s30, 12
    s_add_u32 s41, s6, s7
    s_add_u32 s42, s41, 65536
    s_mul_i32 s43, s28, 5120
    s_add_u32 s73, s43, 61440
    v_and_b32 v3, 15, v2
    v_lshrrev_b32 v4, 4, v2
    s_lshl_b32 s6, s29, 13
    v_lshlrev_b32 v8, 2, v4
    v_xor_b32 v8, v8, v3
    v_lshlrev_b32 v8, 4, v8
    v_lshl_add_u32 v8, v4, 13, v8
    v_add_u32 v200, 0, v8
    v_add_u32 v201, 31744, v8
    v_add_u32 v202, 63488, v8
    v_add_u32 v203, 95232, v8
    v_lshrrev_b32 v9, 3, v2
    v_mul_u32_u24 v9, 1280, v9
    v_and_b32 v10, 7, v2
    s_add_u32 s7, s28, 0
    s_and_b32 s7, s7, 1
    s_lshl_b32 s7, s7, 2
    v_add_u32 v8, s7, v4
    v_xor_b32 v8, v8, v10
    v_lshlrev_b32 v8, 4, v8
    s_mov_b32 s7, 0
    v_add3_u32 v234, v8, v9, s7
    s_add_u32 s7, s28, 1
    s_and_b32 s7, s7, 1
    s_lshl_b32 s7, s7, 2
    v_add_u32 v8, s7, v4
    v_xor_b32 v8, v8, v10
    v_lshlrev_b32 v8, 4, v8
    s_mov_b32 s7, 9216
    v_add3_u32 v235, v8, v9, s7
    s_add_u32 s7, s28, 2
    s_and_b32 s7, s7, 1
    s_lshl_b32 s7, s7, 2
    v_add_u32 v8, s7, v4
    v_xor_b32 v8, v8, v10
    v_lshlrev_b32 v8, 4, v8
    s_mov_b32 s7, 18432
    v_add3_u32 v236, v8, v9, s7
    s_add_u32 s7, s28, 3
    s_and_b32 s7, s7, 1
    s_lshl_b32 s7, s7, 2
    v_add_u32 v8, s7, v4
    v_xor_b32 v8, v8, v10
    v_lshlrev_b32 v8, 4, v8
    s_mov_b32 s7, 27648
    v_add3_u32 v237, v8, v9, s7
    s_add_u32 s7, s28, 4
    s_and_b32 s7, s7, 1
    s_lshl_b32 s7, s7, 2
    v_add_u32 v8, s7, v4
    v_xor_b32 v8, v8, v10
    v_lshlrev_b32 v8, 4, v8
    s_mov_b32 s7, 40960
    v_add3_u32 v238, v8, v9, s7
    s_mov_b32 s97, 0
    s_mov_b32 s98, s97
    s_mov_b32 s99, 0
    s_mov_b32 s32, s51
    s_add_u32 s83, s51, 8
    s_cmp_eq_u32 s97, 1
    s_cselect_b32 s100, s83, s51
    s_mul_i32 s6, s2, 81920
    s_mul_i32 s7, s28, 20480
    s_add_u32 s6, s6, s7
    s_add_u32 s72, s6, 67108864
    s_mov_b32 s79, 0
    s_mul_i32 s68, s100, 160
    s_mul_i32 s69, s28, 40
    s_add_u32 s68, s68, s69
    s_mul_i32 s94, s68, 1280
    s_add_u32 s95, s94, 1280
    s_lshl_b32 s68, s96, 6
    s_add_u32 s36, s94, s68
    s_lshl_b32 s68, s30, 17
    s_lshl_b32 s69, s33, 8
    s_add_u32 s92, s68, s69
    s_add_u32 s93, s92, 5242880
    s_lshl_b32 s68, s96, 18
    s_add_u32 s37, s92, s68
    s_mul_i32 s68, s100, 160
    s_mul_i32 s69, s82, 40
    s_add_u32 s68, s68, s69
    s_mul_i32 s68, s68, 1280
    s_mul_i32 s69, s28, 12800
    s_add_u32 s80, s68, s69
    s_mul_i32 s68, s51, 80
    s_mul_i32 s69, s28, 20
    s_add_u32 s68, s68, s69
    s_lshl_b32 s68, s68, 13
    s_sub_u32 s69, s33, s29
    s_lshl_b32 s69, s69, 8
    s_add_u32 s81, s68, s69
    s_mov_b32 m0, s42
    s_nop 0
    buffer_load_dwordx4 v200, s[12:15], s37 offen lds
    buffer_load_dwordx4 v201, s[12:15], s37 offen offset:1024 lds
    buffer_load_dwordx4 v202, s[12:15], s37 offen offset:2048 lds
    buffer_load_dwordx4 v203, s[12:15], s37 offen offset:3072 lds
    s_add_u32 s37, s37, 262144
    s_cmp_lt_u32 s37, s93
    s_cselect_b32 s37, s37, s92
    s_add_u32 m0, s43, 40960
    s_nop 0
    buffer_load_dwordx4 v234, s[8:11], s36 offen lds
    buffer_load_dwordx4 v235, s[8:11], s36 offen offset:1024 lds
    buffer_load_dwordx4 v236, s[8:11], s36 offen offset:2048 lds
    buffer_load_dwordx4 v237, s[8:11], s36 offen offset:3072 lds
    s_add_u32 m0, m0, 4096
    s_nop 0
    buffer_load_dwordx4 v238, s[8:11], s36 offen lds
    s_add_u32 s36, s36, 128
    s_cmp_lt_u32 s36, s95
    s_cselect_b32 s36, s36, s94
    s_add_u32 m0, s42, 16384
    s_nop 0
    buffer_load_dwordx4 v200, s[12:15], s37 offen lds
    buffer_load_dwordx4 v201, s[12:15], s37 offen offset:1024 lds
    buffer_load_dwordx4 v202, s[12:15], s37 offen offset:2048 lds
    buffer_load_dwordx4 v203, s[12:15], s37 offen offset:3072 lds
    s_add_u32 s37, s37, 262144
    s_cmp_lt_u32 s37, s93
    s_cselect_b32 s37, s37, s92
    s_add_u32 m0, s42, 32768
    s_nop 0
    buffer_load_dwordx4 v200, s[12:15], s37 offen lds
    buffer_load_dwordx4 v201, s[12:15], s37 offen offset:1024 lds
    buffer_load_dwordx4 v202, s[12:15], s37 offen offset:2048 lds
    buffer_load_dwordx4 v203, s[12:15], s37 offen offset:3072 lds
    s_add_u32 s37, s37, 262144
    s_cmp_lt_u32 s37, s93
    s_cselect_b32 s37, s37, s92
    s_mov_b32 m0, s43
    s_nop 0
    buffer_load_dwordx4 v234, s[8:11], s36 offen lds
    buffer_load_dwordx4 v235, s[8:11], s36 offen offset:1024 lds
    buffer_load_dwordx4 v236, s[8:11], s36 offen offset:2048 lds
    buffer_load_dwordx4 v237, s[8:11], s36 offen offset:3072 lds
    s_add_u32 m0, m0, 4096
    s_nop 0
    buffer_load_dwordx4 v238, s[8:11], s36 offen lds
    s_add_u32 s36, s36, 128
    s_cmp_lt_u32 s36, s95
    s_cselect_b32 s36, s36, s94
    s_add_u32 s38, s43, 20480
    s_mov_b32 s39, 40960
    s_lshl_b32 s6, s29, 13
    v_xor_b32 v5, v4, v3
    v_lshlrev_b32 v5, 4, v5
    v_lshlrev_b32 v6, 8, v3
    v_add3_u32 v5, v5, v6, s6
    v_xor_b32 v176, 0, v5
    v_xor_b32 v177, 64, v5
    v_xor_b32 v178, 128, v5
    v_xor_b32 v179, 192, v5
    v_lshrrev_b32 v6, 2, v3
    v_and_b32 v7, 3, v3
    v_lshl_add_u32 v8, v4, 2, v6
    v_and_b32 v9, 7, v8
    v_lshlrev_b32 v9, 1, v9
    v_lshrrev_b32 v10, 1, v7
    v_xor_b32 v9, v9, v10
    v_lshlrev_b32 v9, 4, v9
    v_and_b32 v10, 1, v7
    v_lshlrev_b32 v10, 3, v10
    v_lshlrev_b32 v8, 8, v8
    v_add3_u32 v9, v9, v10, v8
    s_add_u32 s7, s6, 65536
    v_add_u32 v9, s7, v9
    v_xor_b32 v180, 0, v9
    v_xor_b32 v181, 32, v9
    v_xor_b32 v182, 64, v9
    v_xor_b32 v183, 96, v9
    v_xor_b32 v184, 128, v9
    v_xor_b32 v185, 160, v9
    v_xor_b32 v186, 192, v9
    v_xor_b32 v187, 224, v9
    v_lshl_add_u32 v8, v4, 3, v6
    v_lshlrev_b32 v8, 8, v8
    v_lshlrev_b32 v9, 2, v6
    v_xor_b32 v9, v9, v7
    v_lshlrev_b32 v9, 4, v9
    v_add3_u32 v9, v9, v8, s7
    v_xor_b32 v188, 0, v9
    v_xor_b32 v189, 64, v9
    v_xor_b32 v190, 128, v9
    v_xor_b32 v191, 192, v9
    v_lshrrev_b32 v8, 1, v3
    v_xor_b32 v8, v8, v4
    v_lshlrev_b32 v8, 4, v8
    v_lshlrev_b32 v9, 7, v3
    s_mul_i32 s7, s30, 10240
    v_add3_u32 v232, v8, v9, s7
    v_xor_b32 v233, 64, v232
    v_xor_b32 v8, v3, v4
    v_lshlrev_b32 v8, 4, v8
    v_lshl_add_u32 v8, v4, 8, v8
    v_xor_b32 v194, 0, v8
    v_xor_b32 v195, 64, v8
    v_xor_b32 v196, 128, v8
    v_xor_b32 v197, 192, v8
    v_lshlrev_b32 v8, 1, v4
    v_xor_b32 v8, v8, v3
    v_lshlrev_b32 v8, 4, v8
    v_lshl_add_u32 v8, v4, 8, v8
    v_mov_b32 v198, v8
    v_xor_b32 v199, 128, v8
    v_lshlrev_b32 v212, 4, v2
    v_lshlrev_b32 v213, 7, v2
    v_lshrrev_b32 v8, 2, v2
    v_lshlrev_b32 v8, 13, v8
    v_and_b32 v9, 3, v2
    v_lshlrev_b32 v9, 7, v9
    v_add_u32 v214, v8, v9
    v_mov_b32 v9, 0x7ff00000
    v_add_u32 v8, 8192, v213
    v_cmp_gt_u32 vcc, 36, v2
    s_nop 1
    v_cndmask_b32 v239, v9, v8, vcc
    v_add_u32 v8, 131072, v214
    v_cmp_gt_u32 vcc, 16, v2
    s_nop 1
    v_cndmask_b32 v240, v9, v8, vcc
    s_getreg_b32 s56, hwreg(HW_REG_XCC_ID)
    s_and_b32 s56, s56, 7
L1_q:
    s_waitcnt lgkmcnt(0)
    s_waitcnt vmcnt(13)
    s_barrier
    v_add_u32 v192, s39, v232
    ds_read_b128 v[96:99], v192 offset:0
    ds_read_b64_tr_b16 a[160:161], v188 offset:0
    ds_read_b64_tr_b16 a[162:163], v188 offset:1024
    ds_read_b128 v[100:103], v192 offset:2048
    ds_read_b128 v[104:107], v192 offset:4096
    ds_read_b128 v[108:111], v192 offset:6144
    ds_read_b128 v[112:115], v192 offset:8192
    ds_read_b64_tr_b16 a[164:165], v188 offset:8
    ds_read_b64_tr_b16 a[166:167], v188 offset:1032
    ds_read_b64_tr_b16 a[168:169], v189 offset:0
    s_waitcnt lgkmcnt(7)
    v_mfma_f32_16x16x32_bf16 a[0:3], a[160:163], v[96:99], 0
    ds_read_b64_tr_b16 a[170:171], v189 offset:1024
    s_waitcnt lgkmcnt(7)
    v_mfma_f32_16x16x32_bf16 a[4:7], a[160:163], v[100:103], 0
    s_mov_b32 m0, s38
    s_waitcnt lgkmcnt(6)
    v_mfma_f32_16x16x32_bf16 a[8:11], a[160:163], v[104:107], 0
    buffer_load_dwordx4 v234, s[8:11], s36 offen lds
    s_waitcnt lgkmcnt(5)
    v_mfma_f32_16x16x32_bf16 a[12:15], a[160:163], v[108:111], 0
    s_waitcnt lgkmcnt(4)
    v_mfma_f32_16x16x32_bf16 a[16:19], a[160:163], v[112:115], 0
    ds_read_b64_tr_b16 a[172:173], v189 offset:8
    s_waitcnt lgkmcnt(3)
    v_mfma_f32_16x16x32_bf16 a[20:23], a[164:167], v[96:99], 0
    ds_read_b64_tr_b16 a[174:175], v189 offset:1032
    v_mfma_f32_16x16x32_bf16 a[24:27], a[164:167], v[100:103], 0
    buffer_load_dwordx4 v235, s[8:11], s36 offen offset:1024 lds
    v_mfma_f32_16x16x32_bf16 a[28:31], a[164:167], v[104:107], 0
    s_add_u32 m0, s42, 49152
    v_mfma_f32_16x16x32_bf16 a[32:35], a[164:167], v[108:111], 0
    buffer_load_dwordx4 v200, s[12:15], s37 offen lds
    v_mfma_f32_16x16x32_bf16 a[36:39], a[164:167], v[112:115], 0
    ds_read_b64_tr_b16 a[176:177], v190 offset:0
    s_waitcnt lgkmcnt(3)
    v_mfma_f32_16x16x32_bf16 a[40:43], a[168:171], v[96:99], 0
    ds_read_b64_tr_b16 a[178:179], v190 offset:1024
    v_mfma_f32_16x16x32_bf16 a[44:47], a[168:171], v[100:103], 0
    v_mfma_f32_16x16x32_bf16 a[48:51], a[168:171], v[104:107], 0
    buffer_load_dwordx4 v201, s[12:15], s37 offen offset:1024 lds
    v_mfma_f32_16x16x32_bf16 a[52:55], a[168:171], v[108:111], 0
    v_mfma_f32_16x16x32_bf16 a[56:59], a[168:171], v[112:115], 0
    ds_read_b64_tr_b16 a[180:181], v190 offset:8
    s_waitcnt lgkmcnt(3)
    v_mfma_f32_16x16x32_bf16 a[60:63], a[172:175], v[96:99], 0
    ds_read_b64_tr_b16 a[182:183], v190 offset:1032
    s_mov_b32 m0, s38
    v_mfma_f32_16x16x32_bf16 a[64:67], a[172:175], v[100:103], 0
    buffer_load_dwordx4 v236, s[8:11], s36 offen offset:2048 lds
    v_mfma_f32_16x16x32_bf16 a[68:71], a[172:175], v[104:107], 0
    v_mfma_f32_16x16x32_bf16 a[72:75], a[172:175], v[108:111], 0
    ds_read_b64_tr_b16 a[184:185], v191 offset:0
    v_mfma_f32_16x16x32_bf16 a[76:79], a[172:175], v[112:115], 0
    ds_read_b64_tr_b16 a[186:187], v191 offset:1024
    s_waitcnt lgkmcnt(4)
    v_mfma_f32_16x16x32_bf16 a[80:83], a[176:179], v[96:99], 0
    buffer_load_dwordx4 v237, s[8:11], s36 offen offset:3072 lds
    v_mfma_f32_16x16x32_bf16 a[84:87], a[176:179], v[100:103], 0
    ds_read_b64_tr_b16 a[188:189], v191 offset:8
    v_mfma_f32_16x16x32_bf16 a[88:91], a[176:179], v[104:107], 0
    ds_read_b64_tr_b16 a[190:191], v191 offset:1032
    s_add_u32 m0, s42, 49152
    v_mfma_f32_16x16x32_bf16 a[92:95], a[176:179], v[108:111], 0
    buffer_load_dwordx4 v202, s[12:15], s37 offen offset:2048 lds
    v_mfma_f32_16x16x32_bf16 a[96:99], a[176:179], v[112:115], 0
    s_waitcnt lgkmcnt(0)
    v_mfma_f32_16x16x32_bf16 a[100:103], a[180:183], v[96:99], 0
    s_waitcnt vmcnt(16)
    v_mfma_f32_16x16x32_bf16 a[104:107], a[180:183], v[100:103], 0
    s_barrier
    v_add_u32 v192, s39, v233
    v_mfma_f32_16x16x32_bf16 a[108:111], a[180:183], v[104:107], 0
    ds_read_b128 v[116:119], v192 offset:0
    v_mfma_f32_16x16x32_bf16 a[112:115], a[180:183], v[108:111], 0
    ds_read_b64_tr_b16 a[160:161], v188 offset:16384
    v_mfma_f32_16x16x32_bf16 a[116:119], a[180:183], v[112:115], 0
    ds_read_b64_tr_b16 a[162:163], v188 offset:17408
    v_mfma_f32_16x16x32_bf16 a[120:123], a[184:187], v[96:99], 0
    ds_read_b128 v[120:123], v192 offset:2048
    v_mfma_f32_16x16x32_bf16 a[124:127], a[184:187], v[100:103], 0
    ds_read_b128 v[124:127], v192 offset:4096
    v_mfma_f32_16x16x32_bf16 a[128:131], a[184:187], v[104:107], 0
    ds_read_b128 v[128:131], v192 offset:6144
    v_mfma_f32_16x16x32_bf16 a[132:135], a[184:187], v[108:111], 0
    ds_read_b128 v[132:135], v192 offset:8192
    v_mfma_f32_16x16x32_bf16 a[136:139], a[184:187], v[112:115], 0
    buffer_load_dwordx4 v203, s[12:15], s37 offen offset:3072 lds
    v_mfma_f32_16x16x32_bf16 a[140:143], a[188:191], v[96:99], 0
    s_add_u32 s37, s37, 262144
    ds_read_b64_tr_b16 a[164:165], v188 offset:16392
    v_mfma_f32_16x16x32_bf16 a[144:147], a[188:191], v[100:103], 0
    s_add_u32 m0, s38, 4096
    ds_read_b64_tr_b16 a[166:167], v188 offset:17416
    v_mfma_f32_16x16x32_bf16 a[148:151], a[188:191], v[104:107], 0
    buffer_load_dwordx4 v238, s[8:11], s36 offen lds
    v_mfma_f32_16x16x32_bf16 a[152:155], a[188:191], v[108:111], 0
    s_add_u32 s36, s36, 128
    s_cmp_lt_u32 s37, s93
    s_cselect_b32 s37, s37, s92
    v_mfma_f32_16x16x32_bf16 a[156:159], a[188:191], v[112:115], 0
    s_cmp_lt_u32 s36, s95
    s_cselect_b32 s36, s36, s94
    ds_read_b64_tr_b16 a[168:169], v189 offset:16384
    s_waitcnt lgkmcnt(3)
    v_mfma_f32_16x16x32_bf16 a[0:3], a[160:163], v[116:119], a[0:3]
    s_add_u32 s38, s38, 20480
    s_cmp_eq_u32 s38, s73
    s_cselect_b32 s38, s43, s38
    ds_read_b64_tr_b16 a[170:171], v189 offset:17408
    v_mfma_f32_16x16x32_bf16 a[4:7], a[160:163], v[120:123], a[4:7]
    s_mov_b32 m0, s42
    v_mfma_f32_16x16x32_bf16 a[8:11], a[160:163], v[124:127], a[8:11]
    buffer_load_dwordx4 v200, s[12:15], s37 offen lds
    v_mfma_f32_16x16x32_bf16 a[12:15], a[160:163], v[128:131], a[12:15]
    v_mfma_f32_16x16x32_bf16 a[16:19], a[160:163], v[132:135], a[16:19]
    ds_read_b64_tr_b16 a[172:173], v189 offset:16392
    s_waitcnt lgkmcnt(3)
    v_mfma_f32_16x16x32_bf16 a[20:23], a[164:167], v[116:119], a[20:23]
    ds_read_b64_tr_b16 a[174:175], v189 offset:17416
    v_mfma_f32_16x16x32_bf16 a[24:27], a[164:167], v[120:123], a[24:27]
    v_mfma_f32_16x16x32_bf16 a[28:31], a[164:167], v[124:127], a[28:31]
    v_mfma_f32_16x16x32_bf16 a[32:35], a[164:167], v[128:131], a[32:35]
    v_mfma_f32_16x16x32_bf16 a[36:39], a[164:167], v[132:135], a[36:39]
    ds_read_b64_tr_b16 a[176:177], v190 offset:16384
    s_waitcnt lgkmcnt(3)
    v_mfma_f32_16x16x32_bf16 a[40:43], a[168:171], v[116:119], a[40:43]
    ds_read_b64_tr_b16 a[178:179], v190 offset:17408
    v_mfma_f32_16x16x32_bf16 a[44:47], a[168:171], v[120:123], a[44:47]
    v_mfma_f32_16x16x32_bf16 a[48:51], a[168:171], v[124:127], a[48:51]
    buffer_load_dwordx4 v201, s[12:15], s37 offen offset:1024 lds
    v_mfma_f32_16x16x32_bf16 a[52:55], a[168:171], v[128:131], a[52:55]
    v_mfma_f32_16x16x32_bf16 a[56:59], a[168:171], v[132:135], a[56:59]
    ds_read_b64_tr_b16 a[180:181], v190 offset:16392
    s_waitcnt lgkmcnt(3)
    v_mfma_f32_16x16x32_bf16 a[60:63], a[172:175], v[116:119], a[60:63]
    ds_read_b64_tr_b16 a[182:183], v190 offset:17416
    v_mfma_f32_16x16x32_bf16 a[64:67], a[172:175], v[120:123], a[64:67]
    v_mfma_f32_16x16x32_bf16 a[68:71], a[172:175], v[124:127], a[68:71]
    v_mfma_f32_16x16x32_bf16 a[72:75], a[172:175], v[128:131], a[72:75]
    ds_read_b64_tr_b16 a[184:185], v191 offset:16384
    s_add_u32 s39, s39, 20480
    v_mfma_f32_16x16x32_bf16 a[76:79], a[172:175], v[132:135], a[76:79]
    ds_read_b64_tr_b16 a[186:187], v191 offset:17408
    s_cmp_eq_u32 s39, 61440
    s_cselect_b32 s39, 0, s39
    s_waitcnt lgkmcnt(4)
    v_mfma_f32_16x16x32_bf16 a[80:83], a[176:179], v[116:119], a[80:83]
    v_mfma_f32_16x16x32_bf16 a[84:87], a[176:179], v[120:123], a[84:87]
    ds_read_b64_tr_b16 a[188:189], v191 offset:16392
    v_mfma_f32_16x16x32_bf16 a[88:91], a[176:179], v[124:127], a[88:91]
    ds_read_b64_tr_b16 a[190:191], v191 offset:17416
    v_mfma_f32_16x16x32_bf16 a[92:95], a[176:179], v[128:131], a[92:95]
    buffer_load_dwordx4 v202, s[12:15], s37 offen offset:2048 lds
    v_mfma_f32_16x16x32_bf16 a[96:99], a[176:179], v[132:135], a[96:99]
    s_waitcnt lgkmcnt(0)
    v_mfma_f32_16x16x32_bf16 a[100:103], a[180:183], v[116:119], a[100:103]
    s_waitcnt vmcnt(12)
    v_mfma_f32_16x16x32_bf16 a[104:107], a[180:183], v[120:123], a[104:107]
    s_barrier
    v_add_u32 v192, s39, v232
    v_mfma_f32_16x16x32_bf16 a[108:111], a[180:183], v[124:127], a[108:111]
    ds_read_b128 v[96:99], v192 offset:0
    v_mfma_f32_16x16x32_bf16 a[112:115], a[180:183], v[128:131], a[112:115]
    ds_read_b64_tr_b16 a[160:161], v188 offset:32768
    v_mfma_f32_16x16x32_bf16 a[116:119], a[180:183], v[132:135], a[116:119]
    ds_read_b64_tr_b16 a[162:163], v188 offset:33792
    v_mfma_f32_16x16x32_bf16 a[120:123], a[184:187], v[116:119], a[120:123]
    ds_read_b128 v[100:103], v192 offset:2048
    v_mfma_f32_16x16x32_bf16 a[124:127], a[184:187], v[120:123], a[124:127]
    ds_read_b128 v[104:107], v192 offset:4096
    v_mfma_f32_16x16x32_bf16 a[128:131], a[184:187], v[124:127], a[128:131]
    ds_read_b128 v[108:111], v192 offset:6144
    v_mfma_f32_16x16x32_bf16 a[132:135], a[184:187], v[128:131], a[132:135]
    ds_read_b128 v[112:115], v192 offset:8192
    v_mfma_f32_16x16x32_bf16 a[136:139], a[184:187], v[132:135], a[136:139]
    buffer_load_dwordx4 v203, s[12:15], s37 offen offset:3072 lds
    v_mfma_f32_16x16x32_bf16 a[140:143], a[188:191], v[116:119], a[140:143]
    s_add_u32 s37, s37, 262144
    ds_read_b64_tr_b16 a[164:165], v188 offset:32776
    v_mfma_f32_16x16x32_bf16 a[144:147], a[188:191], v[120:123], a[144:147]
    ds_read_b64_tr_b16 a[166:167], v188 offset:33800
    v_mfma_f32_16x16x32_bf16 a[148:151], a[188:191], v[124:127], a[148:151]
    v_mfma_f32_16x16x32_bf16 a[152:155], a[188:191], v[128:131], a[152:155]
    s_cmp_lt_u32 s37, s93
    s_cselect_b32 s37, s37, s92
    v_mfma_f32_16x16x32_bf16 a[156:159], a[188:191], v[132:135], a[156:159]
    ds_read_b64_tr_b16 a[168:169], v189 offset:32768
    s_waitcnt lgkmcnt(3)
    v_mfma_f32_16x16x32_bf16 a[0:3], a[160:163], v[96:99], a[0:3]
    ds_read_b64_tr_b16 a[170:171], v189 offset:33792
    v_mfma_f32_16x16x32_bf16 a[4:7], a[160:163], v[100:103], a[4:7]
    s_mov_b32 m0, s38
    v_mfma_f32_16x16x32_bf16 a[8:11], a[160:163], v[104:107], a[8:11]
    buffer_load_dwordx4 v234, s[8:11], s36 offen lds
    v_mfma_f32_16x16x32_bf16 a[12:15], a[160:163], v[108:111], a[12:15]
    v_mfma_f32_16x16x32_bf16 a[16:19], a[160:163], v[112:115], a[16:19]
    ds_read_b64_tr_b16 a[172:173], v189 offset:32776
    s_waitcnt lgkmcnt(3)
    v_mfma_f32_16x16x32_bf16 a[20:23], a[164:167], v[96:99], a[20:23]
    ds_read_b64_tr_b16 a[174:175], v189 offset:33800
    v_mfma_f32_16x16x32_bf16 a[24:27], a[164:167], v[100:103], a[24:27]
    buffer_load_dwordx4 v235, s[8:11], s36 offen offset:1024 lds
    v_mfma_f32_16x16x32_bf16 a[28:31], a[164:167], v[104:107], a[28:31]
    s_add_u32 m0, s42, 16384
    v_mfma_f32_16x16x32_bf16 a[32:35], a[164:167], v[108:111], a[32:35]
    buffer_load_dwordx4 v200, s[12:15], s37 offen lds
    v_mfma_f32_16x16x32_bf16 a[36:39], a[164:167], v[112:115], a[36:39]
    ds_read_b64_tr_b16 a[176:177], v190 offset:32768
    s_waitcnt lgkmcnt(3)
    v_mfma_f32_16x16x32_bf16 a[40:43], a[168:171], v[96:99], a[40:43]
    ds_read_b64_tr_b16 a[178:179], v190 offset:33792
    v_mfma_f32_16x16x32_bf16 a[44:47], a[168:171], v[100:103], a[44:47]
    v_mfma_f32_16x16x32_bf16 a[48:51], a[168:171], v[104:107], a[48:51]
    buffer_load_dwordx4 v201, s[12:15], s37 offen offset:1024 lds
    v_mfma_f32_16x16x32_bf16 a[52:55], a[168:171], v[108:111], a[52:55]
    v_mfma_f32_16x16x32_bf16 a[56:59], a[168:171], v[112:115], a[56:59]
    ds_read_b64_tr_b16 a[180:181], v190 offset:32776
    s_waitcnt lgkmcnt(3)
    v_mfma_f32_16x16x32_bf16 a[60:63], a[172:175], v[96:99], a[60:63]
    ds_read_b64_tr_b16 a[182:183], v190 offset:33800
    s_mov_b32 m0, s38
    v_mfma_f32_16x16x32_bf16 a[64:67], a[172:175], v[100:103], a[64:67]
    buffer_load_dwordx4 v236, s[8:11], s36 offen offset:2048 lds
    v_mfma_f32_16x16x32_bf16 a[68:71], a[172:175], v[104:107], a[68:71]
    v_mfma_f32_16x16x32_bf16 a[72:75], a[172:175], v[108:111], a[72:75]
    ds_read_b64_tr_b16 a[184:185], v191 offset:32768
    v_mfma_f32_16x16x32_bf16 a[76:79], a[172:175], v[112:115], a[76:79]
    ds_read_b64_tr_b16 a[186:187], v191 offset:33792
    s_waitcnt lgkmcnt(4)
    v_mfma_f32_16x16x32_bf16 a[80:83], a[176:179], v[96:99], a[80:83]
    buffer_load_dwordx4 v237, s[8:11], s36 offen offset:3072 lds
    v_mfma_f32_16x16x32_bf16 a[84:87], a[176:179], v[100:103], a[84:87]
    ds_read_b64_tr_b16 a[188:189], v191 offset:32776
    v_mfma_f32_16x16x32_bf16 a[88:91], a[176:179], v[104:107], a[88:91]
    ds_read_b64_tr_b16 a[190:191], v191 offset:33800
    s_add_u32 m0, s42, 16384
    v_mfma_f32_16x16x32_bf16 a[92:95], a[176:179], v[108:111], a[92:95]
    buffer_load_dwordx4 v202, s[12:15], s37 offen offset:2048 lds
    v_mfma_f32_16x16x32_bf16 a[96:99], a[176:179], v[112:115], a[96:99]
    s_waitcnt lgkmcnt(0)
    v_mfma_f32_16x16x32_bf16 a[100:103], a[180:183], v[96:99], a[100:103]
    s_waitcnt vmcnt(12)
    v_mfma_f32_16x16x32_bf16 a[104:107], a[180:183], v[100:103], a[104:107]
    s_barrier
    v_add_u32 v192, s39, v233
    v_mfma_f32_16x16x32_bf16 a[108:111], a[180:183], v[104:107], a[108:111]
    ds_read_b128 v[116:119], v192 offset:0
    v_mfma_f32_16x16x32_bf16 a[112:115], a[180:183], v[108:111], a[112:115]
    ds_read_b64_tr_b16 a[160:161], v188 offset:49152
    v_mfma_f32_16x16x32_bf16 a[116:119], a[180:183], v[112:115], a[116:119]
    ds_read_b64_tr_b16 a[162:163], v188 offset:50176
    v_mfma_f32_16x16x32_bf16 a[120:123], a[184:187], v[96:99], a[120:123]
    ds_read_b128 v[120:123], v192 offset:2048
    v_mfma_f32_16x16x32_bf16 a[124:127], a[184:187], v[100:103], a[124:127]
    ds_read_b128 v[124:127], v192 offset:4096
    v_mfma_f32_16x16x32_bf16 a[128:131], a[184:187], v[104:107], a[128:131]
    ds_read_b128 v[128:131], v192 offset:6144
    v_mfma_f32_16x16x32_bf16 a[132:135], a[184:187], v[108:111], a[132:135]
    ds_read_b128 v[132:135], v192 offset:8192
    v_mfma_f32_16x16x32_bf16 a[136:139], a[184:187], v[112:115], a[136:139]
    buffer_load_dwordx4 v203, s[12:15], s37 offen offset:3072 lds
    v_mfma_f32_16x16x32_bf16 a[140:143], a[188:191], v[96:99], a[140:143]
    s_add_u32 s37, s37, 262144
    ds_read_b64_tr_b16 a[164:165], v188 offset:49160
    v_mfma_f32_16x16x32_bf16 a[144:147], a[188:191], v[100:103], a[144:147]
    s_add_u32 m0, s38, 4096
    ds_read_b64_tr_b16 a[166:167], v188 offset:50184
    v_mfma_f32_16x16x32_bf16 a[148:151], a[188:191], v[104:107], a[148:151]
    buffer_load_dwordx4 v238, s[8:11], s36 offen lds
    v_mfma_f32_16x16x32_bf16 a[152:155], a[188:191], v[108:111], a[152:155]
    s_add_u32 s36, s36, 128
    s_cmp_lt_u32 s37, s93
    s_cselect_b32 s37, s37, s92
    v_mfma_f32_16x16x32_bf16 a[156:159], a[188:191], v[112:115], a[156:159]
    s_cmp_lt_u32 s36, s95
    s_cselect_b32 s36, s36, s94
    ds_read_b64_tr_b16 a[168:169], v189 offset:49152
    s_waitcnt lgkmcnt(3)
    v_mfma_f32_16x16x32_bf16 a[0:3], a[160:163], v[116:119], a[0:3]
    s_add_u32 s38, s38, 20480
    s_cmp_eq_u32 s38, s73
    s_cselect_b32 s38, s43, s38
    ds_read_b64_tr_b16 a[170:171], v189 offset:50176
    v_mfma_f32_16x16x32_bf16 a[4:7], a[160:163], v[120:123], a[4:7]
    s_add_u32 m0, s42, 32768
    v_mfma_f32_16x16x32_bf16 a[8:11], a[160:163], v[124:127], a[8:11]
    buffer_load_dwordx4 v200, s[12:15], s37 offen lds
    v_mfma_f32_16x16x32_bf16 a[12:15], a[160:163], v[128:131], a[12:15]
    v_mfma_f32_16x16x32_bf16 a[16:19], a[160:163], v[132:135], a[16:19]
    ds_read_b64_tr_b16 a[172:173], v189 offset:49160
    s_waitcnt lgkmcnt(3)
    v_mfma_f32_16x16x32_bf16 a[20:23], a[164:167], v[116:119], a[20:23]
    ds_read_b64_tr_b16 a[174:175], v189 offset:50184
    v_mfma_f32_16x16x32_bf16 a[24:27], a[164:167], v[120:123], a[24:27]
    v_mfma_f32_16x16x32_bf16 a[28:31], a[164:167], v[124:127], a[28:31]
    v_mfma_f32_16x16x32_bf16 a[32:35], a[164:167], v[128:131], a[32:35]
    v_mfma_f32_16x16x32_bf16 a[36:39], a[164:167], v[132:135], a[36:39]
    ds_read_b64_tr_b16 a[176:177], v190 offset:49152
    s_waitcnt lgkmcnt(3)
    v_mfma_f32_16x16x32_bf16 a[40:43], a[168:171], v[116:119], a[40:43]
    ds_read_b64_tr_b16 a[178:179], v190 offset:50176
    v_mfma_f32_16x16x32_bf16 a[44:47], a[168:171], v[120:123], a[44:47]
    v_mfma_f32_16x16x32_bf16 a[48:51], a[168:171], v[124:127], a[48:51]
    buffer_load_dwordx4 v201, s[12:15], s37 offen offset:1024 lds
    v_mfma_f32_16x16x32_bf16 a[52:55], a[168:171], v[128:131], a[52:55]
    v_mfma_f32_16x16x32_bf16 a[56:59], a[168:171], v[132:135], a[56:59]
    ds_read_b64_tr_b16 a[180:181], v190 offset:49160
    s_waitcnt lgkmcnt(3)
    v_mfma_f32_16x16x32_bf16 a[60:63], a[172:175], v[116:119], a[60:63]
    ds_read_b64_tr_b16 a[182:183], v190 offset:50184
    v_mfma_f32_16x16x32_bf16 a[64:67], a[172:175], v[120:123], a[64:67]
    v_mfma_f32_16x16x32_bf16 a[68:71], a[172:175], v[124:127], a[68:71]
    v_mfma_f32_16x16x32_bf16 a[72:75], a[172:175], v[128:131], a[72:75]
    ds_read_b64_tr_b16 a[184:185], v191 offset:49152
    s_add_u32 s39, s39, 20480
    v_mfma_f32_16x16x32_bf16 a[76:79], a[172:175], v[132:135], a[76:79]
    ds_read_b64_tr_b16 a[186:187], v191 offset:50176
    s_cmp_eq_u32 s39, 61440
    s_cselect_b32 s39, 0, s39
    s_waitcnt lgkmcnt(4)
    v_mfma_f32_16x16x32_bf16 a[80:83], a[176:179], v[116:119], a[80:83]
    v_mfma_f32_16x16x32_bf16 a[84:87], a[176:179], v[120:123], a[84:87]
    ds_read_b64_tr_b16 a[188:189], v191 offset:49160
    v_mfma_f32_16x16x32_bf16 a[88:91], a[176:179], v[124:127], a[88:91]
    ds_read_b64_tr_b16 a[190:191], v191 offset:50184
    v_mfma_f32_16x16x32_bf16 a[92:95], a[176:179], v[128:131], a[92:95]
    buffer_load_dwordx4 v202, s[12:15], s37 offen offset:2048 lds
    v_mfma_f32_16x16x32_bf16 a[96:99], a[176:179], v[132:135], a[96:99]
    s_waitcnt lgkmcnt(0)
    v_mfma_f32_16x16x32_bf16 a[100:103], a[180:183], v[116:119], a[100:103]
    s_waitcnt vmcnt(12)
    v_mfma_f32_16x16x32_bf16 a[104:107], a[180:183], v[120:123], a[104:107]
    s_barrier
    v_add_u32 v192, s39, v232
    v_mfma_f32_16x16x32_bf16 a[108:111], a[180:183], v[124:127], a[108:111]
    ds_read_b128 v[96:99], v192 offset:0
    v_mfma_f32_16x16x32_bf16 a[112:115], a[180:183], v[128:131], a[112:115]
    ds_read_b64_tr_b16 a[160:161], v188 offset:0
    v_mfma_f32_16x16x32_bf16 a[116:119], a[180:183], v[132:135], a[116:119]
    ds_read_b64_tr_b16 a[162:163], v188 offset:1024
    v_mfma_f32_16x16x32_bf16 a[120:123], a[184:187], v[116:119], a[120:123]
    ds_read_b128 v[100:103], v192 offset:2048
    v_mfma_f32_16x16x32_bf16 a[124:127], a[184:187], v[120:123], a[124:127]
    ds_read_b128 v[104:107], v192 offset:4096
    v_mfma_f32_16x16x32_bf16 a[128:131], a[184:187], v[124:127], a[128:131]
    ds_read_b128 v[108:111], v192 offset:6144
    v_mfma_f32_16x16x32_bf16 a[132:135], a[184:187], v[128:131], a[132:135]
    ds_read_b128 v[112:115], v192 offset:8192
    v_mfma_f32_16x16x32_bf16 a[136:139], a[184:187], v[132:135], a[136:139]
    buffer_load_dwordx4 v203, s[12:15], s37 offen offset:3072 lds
    v_mfma_f32_16x16x32_bf16 a[140:143], a[188:191], v[116:119], a[140:143]
    s_add_u32 s37, s37, 262144
    ds_read_b64_tr_b16 a[164:165], v188 offset:8
    v_mfma_f32_16x16x32_bf16 a[144:147], a[188:191], v[120:123], a[144:147]
    ds_read_b64_tr_b16 a[166:167], v188 offset:1032
    v_mfma_f32_16x16x32_bf16 a[148:151], a[188:191], v[124:127], a[148:151]
    v_mfma_f32_16x16x32_bf16 a[152:155], a[188:191], v[128:131], a[152:155]
    s_cmp_lt_u32 s37, s93
    s_cselect_b32 s37, s37, s92
    v_mfma_f32_16x16x32_bf16 a[156:159], a[188:191], v[132:135], a[156:159]
    ds_read_b64_tr_b16 a[168:169], v189 offset:0
    s_mov_b32 s40, 3
.p2align 6
L1_qloop:
    s_waitcnt lgkmcnt(3)
    v_mfma_f32_16x16x32_bf16 a[0:3], a[160:163], v[96:99], a[0:3]
    ds_read_b64_tr_b16 a[170:171], v189 offset:1024
    v_mfma_f32_16x16x32_bf16 a[4:7], a[160:163], v[100:103], a[4:7]
    s_mov_b32 m0, s38
    v_mfma_f32_16x16x32_bf16 a[8:11], a[160:163], v[104:107], a[8:11]
    buffer_load_dwordx4 v234, s[8:11], s36 offen lds
    v_mfma_f32_16x16x32_bf16 a[12:15], a[160:163], v[108:111], a[12:15]
    v_mfma_f32_16x16x32_bf16 a[16:19], a[160:163], v[112:115], a[16:19]
    ds_read_b64_tr_b16 a[172:173], v189 offset:8
    s_waitcnt lgkmcnt(3)
    v_mfma_f32_16x16x32_bf16 a[20:23], a[164:167], v[96:99], a[20:23]
    ds_read_b64_tr_b16 a[174:175], v189 offset:1032
    v_mfma_f32_16x16x32_bf16 a[24:27], a[164:167], v[100:103], a[24:27]
    buffer_load_dwordx4 v235, s[8:11], s36 offen offset:1024 lds
    v_mfma_f32_16x16x32_bf16 a[28:31], a[164:167], v[104:107], a[28:31]
    s_add_u32 m0, s42, 49152
    v_mfma_f32_16x16x32_bf16 a[32:35], a[164:167], v[108:111], a[32:35]
    buffer_load_dwordx4 v200, s[12:15], s37 offen lds
    v_mfma_f32_16x16x32_bf16 a[36:39], a[164:167], v[112:115], a[36:39]
    ds_read_b64_tr_b16 a[176:177], v190 offset:0
    s_waitcnt lgkmcnt(3)
    v_mfma_f32_16x16x32_bf16 a[40:43], a[168:171], v[96:99], a[40:43]
    ds_read_b64_tr_b16 a[178:179], v190 offset:1024
    v_mfma_f32_16x16x32_bf16 a[44:47], a[168:171], v[100:103], a[44:47]
    v_mfma_f32_16x16x32_bf16 a[48:51], a[168:171], v[104:107], a[48:51]
    buffer_load_dwordx4 v201, s[12:15], s37 offen offset:1024 lds
    v_mfma_f32_16x16x32_bf16 a[52:55], a[168:171], v[108:111], a[52:55]
    v_mfma_f32_16x16x32_bf16 a[56:59], a[168:171], v[112:115], a[56:59]
    ds_read_b64_tr_b16 a[180:181], v190 offset:8
    s_waitcnt lgkmcnt(3)
    v_mfma_f32_16x16x32_bf16 a[60:63], a[172:175], v[96:99], a[60:63]
    ds_read_b64_tr_b16 a[182:183], v190 offset:1032
    s_mov_b32 m0, s38
    v_mfma_f32_16x16x32_bf16 a[64:67], a[172:175], v[100:103], a[64:67]
    buffer_load_dwordx4 v236, s[8:11], s36 offen offset:2048 lds
    v_mfma_f32_16x16x32_bf16 a[68:71], a[172:175], v[104:107], a[68:71]
    v_mfma_f32_16x16x32_bf16 a[72:75], a[172:175], v[108:111], a[72:75]
    ds_read_b64_tr_b16 a[184:185], v191 offset:0
    v_mfma_f32_16x16x32_bf16 a[76:79], a[172:175], v[112:115], a[76:79]
    ds_read_b64_tr_b16 a[186:187], v191 offset:1024
    s_waitcnt lgkmcnt(4)
    v_mfma_f32_16x16x32_bf16 a[80:83], a[176:179], v[96:99], a[80:83]
    buffer_load_dwordx4 v237, s[8:11], s36 offen offset:3072 lds
    v_mfma_f32_16x16x32_bf16 a[84:87], a[176:179], v[100:103], a[84:87]
    ds_read_b64_tr_b16 a[188:189], v191 offset:8
    v_mfma_f32_16x16x32_bf16 a[88:91], a[176:179], v[104:107], a[88:91]
    ds_read_b64_tr_b16 a[190:191], v191 offset:1032
    s_add_u32 m0, s42, 49152
    v_mfma_f32_16x16x32_bf16 a[92:95], a[176:179], v[108:111], a[92:95]
    buffer_load_dwordx4 v202, s[12:15], s37 offen offset:2048 lds
    v_mfma_f32_16x16x32_bf16 a[96:99], a[176:179], v[112:115], a[96:99]
    s_waitcnt lgkmcnt(0)
    v_mfma_f32_16x16x32_bf16 a[100:103], a[180:183], v[96:99], a[100:103]
    s_waitcnt vmcnt(12)
    v_mfma_f32_16x16x32_bf16 a[104:107], a[180:183], v[100:103], a[104:107]
    s_barrier
    v_add_u32 v192, s39, v233
    v_mfma_f32_16x16x32_bf16 a[108:111], a[180:183], v[104:107], a[108:111]
    ds_read_b128 v[116:119], v192 offset:0
    v_mfma_f32_16x16x32_bf16 a[112:115], a[180:183], v[108:111], a[112:115]
    ds_read_b64_tr_b16 a[160:161], v188 offset:16384
    v_mfma_f32_16x16x32_bf16 a[116:119], a[180:183], v[112:115], a[116:119]
    ds_read_b64_tr_b16 a[162:163], v188 offset:17408
    v_mfma_f32_16x16x32_bf16 a[120:123], a[184:187], v[96:99], a[120:123]
    ds_read_b128 v[120:123], v192 offset:2048
    v_mfma_f32_16x16x32_bf16 a[124:127], a[184:187], v[100:103], a[124:127]
    ds_read_b128 v[124:127], v192 offset:4096
    v_mfma_f32_16x16x32_bf16 a[128:131], a[184:187], v[104:107], a[128:131]
    ds_read_b128 v[128:131], v192 offset:6144
    v_mfma_f32_16x16x32_bf16 a[132:135], a[184:187], v[108:111], a[132:135]
    ds_read_b128 v[132:135], v192 offset:8192
    v_mfma_f32_16x16x32_bf16 a[136:139], a[184:187], v[112:115], a[136:139]
    buffer_load_dwordx4 v203, s[12:15], s37 offen offset:3072 lds
    v_mfma_f32_16x16x32_bf16 a[140:143], a[188:191], v[96:99], a[140:143]
    s_add_u32 s37, s37, 262144
    ds_read_b64_tr_b16 a[164:165], v188 offset:16392
    v_mfma_f32_16x16x32_bf16 a[144:147], a[188:191], v[100:103], a[144:147]
    s_add_u32 m0, s38, 4096
    ds_read_b64_tr_b16 a[166:167], v188 offset:17416
    v_mfma_f32_16x16x32_bf16 a[148:151], a[188:191], v[104:107], a[148:151]
    buffer_load_dwordx4 v238, s[8:11], s36 offen lds
    v_mfma_f32_16x16x32_bf16 a[152:155], a[188:191], v[108:111], a[152:155]
    s_add_u32 s36, s36, 128
    s_cmp_lt_u32 s37, s93
    s_cselect_b32 s37, s37, s92
    v_mfma_f32_16x16x32_bf16 a[156:159], a[188:191], v[112:115], a[156:159]
    s_cmp_lt_u32 s36, s95
    s_cselect_b32 s36, s36, s94
    ds_read_b64_tr_b16 a[168:169], v189 offset:16384
    s_waitcnt lgkmcnt(3)
    v_mfma_f32_16x16x32_bf16 a[0:3], a[160:163], v[116:119], a[0:3]
    s_add_u32 s38, s38, 20480
    s_cmp_eq_u32 s38, s73
    s_cselect_b32 s38, s43, s38
    ds_read_b64_tr_b16 a[170:171], v189 offset:17408
    v_mfma_f32_16x16x32_bf16 a[4:7], a[160:163], v[120:123], a[4:7]
    s_mov_b32 m0, s42
    v_mfma_f32_16x16x32_bf16 a[8:11], a[160:163], v[124:127], a[8:11]
    buffer_load_dwordx4 v200, s[12:15], s37 offen lds
    v_mfma_f32_16x16x32_bf16 a[12:15], a[160:163], v[128:131], a[12:15]
    v_mfma_f32_16x16x32_bf16 a[16:19], a[160:163], v[132:135], a[16:19]
    ds_read_b64_tr_b16 a[172:173], v189 offset:16392
    s_waitcnt lgkmcnt(3)
    v_mfma_f32_16x16x32_bf16 a[20:23], a[164:167], v[116:119], a[20:23]
    ds_read_b64_tr_b16 a[174:175], v189 offset:17416
    v_mfma_f32_16x16x32_bf16 a[24:27], a[164:167], v[120:123], a[24:27]
    v_mfma_f32_16x16x32_bf16 a[28:31], a[164:167], v[124:127], a[28:31]
    v_mfma_f32_16x16x32_bf16 a[32:35], a[164:167], v[128:131], a[32:35]
    v_mfma_f32_16x16x32_bf16 a[36:39], a[164:167], v[132:135], a[36:39]
    ds_read_b64_tr_b16 a[176:177], v190 offset:16384
    s_waitcnt lgkmcnt(3)
    v_mfma_f32_16x16x32_bf16 a[40:43], a[168:171], v[116:119], a[40:43]
    ds_read_b64_tr_b16 a[178:179], v190 offset:17408
    v_mfma_f32_16x16x32_bf16 a[44:47], a[168:171], v[120:123], a[44:47]
    v_mfma_f32_16x16x32_bf16 a[48:51], a[168:171], v[124:127], a[48:51]
    buffer_load_dwordx4 v201, s[12:15], s37 offen offset:1024 lds
    v_mfma_f32_16x16x32_bf16 a[52:55], a[168:171], v[128:131], a[52:55]
    v_mfma_f32_16x16x32_bf16 a[56:59], a[168:171], v[132:135], a[56:59]
    ds_read_b64_tr_b16 a[180:181], v190 offset:16392
    s_waitcnt lgkmcnt(3)
    v_mfma_f32_16x16x32_bf16 a[60:63], a[172:175], v[116:119], a[60:63]
    ds_read_b64_tr_b16 a[182:183], v190 offset:17416
    v_mfma_f32_16x16x32_bf16 a[64:67], a[172:175], v[120:123], a[64:67]
    v_mfma_f32_16x16x32_bf16 a[68:71], a[172:175], v[124:127], a[68:71]
    v_mfma_f32_16x16x32_bf16 a[72:75], a[172:175], v[128:131], a[72:75]
    ds_read_b64_tr_b16 a[184:185], v191 offset:16384
    s_add_u32 s39, s39, 20480
    v_mfma_f32_16x16x32_bf16 a[76:79], a[172:175], v[132:135], a[76:79]
    ds_read_b64_tr_b16 a[186:187], v191 offset:17408
    s_cmp_eq_u32 s39, 61440
    s_cselect_b32 s39, 0, s39
    s_waitcnt lgkmcnt(4)
    v_mfma_f32_16x16x32_bf16 a[80:83], a[176:179], v[116:119], a[80:83]
    v_mfma_f32_16x16x32_bf16 a[84:87], a[176:179], v[120:123], a[84:87]
    ds_read_b64_tr_b16 a[188:189], v191 offset:16392
    v_mfma_f32_16x16x32_bf16 a[88:91], a[176:179], v[124:127], a[88:91]
    ds_read_b64_tr_b16 a[190:191], v191 offset:17416
    v_mfma_f32_16x16x32_bf16 a[92:95], a[176:179], v[128:131], a[92:95]
    buffer_load_dwordx4 v202, s[12:15], s37 offen offset:2048 lds
    v_mfma_f32_16x16x32_bf16 a[96:99], a[176:179], v[132:135], a[96:99]
    s_waitcnt lgkmcnt(0)
    v_mfma_f32_16x16x32_bf16 a[100:103], a[180:183], v[116:119], a[100:103]
    s_waitcnt vmcnt(12)
    v_mfma_f32_16x16x32_bf16 a[104:107], a[180:183], v[120:123], a[104:107]
    s_barrier
    v_add_u32 v192, s39, v232
    v_mfma_f32_16x16x32_bf16 a[108:111], a[180:183], v[124:127], a[108:111]
    ds_read_b128 v[96:99], v192 offset:0
    v_mfma_f32_16x16x32_bf16 a[112:115], a[180:183], v[128:131], a[112:115]
    ds_read_b64_tr_b16 a[160:161], v188 offset:32768
    v_mfma_f32_16x16x32_bf16 a[116:119], a[180:183], v[132:135], a[116:119]
    ds_read_b64_tr_b16 a[162:163], v188 offset:33792
    v_mfma_f32_16x16x32_bf16 a[120:123], a[184:187], v[116:119], a[120:123]
    ds_read_b128 v[100:103], v192 offset:2048
    v_mfma_f32_16x16x32_bf16 a[124:127], a[184:187], v[120:123], a[124:127]
    ds_read_b128 v[104:107], v192 offset:4096
    v_mfma_f32_16x16x32_bf16 a[128:131], a[184:187], v[124:127], a[128:131]
    ds_read_b128 v[108:111], v192 offset:6144
    v_mfma_f32_16x16x32_bf16 a[132:135], a[184:187], v[128:131], a[132:135]
    ds_read_b128 v[112:115], v192 offset:8192
    v_mfma_f32_16x16x32_bf16 a[136:139], a[184:187], v[132:135], a[136:139]
    buffer_load_dwordx4 v203, s[12:15], s37 offen offset:3072 lds
    v_mfma_f32_16x16x32_bf16 a[140:143], a[188:191], v[116:119], a[140:143]
    s_add_u32 s37, s37, 262144
    ds_read_b64_tr_b16 a[164:165], v188 offset:32776
    v_mfma_f32_16x16x32_bf16 a[144:147], a[188:191], v[120:123], a[144:147]
    ds_read_b64_tr_b16 a[166:167], v188 offset:33800
    v_mfma_f32_16x16x32_bf16 a[148:151], a[188:191], v[124:127], a[148:151]
    v_mfma_f32_16x16x32_bf16 a[152:155], a[188:191], v[128:131], a[152:155]
    s_cmp_lt_u32 s37, s93
    s_cselect_b32 s37, s37, s92
    v_mfma_f32_16x16x32_bf16 a[156:159], a[188:191], v[132:135], a[156:159]
    ds_read_b64_tr_b16 a[168:169], v189 offset:32768
    s_waitcnt lgkmcnt(3)
    v_mfma_f32_16x16x32_bf16 a[0:3], a[160:163], v[96:99], a[0:3]
    ds_read_b64_tr_b16 a[170:171], v189 offset:33792
    v_mfma_f32_16x16x32_bf16 a[4:7], a[160:163], v[100:103], a[4:7]
    s_mov_b32 m0, s38
    v_mfma_f32_16x16x32_bf16 a[8:11], a[160:163], v[104:107], a[8:11]
    buffer_load_dwordx4 v234, s[8:11], s36 offen lds
    v_mfma_f32_16x16x32_bf16 a[12:15], a[160:163], v[108:111], a[12:15]
    v_mfma_f32_16x16x32_bf16 a[16:19], a[160:163], v[112:115], a[16:19]
    ds_read_b64_tr_b16 a[172:173], v189 offset:32776
    s_waitcnt lgkmcnt(3)
    v_mfma_f32_16x16x32_bf16 a[20:23], a[164:167], v[96:99], a[20:23]
    ds_read_b64_tr_b16 a[174:175], v189 offset:33800
    v_mfma_f32_16x16x32_bf16 a[24:27], a[164:167], v[100:103], a[24:27]
    buffer_load_dwordx4 v235, s[8:11], s36 offen offset:1024 lds
    v_mfma_f32_16x16x32_bf16 a[28:31], a[164:167], v[104:107], a[28:31]
    s_add_u32 m0, s42, 16384
    v_mfma_f32_16x16x32_bf16 a[32:35], a[164:167], v[108:111], a[32:35]
    buffer_load_dwordx4 v200, s[12:15], s37 offen lds
    v_mfma_f32_16x16x32_bf16 a[36:39], a[164:167], v[112:115], a[36:39]
    ds_read_b64_tr_b16 a[176:177], v190 offset:32768
    s_waitcnt lgkmcnt(3)
    v_mfma_f32_16x16x32_bf16 a[40:43], a[168:171], v[96:99], a[40:43]
    ds_read_b64_tr_b16 a[178:179], v190 offset:33792
    v_mfma_f32_16x16x32_bf16 a[44:47], a[168:171], v[100:103], a[44:47]
    v_mfma_f32_16x16x32_bf16 a[48:51], a[168:171], v[104:107], a[48:51]
    buffer_load_dwordx4 v201, s[12:15], s37 offen offset:1024 lds
    v_mfma_f32_16x16x32_bf16 a[52:55], a[168:171], v[108:111], a[52:55]
    v_mfma_f32_16x16x32_bf16 a[56:59], a[168:171], v[112:115], a[56:59]
    ds_read_b64_tr_b16 a[180:181], v190 offset:32776
    s_waitcnt lgkmcnt(3)
    v_mfma_f32_16x16x32_bf16 a[60:63], a[172:175], v[96:99], a[60:63]
    ds_read_b64_tr_b16 a[182:183], v190 offset:33800
    s_mov_b32 m0, s38
    v_mfma_f32_16x16x32_bf16 a[64:67], a[172:175], v[100:103], a[64:67]
    buffer_load_dwordx4 v236, s[8:11], s36 offen offset:2048 lds
    v_mfma_f32_16x16x32_bf16 a[68:71], a[172:175], v[104:107], a[68:71]
    v_mfma_f32_16x16x32_bf16 a[72:75], a[172:175], v[108:111], a[72:75]
    ds_read_b64_tr_b16 a[184:185], v191 offset:32768
    v_mfma_f32_16x16x32_bf16 a[76:79], a[172:175], v[112:115], a[76:79]
    ds_read_b64_tr_b16 a[186:187], v191 offset:33792
    s_waitcnt lgkmcnt(4)
    v_mfma_f32_16x16x32_bf16 a[80:83], a[176:179], v[96:99], a[80:83]
    buffer_load_dwordx4 v237, s[8:11], s36 offen offset:3072 lds
    v_mfma_f32_16x16x32_bf16 a[84:87], a[176:179], v[100:103], a[84:87]
    ds_read_b64_tr_b16 a[188:189], v191 offset:32776
    v_mfma_f32_16x16x32_bf16 a[88:91], a[176:179], v[104:107], a[88:91]
    ds_read_b64_tr_b16 a[190:191], v191 offset:33800
    s_add_u32 m0, s42, 16384
    v_mfma_f32_16x16x32_bf16 a[92:95], a[176:179], v[108:111], a[92:95]
    buffer_load_dwordx4 v202, s[12:15], s37 offen offset:2048 lds
    v_mfma_f32_16x16x32_bf16 a[96:99], a[176:179], v[112:115], a[96:99]
    s_waitcnt lgkmcnt(0)
    v_mfma_f32_16x16x32_bf16 a[100:103], a[180:183], v[96:99], a[100:103]
    s_waitcnt vmcnt(12)
    v_mfma_f32_16x16x32_bf16 a[104:107], a[180:183], v[100:103], a[104:107]
    s_barrier
    v_add_u32 v192, s39, v233
    v_mfma_f32_16x16x32_bf16 a[108:111], a[180:183], v[104:107], a[108:111]
    ds_read_b128 v[116:119], v192 offset:0
    v_mfma_f32_16x16x32_bf16 a[112:115], a[180:183], v[108:111], a[112:115]
    ds_read_b64_tr_b16 a[160:161], v188 offset:49152
    v_mfma_f32_16x16x32_bf16 a[116:119], a[180:183], v[112:115], a[116:119]
    ds_read_b64_tr_b16 a[162:163], v188 offset:50176
    v_mfma_f32_16x16x32_bf16 a[120:123], a[184:187], v[96:99], a[120:123]
    ds_read_b128 v[120:123], v192 offset:2048
    v_mfma_f32_16x16x32_bf16 a[124:127], a[184:187], v[100:103], a[124:127]
    ds_read_b128 v[124:127], v192 offset:4096
    v_mfma_f32_16x16x32_bf16 a[128:131], a[184:187], v[104:107], a[128:131]
    ds_read_b128 v[128:131], v192 offset:6144
    v_mfma_f32_16x16x32_bf16 a[132:135], a[184:187], v[108:111], a[132:135]
    ds_read_b128 v[132:135], v192 offset:8192
    v_mfma_f32_16x16x32_bf16 a[136:139], a[184:187], v[112:115], a[136:139]
    buffer_load_dwordx4 v203, s[12:15], s37 offen offset:3072 lds
    v_mfma_f32_16x16x32_bf16 a[140:143], a[188:191], v[96:99], a[140:143]
    s_add_u32 s37, s37, 262144
    ds_read_b64_tr_b16 a[164:165], v188 offset:49160
    v_mfma_f32_16x16x32_bf16 a[144:147], a[188:191], v[100:103], a[144:147]
    s_add_u32 m0, s38, 4096
    ds_read_b64_tr_b16 a[166:167], v188 offset:50184
    v_mfma_f32_16x16x32_bf16 a[148:151], a[188:191], v[104:107], a[148:151]
    buffer_load_dwordx4 v238, s[8:11], s36 offen lds
    v_mfma_f32_16x16x32_bf16 a[152:155], a[188:191], v[108:111], a[152:155]
    s_add_u32 s36, s36, 128
    s_cmp_lt_u32 s37, s93
    s_cselect_b32 s37, s37, s92
    v_mfma_f32_16x16x32_bf16 a[156:159], a[188:191], v[112:115], a[156:159]
    s_cmp_lt_u32 s36, s95
    s_cselect_b32 s36, s36, s94
    ds_read_b64_tr_b16 a[168:169], v189 offset:49152
    s_waitcnt lgkmcnt(3)
    v_mfma_f32_16x16x32_bf16 a[0:3], a[160:163], v[116:119], a[0:3]
    s_add_u32 s38, s38, 20480
    s_cmp_eq_u32 s38, s73
    s_cselect_b32 s38, s43, s38
    ds_read_b64_tr_b16 a[170:171], v189 offset:50176
    v_mfma_f32_16x16x32_bf16 a[4:7], a[160:163], v[120:123], a[4:7]
    s_add_u32 m0, s42, 32768
    v_mfma_f32_16x16x32_bf16 a[8:11], a[160:163], v[124:127], a[8:11]
    buffer_load_dwordx4 v200, s[12:15], s37 offen lds
    v_mfma_f32_16x16x32_bf16 a[12:15], a[160:163], v[128:131], a[12:15]
    v_mfma_f32_16x16x32_bf16 a[16:19], a[160:163], v[132:135], a[16:19]
    ds_read_b64_tr_b16 a[172:173], v189 offset:49160
    s_waitcnt lgkmcnt(3)
    v_mfma_f32_16x16x32_bf16 a[20:23], a[164:167], v[116:119], a[20:23]
    ds_read_b64_tr_b16 a[174:175], v189 offset:50184
    v_mfma_f32_16x16x32_bf16 a[24:27], a[164:167], v[120:123], a[24:27]
    v_mfma_f32_16x16x32_bf16 a[28:31], a[164:167], v[124:127], a[28:31]
    v_mfma_f32_16x16x32_bf16 a[32:35], a[164:167], v[128:131], a[32:35]
    v_mfma_f32_16x16x32_bf16 a[36:39], a[164:167], v[132:135], a[36:39]
    ds_read_b64_tr_b16 a[176:177], v190 offset:49152
    s_waitcnt lgkmcnt(3)
    v_mfma_f32_16x16x32_bf16 a[40:43], a[168:171], v[116:119], a[40:43]
    ds_read_b64_tr_b16 a[178:179], v190 offset:50176
    v_mfma_f32_16x16x32_bf16 a[44:47], a[168:171], v[120:123], a[44:47]
    v_mfma_f32_16x16x32_bf16 a[48:51], a[168:171], v[124:127], a[48:51]
    buffer_load_dwordx4 v201, s[12:15], s37 offen offset:1024 lds
    v_mfma_f32_16x16x32_bf16 a[52:55], a[168:171], v[128:131], a[52:55]
    v_mfma_f32_16x16x32_bf16 a[56:59], a[168:171], v[132:135], a[56:59]
    ds_read_b64_tr_b16 a[180:181], v190 offset:49160
    s_waitcnt lgkmcnt(3)
    v_mfma_f32_16x16x32_bf16 a[60:63], a[172:175], v[116:119], a[60:63]
    ds_read_b64_tr_b16 a[182:183], v190 offset:50184
    v_mfma_f32_16x16x32_bf16 a[64:67], a[172:175], v[120:123], a[64:67]
    v_mfma_f32_16x16x32_bf16 a[68:71], a[172:175], v[124:127], a[68:71]
    v_mfma_f32_16x16x32_bf16 a[72:75], a[172:175], v[128:131], a[72:75]
    ds_read_b64_tr_b16 a[184:185], v191 offset:49152
    s_add_u32 s39, s39, 20480
    v_mfma_f32_16x16x32_bf16 a[76:79], a[172:175], v[132:135], a[76:79]
    ds_read_b64_tr_b16 a[186:187], v191 offset:50176
    s_cmp_eq_u32 s39, 61440
    s_cselect_b32 s39, 0, s39
    s_waitcnt lgkmcnt(4)
    v_mfma_f32_16x16x32_bf16 a[80:83], a[176:179], v[116:119], a[80:83]
    v_mfma_f32_16x16x32_bf16 a[84:87], a[176:179], v[120:123], a[84:87]
    ds_read_b64_tr_b16 a[188:189], v191 offset:49160
    v_mfma_f32_16x16x32_bf16 a[88:91], a[176:179], v[124:127], a[88:91]
    ds_read_b64_tr_b16 a[190:191], v191 offset:50184
    v_mfma_f32_16x16x32_bf16 a[92:95], a[176:179], v[128:131], a[92:95]
    buffer_load_dwordx4 v202, s[12:15], s37 offen offset:2048 lds
    v_mfma_f32_16x16x32_bf16 a[96:99], a[176:179], v[132:135], a[96:99]
    s_waitcnt lgkmcnt(0)
    v_mfma_f32_16x16x32_bf16 a[100:103], a[180:183], v[116:119], a[100:103]
    s_waitcnt vmcnt(12)
    v_mfma_f32_16x16x32_bf16 a[104:107], a[180:183], v[120:123], a[104:107]
    s_barrier
    v_add_u32 v192, s39, v232
    v_mfma_f32_16x16x32_bf16 a[108:111], a[180:183], v[124:127], a[108:111]
    ds_read_b128 v[96:99], v192 offset:0
    v_mfma_f32_16x16x32_bf16 a[112:115], a[180:183], v[128:131], a[112:115]
    ds_read_b64_tr_b16 a[160:161], v188 offset:0
    v_mfma_f32_16x16x32_bf16 a[116:119], a[180:183], v[132:135], a[116:119]
    ds_read_b64_tr_b16 a[162:163], v188 offset:1024
    v_mfma_f32_16x16x32_bf16 a[120:123], a[184:187], v[116:119], a[120:123]
    ds_read_b128 v[100:103], v192 offset:2048
    v_mfma_f32_16x16x32_bf16 a[124:127], a[184:187], v[120:123], a[124:127]
    ds_read_b128 v[104:107], v192 offset:4096
    v_mfma_f32_16x16x32_bf16 a[128:131], a[184:187], v[124:127], a[128:131]
    ds_read_b128 v[108:111], v192 offset:6144
    v_mfma_f32_16x16x32_bf16 a[132:135], a[184:187], v[128:131], a[132:135]
    ds_read_b128 v[112:115], v192 offset:8192
    v_mfma_f32_16x16x32_bf16 a[136:139], a[184:187], v[132:135], a[136:139]
    buffer_load_dwordx4 v203, s[12:15], s37 offen offset:3072 lds
    v_mfma_f32_16x16x32_bf16 a[140:143], a[188:191], v[116:119], a[140:143]
    s_add_u32 s37, s37, 262144
    ds_read_b64_tr_b16 a[164:165], v188 offset:8
    v_mfma_f32_16x16x32_bf16 a[144:147], a[188:191], v[120:123], a[144:147]
    ds_read_b64_tr_b16 a[166:167], v188 offset:1032
    v_mfma_f32_16x16x32_bf16 a[148:151], a[188:191], v[124:127], a[148:151]
    v_mfma_f32_16x16x32_bf16 a[152:155], a[188:191], v[128:131], a[152:155]
    s_cmp_lt_u32 s37, s93
    s_cselect_b32 s37, s37, s92
    v_mfma_f32_16x16x32_bf16 a[156:159], a[188:191], v[132:135], a[156:159]
    ds_read_b64_tr_b16 a[168:169], v189 offset:0
    s_sub_u32 s40, s40, 1
    s_cmp_lg_u32 s40, 0
    s_cbranch_scc1 L1_qloop
    s_lshl_b32 s68, s32, 5
    s_add_u32 s68, s68, s33
    s_lshl_b32 s47, s68, 18
    s_add_u32 s18, s47, 262144
    s_mov_b32 s22, s18
    s_lshl_b32 s68, s30, 12
    s_add_u32 s34, s47, s68
    s_mov_b32 s35, s34
    s_lshl_b32 s68, s71, 4
    s_add_u32 s68, s68, s32
    s_mul_i32 s68, s68, 10
    s_mul_i32 s69, s30, 5
    s_add_u32 s68, s68, s69
    s_lshl_b32 s68, s68, 7
    s_lshl_b32 s69, s33, 2
    s_add_u32 s68, s68, s69
    s_lshl_b32 s48, s68, 10
    s_waitcnt lgkmcnt(3)
    v_mfma_f32_16x16x32_bf16 a[0:3], a[160:163], v[96:99], a[0:3]
    ds_read_b64_tr_b16 a[170:171], v189 offset:1024
    v_mfma_f32_16x16x32_bf16 a[4:7], a[160:163], v[100:103], a[4:7]
    s_add_u32 m0, s42, 49152
    v_mfma_f32_16x16x32_bf16 a[8:11], a[160:163], v[104:107], a[8:11]
    buffer_load_dwordx4 v200, s[12:15], s37 offen lds
    v_mfma_f32_16x16x32_bf16 a[12:15], a[160:163], v[108:111], a[12:15]
    v_mfma_f32_16x16x32_bf16 a[16:19], a[160:163], v[112:115], a[16:19]
    ds_read_b64_tr_b16 a[172:173], v189 offset:8
    s_waitcnt lgkmcnt(3)
    v_mfma_f32_16x16x32_bf16 a[20:23], a[164:167], v[96:99], a[20:23]
    ds_read_b64_tr_b16 a[174:175], v189 offset:1032
    v_mfma_f32_16x16x32_bf16 a[24:27], a[164:167], v[100:103], a[24:27]
    v_mfma_f32_16x16x32_bf16 a[28:31], a[164:167], v[104:107], a[28:31]
    v_mfma_f32_16x16x32_bf16 a[32:35], a[164:167], v[108:111], a[32:35]
    v_mfma_f32_16x16x32_bf16 a[36:39], a[164:167], v[112:115], a[36:39]
    ds_read_b64_tr_b16 a[176:177], v190 offset:0
    s_waitcnt lgkmcnt(3)
    v_mfma_f32_16x16x32_bf16 a[40:43], a[168:171], v[96:99], a[40:43]
    ds_read_b64_tr_b16 a[178:179], v190 offset:1024
    v_mfma_f32_16x16x32_bf16 a[44:47], a[168:171], v[100:103], a[44:47]
    v_mfma_f32_16x16x32_bf16 a[48:51], a[168:171], v[104:107], a[48:51]
    buffer_load_dwordx4 v201, s[12:15], s37 offen offset:1024 lds
    v_mfma_f32_16x16x32_bf16 a[52:55], a[168:171], v[108:111], a[52:55]
    v_mfma_f32_16x16x32_bf16 a[56:59], a[168:171], v[112:115], a[56:59]
    ds_read_b64_tr_b16 a[180:181], v190 offset:8
    s_waitcnt lgkmcnt(3)
    v_mfma_f32_16x16x32_bf16 a[60:63], a[172:175], v[96:99], a[60:63]
    ds_read_b64_tr_b16 a[182:183], v190 offset:1032
    v_mfma_f32_16x16x32_bf16 a[64:67], a[172:175], v[100:103], a[64:67]
    v_mfma_f32_16x16x32_bf16 a[68:71], a[172:175], v[104:107], a[68:71]
    v_mfma_f32_16x16x32_bf16 a[72:75], a[172:175], v[108:111], a[72:75]
    ds_read_b64_tr_b16 a[184:185], v191 offset:0
    v_mfma_f32_16x16x32_bf16 a[76:79], a[172:175], v[112:115], a[76:79]
    ds_read_b64_tr_b16 a[186:187], v191 offset:1024
    s_waitcnt lgkmcnt(4)
    v_mfma_f32_16x16x32_bf16 a[80:83], a[176:179], v[96:99], a[80:83]
    v_mfma_f32_16x16x32_bf16 a[84:87], a[176:179], v[100:103], a[84:87]
    ds_read_b64_tr_b16 a[188:189], v191 offset:8
    v_mfma_f32_16x16x32_bf16 a[88:91], a[176:179], v[104:107], a[88:91]
    ds_read_b64_tr_b16 a[190:191], v191 offset:1032
    v_mfma_f32_16x16x32_bf16 a[92:95], a[176:179], v[108:111], a[92:95]
    buffer_load_dwordx4 v202, s[12:15], s37 offen offset:2048 lds
    v_mfma_f32_16x16x32_bf16 a[96:99], a[176:179], v[112:115], a[96:99]
    s_waitcnt lgkmcnt(0)
    v_mfma_f32_16x16x32_bf16 a[100:103], a[180:183], v[96:99], a[100:103]
    s_waitcnt vmcnt(8)
    v_mfma_f32_16x16x32_bf16 a[104:107], a[180:183], v[100:103], a[104:107]
    s_barrier
    v_add_u32 v192, s39, v233
    v_mfma_f32_16x16x32_bf16 a[108:111], a[180:183], v[104:107], a[108:111]
    ds_read_b128 v[116:119], v192 offset:0
    v_mfma_f32_16x16x32_bf16 a[112:115], a[180:183], v[108:111], a[112:115]
    ds_read_b64_tr_b16 a[160:161], v188 offset:16384
    v_mfma_f32_16x16x32_bf16 a[116:119], a[180:183], v[112:115], a[116:119]
    ds_read_b64_tr_b16 a[162:163], v188 offset:17408
    v_mfma_f32_16x16x32_bf16 a[120:123], a[184:187], v[96:99], a[120:123]
    ds_read_b128 v[120:123], v192 offset:2048
    v_mfma_f32_16x16x32_bf16 a[124:127], a[184:187], v[100:103], a[124:127]
    ds_read_b128 v[124:127], v192 offset:4096
    v_mfma_f32_16x16x32_bf16 a[128:131], a[184:187], v[104:107], a[128:131]
    ds_read_b128 v[128:131], v192 offset:6144
    v_mfma_f32_16x16x32_bf16 a[132:135], a[184:187], v[108:111], a[132:135]
    ds_read_b128 v[132:135], v192 offset:8192
    v_mfma_f32_16x16x32_bf16 a[136:139], a[184:187], v[112:115], a[136:139]
    buffer_load_dwordx4 v203, s[12:15], s37 offen offset:3072 lds
    v_mfma_f32_16x16x32_bf16 a[140:143], a[188:191], v[96:99], a[140:143]
    s_add_u32 s37, s37, 262144
    ds_read_b64_tr_b16 a[164:165], v188 offset:16392
    v_mfma_f32_16x16x32_bf16 a[144:147], a[188:191], v[100:103], a[144:147]
    ds_read_b64_tr_b16 a[166:167], v188 offset:17416
    v_mfma_f32_16x16x32_bf16 a[148:151], a[188:191], v[104:107], a[148:151]
    v_mfma_f32_16x16x32_bf16 a[152:155], a[188:191], v[108:111], a[152:155]
    s_cmp_lt_u32 s37, s93
    s_cselect_b32 s37, s37, s92
    v_mfma_f32_16x16x32_bf16 a[156:159], a[188:191], v[112:115], a[156:159]
    ds_read_b64_tr_b16 a[168:169], v189 offset:16384
    s_mov_b32 m0, s41
    s_waitcnt lgkmcnt(3)
    v_mfma_f32_16x16x32_bf16 a[0:3], a[160:163], v[116:119], a[0:3]
    ds_read_b64_tr_b16 a[170:171], v189 offset:17408
    buffer_load_dwordx4 v194, s[16:19], s34 offen nt lds
    v_mfma_f32_16x16x32_bf16 a[4:7], a[160:163], v[120:123], a[4:7]
    buffer_load_dwordx4 v195, s[16:19], s34 offen offset:1024 nt lds
    v_mfma_f32_16x16x32_bf16 a[8:11], a[160:163], v[124:127], a[8:11]
    buffer_load_dwordx4 v196, s[16:19], s34 offen offset:2048 nt lds
    v_mfma_f32_16x16x32_bf16 a[12:15], a[160:163], v[128:131], a[12:15]
    buffer_load_dwordx4 v197, s[16:19], s34 offen offset:3072 nt lds
    s_add_u32 s34, s34, 8192
    v_mfma_f32_16x16x32_bf16 a[16:19], a[160:163], v[132:135], a[16:19]
    ds_read_b64_tr_b16 a[172:173], v189 offset:16392
    s_mov_b32 m0, s42
    s_waitcnt lgkmcnt(3)
    v_mfma_f32_16x16x32_bf16 a[20:23], a[164:167], v[116:119], a[20:23]
    ds_read_b64_tr_b16 a[174:175], v189 offset:17416
    buffer_load_dwordx4 v198, s[20:23], s35 offen nt lds
    v_mfma_f32_16x16x32_bf16 a[24:27], a[164:167], v[120:123], a[24:27]
    buffer_load_dwordx4 v199, s[20:23], s35 offen offset:1024 nt lds
    v_mfma_f32_16x16x32_bf16 a[28:31], a[164:167], v[124:127], a[28:31]
    buffer_load_dwordx4 v198, s[20:23], s35 offen offset:2048 nt lds
    v_mfma_f32_16x16x32_bf16 a[32:35], a[164:167], v[128:131], a[32:35]
    buffer_load_dwordx4 v199, s[20:23], s35 offen offset:3072 nt lds
    s_add_u32 s35, s35, 8192
    v_mfma_f32_16x16x32_bf16 a[36:39], a[164:167], v[132:135], a[36:39]
    ds_read_b64_tr_b16 a[176:177], v190 offset:16384
    s_waitcnt lgkmcnt(3)
    v_mfma_f32_16x16x32_bf16 a[40:43], a[168:171], v[116:119], a[40:43]
    ds_read_b64_tr_b16 a[178:179], v190 offset:17408
    v_mfma_f32_16x16x32_bf16 a[44:47], a[168:171], v[120:123], a[44:47]
    v_mfma_f32_16x16x32_bf16 a[48:51], a[168:171], v[124:127], a[48:51]
    v_mfma_f32_16x16x32_bf16 a[52:55], a[168:171], v[128:131], a[52:55]
    v_mfma_f32_16x16x32_bf16 a[56:59], a[168:171], v[132:135], a[56:59]
    ds_read_b64_tr_b16 a[180:181], v190 offset:16392
    s_waitcnt lgkmcnt(3)
    v_mfma_f32_16x16x32_bf16 a[60:63], a[172:175], v[116:119], a[60:63]
    ds_read_b64_tr_b16 a[182:183], v190 offset:17416
    v_mfma_f32_16x16x32_bf16 a[64:67], a[172:175], v[120:123], a[64:67]
    v_mfma_f32_16x16x32_bf16 a[68:71], a[172:175], v[124:127], a[68:71]
    v_mfma_f32_16x16x32_bf16 a[72:75], a[172:175], v[128:131], a[72:75]
    ds_read_b64_tr_b16 a[184:185], v191 offset:16384
    s_add_u32 s39, s39, 20480
    v_mfma_f32_16x16x32_bf16 a[76:79], a[172:175], v[132:135], a[76:79]
    ds_read_b64_tr_b16 a[186:187], v191 offset:17408
    s_cmp_eq_u32 s39, 61440
    s_cselect_b32 s39, 0, s39
    s_waitcnt lgkmcnt(4)
    v_mfma_f32_16x16x32_bf16 a[80:83], a[176:179], v[116:119], a[80:83]
    v_mfma_f32_16x16x32_bf16 a[84:87], a[176:179], v[120:123], a[84:87]
    ds_read_b64_tr_b16 a[188:189], v191 offset:16392
    v_mfma_f32_16x16x32_bf16 a[88:91], a[176:179], v[124:127], a[88:91]
    ds_read_b64_tr_b16 a[190:191], v191 offset:17416
    v_mfma_f32_16x16x32_bf16 a[92:95], a[176:179], v[128:131], a[92:95]
    v_mfma_f32_16x16x32_bf16 a[96:99], a[176:179], v[132:135], a[96:99]
    s_waitcnt lgkmcnt(0)
    v_mfma_f32_16x16x32_bf16 a[100:103], a[180:183], v[116:119], a[100:103]
    s_waitcnt vmcnt(12)
    v_mfma_f32_16x16x32_bf16 a[104:107], a[180:183], v[120:123], a[104:107]
    s_barrier
    v_add_u32 v192, s39, v232
    v_mfma_f32_16x16x32_bf16 a[108:111], a[180:183], v[124:127], a[108:111]
    ds_read_b128 v[96:99], v192 offset:0
    v_mfma_f32_16x16x32_bf16 a[112:115], a[180:183], v[128:131], a[112:115]
    ds_read_b64_tr_b16 a[160:161], v188 offset:32768
    v_mfma_f32_16x16x32_bf16 a[116:119], a[180:183], v[132:135], a[116:119]
    ds_read_b64_tr_b16 a[162:163], v188 offset:33792
    v_mfma_f32_16x16x32_bf16 a[120:123], a[184:187], v[116:119], a[120:123]
    ds_read_b128 v[100:103], v192 offset:2048
    v_mfma_f32_16x16x32_bf16 a[124:127], a[184:187], v[120:123], a[124:127]
    ds_read_b128 v[104:107], v192 offset:4096
    v_mfma_f32_16x16x32_bf16 a[128:131], a[184:187], v[124:127], a[128:131]
    ds_read_b128 v[108:111], v192 offset:6144
    v_mfma_f32_16x16x32_bf16 a[132:135], a[184:187], v[128:131], a[132:135]
    ds_read_b128 v[112:115], v192 offset:8192
    v_mfma_f32_16x16x32_bf16 a[136:139], a[184:187], v[132:135], a[136:139]
    v_mfma_f32_16x16x32_bf16 a[140:143], a[188:191], v[116:119], a[140:143]
    ds_read_b64_tr_b16 a[164:165], v188 offset:32776
    v_mfma_f32_16x16x32_bf16 a[144:147], a[188:191], v[120:123], a[144:147]
    ds_read_b64_tr_b16 a[166:167], v188 offset:33800
    v_mfma_f32_16x16x32_bf16 a[148:151], a[188:191], v[124:127], a[148:151]
    v_mfma_f32_16x16x32_bf16 a[152:155], a[188:191], v[128:131], a[152:155]
    v_mfma_f32_16x16x32_bf16 a[156:159], a[188:191], v[132:135], a[156:159]
    ds_read_b64_tr_b16 a[168:169], v189 offset:32768
    s_add_u32 m0, s42, 16384
    s_waitcnt lgkmcnt(3)
    v_mfma_f32_16x16x32_bf16 a[0:3], a[160:163], v[96:99], a[0:3]
    ds_read_b64_tr_b16 a[170:171], v189 offset:33792
    buffer_load_dwordx4 v198, s[20:23], s35 offen nt lds
    v_mfma_f32_16x16x32_bf16 a[4:7], a[160:163], v[100:103], a[4:7]
    buffer_load_dwordx4 v199, s[20:23], s35 offen offset:1024 nt lds
    v_mfma_f32_16x16x32_bf16 a[8:11], a[160:163], v[104:107], a[8:11]
    buffer_load_dwordx4 v198, s[20:23], s35 offen offset:2048 nt lds
    v_mfma_f32_16x16x32_bf16 a[12:15], a[160:163], v[108:111], a[12:15]
    buffer_load_dwordx4 v199, s[20:23], s35 offen offset:3072 nt lds
    s_add_u32 s35, s35, 8192
    v_mfma_f32_16x16x32_bf16 a[16:19], a[160:163], v[112:115], a[16:19]
    ds_read_b64_tr_b16 a[172:173], v189 offset:32776
    s_waitcnt lgkmcnt(3)
    v_mfma_f32_16x16x32_bf16 a[20:23], a[164:167], v[96:99], a[20:23]
    ds_read_b64_tr_b16 a[174:175], v189 offset:33800
    v_mfma_f32_16x16x32_bf16 a[24:27], a[164:167], v[100:103], a[24:27]
    v_mfma_f32_16x16x32_bf16 a[28:31], a[164:167], v[104:107], a[28:31]
    v_mfma_f32_16x16x32_bf16 a[32:35], a[164:167], v[108:111], a[32:35]
    v_mfma_f32_16x16x32_bf16 a[36:39], a[164:167], v[112:115], a[36:39]
    ds_read_b64_tr_b16 a[176:177], v190 offset:32768
    s_waitcnt lgkmcnt(3)
    v_mfma_f32_16x16x32_bf16 a[40:43], a[168:171], v[96:99], a[40:43]
    ds_read_b64_tr_b16 a[178:179], v190 offset:33792
    v_mfma_f32_16x16x32_bf16 a[44:47], a[168:171], v[100:103], a[44:47]
    v_mfma_f32_16x16x32_bf16 a[48:51], a[168:171], v[104:107], a[48:51]
    v_mfma_f32_16x16x32_bf16 a[52:55], a[168:171], v[108:111], a[52:55]
    v_mfma_f32_16x16x32_bf16 a[56:59], a[168:171], v[112:115], a[56:59]
    ds_read_b64_tr_b16 a[180:181], v190 offset:32776
    s_waitcnt lgkmcnt(3)
    v_mfma_f32_16x16x32_bf16 a[60:63], a[172:175], v[96:99], a[60:63]
    ds_read_b64_tr_b16 a[182:183], v190 offset:33800
    v_mfma_f32_16x16x32_bf16 a[64:67], a[172:175], v[100:103], a[64:67]
    v_mfma_f32_16x16x32_bf16 a[68:71], a[172:175], v[104:107], a[68:71]
    v_mfma_f32_16x16x32_bf16 a[72:75], a[172:175], v[108:111], a[72:75]
    ds_read_b64_tr_b16 a[184:185], v191 offset:32768
    v_mfma_f32_16x16x32_bf16 a[76:79], a[172:175], v[112:115], a[76:79]
    ds_read_b64_tr_b16 a[186:187], v191 offset:33792
    s_waitcnt lgkmcnt(4)
    v_mfma_f32_16x16x32_bf16 a[80:83], a[176:179], v[96:99], a[80:83]
    v_mfma_f32_16x16x32_bf16 a[84:87], a[176:179], v[100:103], a[84:87]
    ds_read_b64_tr_b16 a[188:189], v191 offset:32776
    v_mfma_f32_16x16x32_bf16 a[88:91], a[176:179], v[104:107], a[88:91]
    ds_read_b64_tr_b16 a[190:191], v191 offset:33800
    v_mfma_f32_16x16x32_bf16 a[92:95], a[176:179], v[108:111], a[92:95]
    v_mfma_f32_16x16x32_bf16 a[96:99], a[176:179], v[112:115], a[96:99]
    s_waitcnt lgkmcnt(0)
    v_mfma_f32_16x16x32_bf16 a[100:103], a[180:183], v[96:99], a[100:103]
    s_waitcnt vmcnt(12)
    v_mfma_f32_16x16x32_bf16 a[104:107], a[180:183], v[100:103], a[104:107]
    s_barrier
    v_add_u32 v192, s39, v233
    v_mfma_f32_16x16x32_bf16 a[108:111], a[180:183], v[104:107], a[108:111]
    ds_read_b128 v[116:119], v192 offset:0
    v_mfma_f32_16x16x32_bf16 a[112:115], a[180:183], v[108:111], a[112:115]
    ds_read_b64_tr_b16 a[160:161], v188 offset:49152
    v_mfma_f32_16x16x32_bf16 a[116:119], a[180:183], v[112:115], a[116:119]
    ds_read_b64_tr_b16 a[162:163], v188 offset:50176
    v_mfma_f32_16x16x32_bf16 a[120:123], a[184:187], v[96:99], a[120:123]
    ds_read_b128 v[120:123], v192 offset:2048
    v_mfma_f32_16x16x32_bf16 a[124:127], a[184:187], v[100:103], a[124:127]
    ds_read_b128 v[124:127], v192 offset:4096
    v_mfma_f32_16x16x32_bf16 a[128:131], a[184:187], v[104:107], a[128:131]
    ds_read_b128 v[128:131], v192 offset:6144
    v_mfma_f32_16x16x32_bf16 a[132:135], a[184:187], v[108:111], a[132:135]
    ds_read_b128 v[132:135], v192 offset:8192
    v_mfma_f32_16x16x32_bf16 a[136:139], a[184:187], v[112:115], a[136:139]
    v_mfma_f32_16x16x32_bf16 a[140:143], a[188:191], v[96:99], a[140:143]
    ds_read_b64_tr_b16 a[164:165], v188 offset:49160
    v_mfma_f32_16x16x32_bf16 a[144:147], a[188:191], v[100:103], a[144:147]
    ds_read_b64_tr_b16 a[166:167], v188 offset:50184
    v_mfma_f32_16x16x32_bf16 a[148:151], a[188:191], v[104:107], a[148:151]
    v_mfma_f32_16x16x32_bf16 a[152:155], a[188:191], v[108:111], a[152:155]
    v_mfma_f32_16x16x32_bf16 a[156:159], a[188:191], v[112:115], a[156:159]
    ds_read_b64_tr_b16 a[168:169], v189 offset:49152
    s_add_u32 m0, s41, 16384
    s_waitcnt lgkmcnt(3)
    v_mfma_f32_16x16x32_bf16 a[0:3], a[160:163], v[116:119], a[0:3]
    ds_read_b64_tr_b16 a[170:171], v189 offset:50176
    buffer_load_dwordx4 v194, s[16:19], s34 offen nt lds
    v_mfma_f32_16x16x32_bf16 a[4:7], a[160:163], v[120:123], a[4:7]
    buffer_load_dwordx4 v195, s[16:19], s34 offen offset:1024 nt lds
    v_mfma_f32_16x16x32_bf16 a[8:11], a[160:163], v[124:127], a[8:11]
    buffer_load_dwordx4 v196, s[16:19], s34 offen offset:2048 nt lds
    v_mfma_f32_16x16x32_bf16 a[12:15], a[160:163], v[128:131], a[12:15]
    buffer_load_dwordx4 v197, s[16:19], s34 offen offset:3072 nt lds
    s_add_u32 s34, s34, 8192
    v_mfma_f32_16x16x32_bf16 a[16:19], a[160:163], v[132:135], a[16:19]
    ds_read_b64_tr_b16 a[172:173], v189 offset:49160
    s_add_u32 m0, s42, 32768
    s_waitcnt lgkmcnt(3)
    v_mfma_f32_16x16x32_bf16 a[20:23], a[164:167], v[116:119], a[20:23]
    ds_read_b64_tr_b16 a[174:175], v189 offset:50184
    buffer_load_dwordx4 v198, s[20:23], s35 offen nt lds
    v_mfma_f32_16x16x32_bf16 a[24:27], a[164:167], v[120:123], a[24:27]
    buffer_load_dwordx4 v199, s[20:23], s35 offen offset:1024 nt lds
    v_mfma_f32_16x16x32_bf16 a[28:31], a[164:167], v[124:127], a[28:31]
    buffer_load_dwordx4 v198, s[20:23], s35 offen offset:2048 nt lds
    v_mfma_f32_16x16x32_bf16 a[32:35], a[164:167], v[128:131], a[32:35]
    buffer_load_dwordx4 v199, s[20:23], s35 offen offset:3072 nt lds
    s_add_u32 s35, s35, 8192
    v_mfma_f32_16x16x32_bf16 a[36:39], a[164:167], v[132:135], a[36:39]
    ds_read_b64_tr_b16 a[176:177], v190 offset:49152
    s_waitcnt lgkmcnt(3)
    v_mfma_f32_16x16x32_bf16 a[40:43], a[168:171], v[116:119], a[40:43]
    ds_read_b64_tr_b16 a[178:179], v190 offset:50176
    v_mfma_f32_16x16x32_bf16 a[44:47], a[168:171], v[120:123], a[44:47]
    v_mfma_f32_16x16x32_bf16 a[48:51], a[168:171], v[124:127], a[48:51]
    v_mfma_f32_16x16x32_bf16 a[52:55], a[168:171], v[128:131], a[52:55]
    v_mfma_f32_16x16x32_bf16 a[56:59], a[168:171], v[132:135], a[56:59]
    ds_read_b64_tr_b16 a[180:181], v190 offset:49160
    s_waitcnt lgkmcnt(3)
    v_mfma_f32_16x16x32_bf16 a[60:63], a[172:175], v[116:119], a[60:63]
    ds_read_b64_tr_b16 a[182:183], v190 offset:50184
    v_mfma_f32_16x16x32_bf16 a[64:67], a[172:175], v[120:123], a[64:67]
    v_mfma_f32_16x16x32_bf16 a[68:71], a[172:175], v[124:127], a[68:71]
    v_mfma_f32_16x16x32_bf16 a[72:75], a[172:175], v[128:131], a[72:75]
    ds_read_b64_tr_b16 a[184:185], v191 offset:49152
    s_add_u32 s39, s39, 20480
    v_mfma_f32_16x16x32_bf16 a[76:79], a[172:175], v[132:135], a[76:79]
    ds_read_b64_tr_b16 a[186:187], v191 offset:50176
    s_cmp_eq_u32 s39, 61440
    s_cselect_b32 s39, 0, s39
    s_waitcnt lgkmcnt(4)
    v_mfma_f32_16x16x32_bf16 a[80:83], a[176:179], v[116:119], a[80:83]
    v_mfma_f32_16x16x32_bf16 a[84:87], a[176:179], v[120:123], a[84:87]
    ds_read_b64_tr_b16 a[188:189], v191 offset:49160
    v_mfma_f32_16x16x32_bf16 a[88:91], a[176:179], v[124:127], a[88:91]
    ds_read_b64_tr_b16 a[190:191], v191 offset:50184
    v_mfma_f32_16x16x32_bf16 a[92:95], a[176:179], v[128:131], a[92:95]
    v_mfma_f32_16x16x32_bf16 a[96:99], a[176:179], v[132:135], a[96:99]
    s_waitcnt lgkmcnt(3)
    v_mfma_f32_16x16x32_bf16 a[100:103], a[180:183], v[116:119], a[100:103]
    v_mfma_f32_16x16x32_bf16 a[104:107], a[180:183], v[120:123], a[104:107]
    v_mfma_f32_16x16x32_bf16 a[108:111], a[180:183], v[124:127], a[108:111]
    v_mfma_f32_16x16x32_bf16 a[112:115], a[180:183], v[128:131], a[112:115]
    v_mfma_f32_16x16x32_bf16 a[116:119], a[180:183], v[132:135], a[116:119]
    s_waitcnt lgkmcnt(0)
    v_mfma_f32_16x16x32_bf16 a[120:123], a[184:187], v[116:119], a[120:123]
    v_mfma_f32_16x16x32_bf16 a[124:127], a[184:187], v[120:123], a[124:127]
    v_mfma_f32_16x16x32_bf16 a[128:131], a[184:187], v[124:127], a[128:131]
    v_mfma_f32_16x16x32_bf16 a[132:135], a[184:187], v[128:131], a[132:135]
    v_mfma_f32_16x16x32_bf16 a[136:139], a[184:187], v[132:135], a[136:139]
    v_mfma_f32_16x16x32_bf16 a[140:143], a[188:191], v[116:119], a[140:143]
    v_mfma_f32_16x16x32_bf16 a[144:147], a[188:191], v[120:123], a[144:147]
    v_mfma_f32_16x16x32_bf16 a[148:151], a[188:191], v[124:127], a[148:151]
    v_mfma_f32_16x16x32_bf16 a[152:155], a[188:191], v[128:131], a[152:155]
    v_mfma_f32_16x16x32_bf16 a[156:159], a[188:191], v[132:135], a[156:159]
    s_waitcnt lgkmcnt(0)
    s_waitcnt vmcnt(16)
    s_barrier
    s_add_u32 m0, s41, 32768
    s_nop 0
    buffer_load_dwordx4 v194, s[16:19], s34 offen nt lds
    buffer_load_dwordx4 v195, s[16:19], s34 offen offset:1024 nt lds
    buffer_load_dwordx4 v196, s[16:19], s34 offen offset:2048 nt lds
    buffer_load_dwordx4 v197, s[16:19], s34 offen offset:3072 nt lds
    s_add_u32 s34, s34, 8192
    s_add_u32 m0, s41, 49152
    s_nop 0
    buffer_load_dwordx4 v194, s[16:19], s34 offen nt lds
    buffer_load_dwordx4 v195, s[16:19], s34 offen offset:1024 nt lds
    buffer_load_dwordx4 v196, s[16:19], s34 offen offset:2048 nt lds
    buffer_load_dwordx4 v197, s[16:19], s34 offen offset:3072 nt lds
    s_add_u32 s34, s34, 8192
    ds_read_b128 a[160:163], v176 offset:0
    ds_read_b128 a[164:167], v177 offset:0
    ds_read_b128 a[168:171], v178 offset:0
    ds_read_b128 a[172:175], v179 offset:0
    ds_read_b128 a[176:179], v176 offset:4096
    ds_read_b128 a[180:183], v177 offset:4096
    s_nop 7
    v_accvgpr_read_b32 v216, a0
    v_accvgpr_read_b32 v217, a1
    v_accvgpr_read_b32 v218, a2
    v_accvgpr_read_b32 v219, a3
    v_accvgpr_read_b32 v220, a20
    v_accvgpr_read_b32 v221, a21
    v_accvgpr_read_b32 v222, a22
    v_accvgpr_read_b32 v223, a23
    v_pk_mul_f32 v[216:217], v[216:217], s[44:45]
    v_pk_mul_f32 v[218:219], v[218:219], s[44:45]
    v_pk_mul_f32 v[220:221], v[220:221], s[44:45]
    v_pk_mul_f32 v[222:223], v[222:223], s[44:45]
    v_cvt_pk_bf16_f32 v16, v216, v217
    v_cvt_pk_bf16_f32 v17, v218, v219
    v_cvt_pk_bf16_f32 v18, v220, v221
    v_cvt_pk_bf16_f32 v19, v222, v223
    v_accvgpr_read_b32 v224, a40
    v_accvgpr_read_b32 v225, a41
    v_accvgpr_read_b32 v226, a42
    v_accvgpr_read_b32 v227, a43
    v_accvgpr_read_b32 v228, a60
    v_accvgpr_read_b32 v229, a61
    v_accvgpr_read_b32 v230, a62
    v_accvgpr_read_b32 v231, a63
    v_pk_mul_f32 v[224:225], v[224:225], s[44:45]
    v_pk_mul_f32 v[226:227], v[226:227], s[44:45]
    v_pk_mul_f32 v[228:229], v[228:229], s[44:45]
    v_pk_mul_f32 v[230:231], v[230:231], s[44:45]
    v_cvt_pk_bf16_f32 v20, v224, v225
    v_cvt_pk_bf16_f32 v21, v226, v227
    v_cvt_pk_bf16_f32 v22, v228, v229
    v_cvt_pk_bf16_f32 v23, v230, v231
    v_accvgpr_read_b32 v216, a80
    v_accvgpr_read_b32 v217, a81
    v_accvgpr_read_b32 v218, a82
    v_accvgpr_read_b32 v219, a83
    v_accvgpr_read_b32 v220, a100
    v_accvgpr_read_b32 v221, a101
    v_accvgpr_read_b32 v222, a102
    v_accvgpr_read_b32 v223, a103
    v_pk_mul_f32 v[216:217], v[216:217], s[44:45]
    v_pk_mul_f32 v[218:219], v[218:219], s[44:45]
    v_pk_mul_f32 v[220:221], v[220:221], s[44:45]
    v_pk_mul_f32 v[222:223], v[222:223], s[44:45]
    v_cvt_pk_bf16_f32 v24, v216, v217
    v_cvt_pk_bf16_f32 v25, v218, v219
    v_cvt_pk_bf16_f32 v26, v220, v221
    v_cvt_pk_bf16_f32 v27, v222, v223
    v_accvgpr_read_b32 v224, a120
    v_accvgpr_read_b32 v225, a121
    v_accvgpr_read_b32 v226, a122
    v_accvgpr_read_b32 v227, a123
    v_accvgpr_read_b32 v228, a140
    v_accvgpr_read_b32 v229, a141
    v_accvgpr_read_b32 v230, a142
    v_accvgpr_read_b32 v231, a143
    v_pk_mul_f32 v[224:225], v[224:225], s[44:45]
    v_pk_mul_f32 v[226:227], v[226:227], s[44:45]
    v_pk_mul_f32 v[228:229], v[228:229], s[44:45]
    v_pk_mul_f32 v[230:231], v[230:231], s[44:45]
    v_cvt_pk_bf16_f32 v28, v224, v225
    v_cvt_pk_bf16_f32 v29, v226, v227
    v_cvt_pk_bf16_f32 v30, v228, v229
    v_cvt_pk_bf16_f32 v31, v230, v231
    v_accvgpr_read_b32 v216, a4
    v_accvgpr_read_b32 v217, a5
    v_accvgpr_read_b32 v218, a6
    v_accvgpr_read_b32 v219, a7
    v_accvgpr_read_b32 v220, a24
    v_accvgpr_read_b32 v221, a25
    v_accvgpr_read_b32 v222, a26
    v_accvgpr_read_b32 v223, a27
    v_pk_mul_f32 v[216:217], v[216:217], s[44:45]
    v_pk_mul_f32 v[218:219], v[218:219], s[44:45]
    v_pk_mul_f32 v[220:221], v[220:221], s[44:45]
    v_pk_mul_f32 v[222:223], v[222:223], s[44:45]
    v_cvt_pk_bf16_f32 v32, v216, v217
    v_cvt_pk_bf16_f32 v33, v218, v219
    v_cvt_pk_bf16_f32 v34, v220, v221
    v_cvt_pk_bf16_f32 v35, v222, v223
    v_accvgpr_read_b32 v224, a44
    v_accvgpr_read_b32 v225, a45
    v_accvgpr_read_b32 v226, a46
    v_accvgpr_read_b32 v227, a47
    v_accvgpr_read_b32 v228, a64
    v_accvgpr_read_b32 v229, a65
    v_accvgpr_read_b32 v230, a66
    v_accvgpr_read_b32 v231, a67
    v_pk_mul_f32 v[224:225], v[224:225], s[44:45]
    v_pk_mul_f32 v[226:227], v[226:227], s[44:45]
    v_pk_mul_f32 v[228:229], v[228:229], s[44:45]
    v_pk_mul_f32 v[230:231], v[230:231], s[44:45]
    v_cvt_pk_bf16_f32 v36, v224, v225
    v_cvt_pk_bf16_f32 v37, v226, v227
    v_cvt_pk_bf16_f32 v38, v228, v229
    v_cvt_pk_bf16_f32 v39, v230, v231
    v_accvgpr_read_b32 v216, a84
    v_accvgpr_read_b32 v217, a85
    v_accvgpr_read_b32 v218, a86
    v_accvgpr_read_b32 v219, a87
    v_accvgpr_read_b32 v220, a104
    v_accvgpr_read_b32 v221, a105
    v_accvgpr_read_b32 v222, a106
    v_accvgpr_read_b32 v223, a107
    v_pk_mul_f32 v[216:217], v[216:217], s[44:45]
    v_pk_mul_f32 v[218:219], v[218:219], s[44:45]
    v_pk_mul_f32 v[220:221], v[220:221], s[44:45]
    v_pk_mul_f32 v[222:223], v[222:223], s[44:45]
    v_cvt_pk_bf16_f32 v40, v216, v217
    v_cvt_pk_bf16_f32 v41, v218, v219
    v_cvt_pk_bf16_f32 v42, v220, v221
    v_cvt_pk_bf16_f32 v43, v222, v223
    v_accvgpr_read_b32 v224, a124
    v_accvgpr_read_b32 v225, a125
    v_accvgpr_read_b32 v226, a126
    v_accvgpr_read_b32 v227, a127
    v_accvgpr_read_b32 v228, a144
    v_accvgpr_read_b32 v229, a145
    v_accvgpr_read_b32 v230, a146
    v_accvgpr_read_b32 v231, a147
    v_pk_mul_f32 v[224:225], v[224:225], s[44:45]
    v_pk_mul_f32 v[226:227], v[226:227], s[44:45]
    v_pk_mul_f32 v[228:229], v[228:229], s[44:45]
    v_pk_mul_f32 v[230:231], v[230:231], s[44:45]
    v_cvt_pk_bf16_f32 v44, v224, v225
    v_cvt_pk_bf16_f32 v45, v226, v227
    v_cvt_pk_bf16_f32 v46, v228, v229
    v_cvt_pk_bf16_f32 v47, v230, v231
    v_accvgpr_read_b32 v216, a8
    v_accvgpr_read_b32 v217, a9
    v_accvgpr_read_b32 v218, a10
    v_accvgpr_read_b32 v219, a11
    v_accvgpr_read_b32 v220, a28
    v_accvgpr_read_b32 v221, a29
    v_accvgpr_read_b32 v222, a30
    v_accvgpr_read_b32 v223, a31
    v_pk_mul_f32 v[216:217], v[216:217], s[44:45]
    v_pk_mul_f32 v[218:219], v[218:219], s[44:45]
    v_pk_mul_f32 v[220:221], v[220:221], s[44:45]
    v_pk_mul_f32 v[222:223], v[222:223], s[44:45]
    v_cvt_pk_bf16_f32 v48, v216, v217
    v_cvt_pk_bf16_f32 v49, v218, v219
    v_cvt_pk_bf16_f32 v50, v220, v221
    v_cvt_pk_bf16_f32 v51, v222, v223
    v_accvgpr_read_b32 v224, a48
    v_accvgpr_read_b32 v225, a49
    v_accvgpr_read_b32 v226, a50
    v_accvgpr_read_b32 v227, a51
    v_accvgpr_read_b32 v228, a68
    v_accvgpr_read_b32 v229, a69
    v_accvgpr_read_b32 v230, a70
    v_accvgpr_read_b32 v231, a71
    v_pk_mul_f32 v[224:225], v[224:225], s[44:45]
    v_pk_mul_f32 v[226:227], v[226:227], s[44:45]
    v_pk_mul_f32 v[228:229], v[228:229], s[44:45]
    v_pk_mul_f32 v[230:231], v[230:231], s[44:45]
    v_cvt_pk_bf16_f32 v52, v224, v225
    v_cvt_pk_bf16_f32 v53, v226, v227
    v_cvt_pk_bf16_f32 v54, v228, v229
    v_cvt_pk_bf16_f32 v55, v230, v231
    v_accvgpr_read_b32 v216, a88
    v_accvgpr_read_b32 v217, a89
    v_accvgpr_read_b32 v218, a90
    v_accvgpr_read_b32 v219, a91
    v_accvgpr_read_b32 v220, a108
    v_accvgpr_read_b32 v221, a109
    v_accvgpr_read_b32 v222, a110
    v_accvgpr_read_b32 v223, a111
    v_pk_mul_f32 v[216:217], v[216:217], s[44:45]
    v_pk_mul_f32 v[218:219], v[218:219], s[44:45]
    v_pk_mul_f32 v[220:221], v[220:221], s[44:45]
    v_pk_mul_f32 v[222:223], v[222:223], s[44:45]
    v_cvt_pk_bf16_f32 v56, v216, v217
    v_cvt_pk_bf16_f32 v57, v218, v219
    v_cvt_pk_bf16_f32 v58, v220, v221
    v_cvt_pk_bf16_f32 v59, v222, v223
    v_accvgpr_read_b32 v224, a128
    v_accvgpr_read_b32 v225, a129
    v_accvgpr_read_b32 v226, a130
    v_accvgpr_read_b32 v227, a131
    v_accvgpr_read_b32 v228, a148
    v_accvgpr_read_b32 v229, a149
    v_accvgpr_read_b32 v230, a150
    v_accvgpr_read_b32 v231, a151
    v_pk_mul_f32 v[224:225], v[224:225], s[44:45]
    v_pk_mul_f32 v[226:227], v[226:227], s[44:45]
    v_pk_mul_f32 v[228:229], v[228:229], s[44:45]
    v_pk_mul_f32 v[230:231], v[230:231], s[44:45]
    v_cvt_pk_bf16_f32 v60, v224, v225
    v_cvt_pk_bf16_f32 v61, v226, v227
    v_cvt_pk_bf16_f32 v62, v228, v229
    v_cvt_pk_bf16_f32 v63, v230, v231
    v_accvgpr_read_b32 v216, a12
    v_accvgpr_read_b32 v217, a13
    v_accvgpr_read_b32 v218, a14
    v_accvgpr_read_b32 v219, a15
    v_accvgpr_read_b32 v220, a32
    v_accvgpr_read_b32 v221, a33
    v_accvgpr_read_b32 v222, a34
    v_accvgpr_read_b32 v223, a35
    v_pk_mul_f32 v[216:217], v[216:217], s[44:45]
    v_pk_mul_f32 v[218:219], v[218:219], s[44:45]
    v_pk_mul_f32 v[220:221], v[220:221], s[44:45]
    v_pk_mul_f32 v[222:223], v[222:223], s[44:45]
    v_cvt_pk_bf16_f32 v64, v216, v217
    v_cvt_pk_bf16_f32 v65, v218, v219
    v_cvt_pk_bf16_f32 v66, v220, v221
    v_cvt_pk_bf16_f32 v67, v222, v223
    v_accvgpr_read_b32 v224, a52
    v_accvgpr_read_b32 v225, a53
    v_accvgpr_read_b32 v226, a54
    v_accvgpr_read_b32 v227, a55
    v_accvgpr_read_b32 v228, a72
    v_accvgpr_read_b32 v229, a73
    v_accvgpr_read_b32 v230, a74
    v_accvgpr_read_b32 v231, a75
    v_pk_mul_f32 v[224:225], v[224:225], s[44:45]
    v_pk_mul_f32 v[226:227], v[226:227], s[44:45]
    v_pk_mul_f32 v[228:229], v[228:229], s[44:45]
    v_pk_mul_f32 v[230:231], v[230:231], s[44:45]
    v_cvt_pk_bf16_f32 v68, v224, v225
    v_cvt_pk_bf16_f32 v69, v226, v227
    v_cvt_pk_bf16_f32 v70, v228, v229
    v_cvt_pk_bf16_f32 v71, v230, v231
    v_accvgpr_read_b32 v216, a92
    v_accvgpr_read_b32 v217, a93
    v_accvgpr_read_b32 v218, a94
    v_accvgpr_read_b32 v219, a95
    v_accvgpr_read_b32 v220, a112
    v_accvgpr_read_b32 v221, a113
    v_accvgpr_read_b32 v222, a114
    v_accvgpr_read_b32 v223, a115
    v_pk_mul_f32 v[216:217], v[216:217], s[44:45]
    v_pk_mul_f32 v[218:219], v[218:219], s[44:45]
    v_pk_mul_f32 v[220:221], v[220:221], s[44:45]
    v_pk_mul_f32 v[222:223], v[222:223], s[44:45]
    v_cvt_pk_bf16_f32 v72, v216, v217
    v_cvt_pk_bf16_f32 v73, v218, v219
    v_cvt_pk_bf16_f32 v74, v220, v221
    v_cvt_pk_bf16_f32 v75, v222, v223
    v_accvgpr_read_b32 v224, a132
    v_accvgpr_read_b32 v225, a133
    v_accvgpr_read_b32 v226, a134
    v_accvgpr_read_b32 v227, a135
    v_accvgpr_read_b32 v228, a152
    v_accvgpr_read_b32 v229, a153
    v_accvgpr_read_b32 v230, a154
    v_accvgpr_read_b32 v231, a155
    v_pk_mul_f32 v[224:225], v[224:225], s[44:45]
    v_pk_mul_f32 v[226:227], v[226:227], s[44:45]
    v_pk_mul_f32 v[228:229], v[228:229], s[44:45]
    v_pk_mul_f32 v[230:231], v[230:231], s[44:45]
    v_cvt_pk_bf16_f32 v76, v224, v225
    v_cvt_pk_bf16_f32 v77, v226, v227
    v_cvt_pk_bf16_f32 v78, v228, v229
    v_cvt_pk_bf16_f32 v79, v230, v231
    v_accvgpr_read_b32 v216, a16
    v_accvgpr_read_b32 v217, a17
    v_accvgpr_read_b32 v218, a18
    v_accvgpr_read_b32 v219, a19
    v_accvgpr_read_b32 v220, a36
    v_accvgpr_read_b32 v221, a37
    v_accvgpr_read_b32 v222, a38
    v_accvgpr_read_b32 v223, a39
    v_pk_mul_f32 v[216:217], v[216:217], s[44:45]
    v_pk_mul_f32 v[218:219], v[218:219], s[44:45]
    v_pk_mul_f32 v[220:221], v[220:221], s[44:45]
    v_pk_mul_f32 v[222:223], v[222:223], s[44:45]
    v_cvt_pk_bf16_f32 v80, v216, v217
    v_cvt_pk_bf16_f32 v81, v218, v219
    v_cvt_pk_bf16_f32 v82, v220, v221
    v_cvt_pk_bf16_f32 v83, v222, v223
    v_accvgpr_read_b32 v224, a56
    v_accvgpr_read_b32 v225, a57
    v_accvgpr_read_b32 v226, a58
    v_accvgpr_read_b32 v227, a59
    v_accvgpr_read_b32 v228, a76
    v_accvgpr_read_b32 v229, a77
    v_accvgpr_read_b32 v230, a78
    v_accvgpr_read_b32 v231, a79
    v_pk_mul_f32 v[224:225], v[224:225], s[44:45]
    v_pk_mul_f32 v[226:227], v[226:227], s[44:45]
    v_pk_mul_f32 v[228:229], v[228:229], s[44:45]
    v_pk_mul_f32 v[230:231], v[230:231], s[44:45]
    v_cvt_pk_bf16_f32 v84, v224, v225
    v_cvt_pk_bf16_f32 v85, v226, v227
    v_cvt_pk_bf16_f32 v86, v228, v229
    v_cvt_pk_bf16_f32 v87, v230, v231
    v_accvgpr_read_b32 v216, a96
    v_accvgpr_read_b32 v217, a97
    v_accvgpr_read_b32 v218, a98
    v_accvgpr_read_b32 v219, a99
    v_accvgpr_read_b32 v220, a116
    v_accvgpr_read_b32 v221, a117
    v_accvgpr_read_b32 v222, a118
    v_accvgpr_read_b32 v223, a119
    v_pk_mul_f32 v[216:217], v[216:217], s[44:45]
    v_pk_mul_f32 v[218:219], v[218:219], s[44:45]
    v_pk_mul_f32 v[220:221], v[220:221], s[44:45]
    v_pk_mul_f32 v[222:223], v[222:223], s[44:45]
    v_cvt_pk_bf16_f32 v88, v216, v217
    v_cvt_pk_bf16_f32 v89, v218, v219
    v_cvt_pk_bf16_f32 v90, v220, v221
    v_cvt_pk_bf16_f32 v91, v222, v223
    v_accvgpr_read_b32 v224, a136
    v_accvgpr_read_b32 v225, a137
    v_accvgpr_read_b32 v226, a138
    v_accvgpr_read_b32 v227, a139
    v_accvgpr_read_b32 v228, a156
    v_accvgpr_read_b32 v229, a157
    v_accvgpr_read_b32 v230, a158
    v_accvgpr_read_b32 v231, a159
    v_pk_mul_f32 v[224:225], v[224:225], s[44:45]
    v_pk_mul_f32 v[226:227], v[226:227], s[44:45]
    v_pk_mul_f32 v[228:229], v[228:229], s[44:45]
    v_pk_mul_f32 v[230:231], v[230:231], s[44:45]
    v_cvt_pk_bf16_f32 v92, v224, v225
    v_cvt_pk_bf16_f32 v93, v226, v227
    v_cvt_pk_bf16_f32 v94, v228, v229
    v_cvt_pk_bf16_f32 v95, v230, v231
L1_a:
    s_and_b32 s57, s56, 1
    s_cmp_eq_u32 s57, 0
    s_cselect_b64 vcc, -1, 0
    s_waitcnt lgkmcnt(5)
    v_mfma_f32_16x16x32_bf16 v[96:99], a[160:163], v[16:19], 0
    ds_read_b128 a[184:187], v178 offset:4096
    v_mfma_f32_16x16x32_bf16 v[100:103], a[160:163], v[32:35], 0
    ds_read_b128 a[188:191], v179 offset:4096
    v_mfma_f32_16x16x32_bf16 v[104:107], a[160:163], v[48:51], 0
    v_mfma_f32_16x16x32_bf16 v[108:111], a[160:163], v[64:67], 0
    v_mfma_f32_16x16x32_bf16 v[112:115], a[160:163], v[80:83], 0
    s_waitcnt lgkmcnt(6)
    v_mfma_f32_16x16x32_bf16 v[96:99], a[164:167], v[20:23], v[96:99]
    v_mfma_f32_16x16x32_bf16 v[100:103], a[164:167], v[36:39], v[100:103]
    v_mfma_f32_16x16x32_bf16 v[104:107], a[164:167], v[52:55], v[104:107]
    v_mfma_f32_16x16x32_bf16 v[108:111], a[164:167], v[68:71], v[108:111]
    v_mfma_f32_16x16x32_bf16 v[112:115], a[164:167], v[84:87], v[112:115]
    s_waitcnt lgkmcnt(0)
    v_mfma_f32_16x16x32_bf16 v[96:99], a[168:171], v[24:27], v[96:99]
    v_mfma_f32_16x16x32_bf16 v[100:103], a[168:171], v[40:43], v[100:103]
    v_mfma_f32_16x16x32_bf16 v[104:107], a[168:171], v[56:59], v[104:107]
    v_mfma_f32_16x16x32_bf16 v[108:111], a[168:171], v[72:75], v[108:111]
    v_mfma_f32_16x16x32_bf16 v[112:115], a[168:171], v[88:91], v[112:115]
    v_mfma_f32_16x16x32_bf16 v[96:99], a[172:175], v[28:31], v[96:99]
    v_mfma_f32_16x16x32_bf16 v[100:103], a[172:175], v[44:47], v[100:103]
    v_mfma_f32_16x16x32_bf16 v[104:107], a[172:175], v[60:63], v[104:107]
    v_mfma_f32_16x16x32_bf16 v[108:111], a[172:175], v[76:79], v[108:111]
    v_mfma_f32_16x16x32_bf16 v[112:115], a[172:175], v[92:95], v[112:115]
    v_mfma_f32_16x16x32_bf16 v[116:119], a[176:179], v[16:19], 0
    s_nop 2
    v_exp_f32 v96, v96
    v_mfma_f32_16x16x32_bf16 v[120:123], a[176:179], v[32:35], 0
    v_exp_f32 v97, v97
    v_mfma_f32_16x16x32_bf16 v[124:127], a[176:179], v[48:51], 0
    v_exp_f32 v98, v98
    v_mfma_f32_16x16x32_bf16 v[128:131], a[176:179], v[64:67], 0
    v_exp_f32 v99, v99
    v_mfma_f32_16x16x32_bf16 v[132:135], a[176:179], v[80:83], 0
    v_mov_b32 v207, v96
    v_add_f32 v207, v207, v97
    v_mfma_f32_16x16x32_bf16 v[116:119], a[180:183], v[20:23], v[116:119]
    v_add_f32 v207, v207, v98
    v_add_f32 v207, v207, v99
    v_mfma_f32_16x16x32_bf16 v[120:123], a[180:183], v[36:39], v[120:123]
    v_cvt_pk_bf16_f32 v136, v96, v97
    v_cvt_pk_bf16_f32 v137, v98, v99
    v_mfma_f32_16x16x32_bf16 v[124:127], a[180:183], v[52:55], v[124:127]
    v_exp_f32 v100, v100
    v_mfma_f32_16x16x32_bf16 v[128:131], a[180:183], v[68:71], v[128:131]
    v_exp_f32 v101, v101
    v_mfma_f32_16x16x32_bf16 v[132:135], a[180:183], v[84:87], v[132:135]
    v_exp_f32 v102, v102
    v_mfma_f32_16x16x32_bf16 v[116:119], a[184:187], v[24:27], v[116:119]
    v_exp_f32 v103, v103
    v_mfma_f32_16x16x32_bf16 v[120:123], a[184:187], v[40:43], v[120:123]
    v_mov_b32 v208, v100
    v_add_f32 v208, v208, v101
    v_mfma_f32_16x16x32_bf16 v[124:127], a[184:187], v[56:59], v[124:127]
    v_add_f32 v208, v208, v102
    v_add_f32 v208, v208, v103
    v_mfma_f32_16x16x32_bf16 v[128:131], a[184:187], v[72:75], v[128:131]
    v_cvt_pk_bf16_f32 v140, v100, v101
    v_cvt_pk_bf16_f32 v141, v102, v103
    v_mfma_f32_16x16x32_bf16 v[132:135], a[184:187], v[88:91], v[132:135]
    v_exp_f32 v104, v104
    v_mfma_f32_16x16x32_bf16 v[116:119], a[188:191], v[28:31], v[116:119]
    v_exp_f32 v105, v105
    v_mfma_f32_16x16x32_bf16 v[120:123], a[188:191], v[44:47], v[120:123]
    v_exp_f32 v106, v106
    v_mfma_f32_16x16x32_bf16 v[124:127], a[188:191], v[60:63], v[124:127]
    v_exp_f32 v107, v107
    v_mfma_f32_16x16x32_bf16 v[128:131], a[188:191], v[76:79], v[128:131]
    v_mov_b32 v209, v104
    v_add_f32 v209, v209, v105
    v_mfma_f32_16x16x32_bf16 v[132:135], a[188:191], v[92:95], v[132:135]
    v_add_f32 v209, v209, v106
    v_add_f32 v209, v209, v107
    v_cvt_pk_bf16_f32 v144, v104, v105
    v_cvt_pk_bf16_f32 v145, v106, v107
    v_exp_f32 v108, v108
    v_exp_f32 v109, v109
    v_exp_f32 v110, v110
    v_exp_f32 v111, v111
    v_mov_b32 v210, v108
    v_add_f32 v210, v210, v109
    v_add_f32 v210, v210, v110
    v_add_f32 v210, v210, v111
    v_cvt_pk_bf16_f32 v148, v108, v109
    v_cvt_pk_bf16_f32 v149, v110, v111
    v_exp_f32 v112, v112
    v_exp_f32 v113, v113
    v_exp_f32 v114, v114
    v_exp_f32 v115, v115
    v_mov_b32 v211, v112
    v_add_f32 v211, v211, v113
    v_add_f32 v211, v211, v114
    v_add_f32 v211, v211, v115
    v_cvt_pk_bf16_f32 v152, v112, v113
    v_cvt_pk_bf16_f32 v153, v114, v115
    v_exp_f32 v116, v116
    v_exp_f32 v117, v117
    v_exp_f32 v118, v118
    v_exp_f32 v119, v119
    v_add_f32 v207, v207, v116
    v_add_f32 v207, v207, v117
    v_add_f32 v207, v207, v118
    v_add_f32 v207, v207, v119
    v_cvt_pk_bf16_f32 v138, v116, v117
    v_cvt_pk_bf16_f32 v139, v118, v119
    v_exp_f32 v120, v120
    s_waitcnt lgkmcnt(0)
    v_exp_f32 v121, v121
    s_waitcnt vmcnt(12)
    v_exp_f32 v122, v122
    s_barrier
    v_exp_f32 v123, v123
    ds_read_b128 a[160:163], v176 offset:16384
    v_add_f32 v208, v208, v120
    v_add_f32 v208, v208, v121
    ds_read_b128 a[164:167], v177 offset:16384
    v_add_f32 v208, v208, v122
    v_add_f32 v208, v208, v123
    ds_read_b128 a[168:171], v178 offset:16384
    v_cvt_pk_bf16_f32 v142, v120, v121
    v_cvt_pk_bf16_f32 v143, v122, v123
    v_exp_f32 v124, v124
    v_exp_f32 v125, v125
    v_exp_f32 v126, v126
    v_exp_f32 v127, v127
    ds_read_b128 a[172:175], v179 offset:16384
    v_add_f32 v209, v209, v124
    v_add_f32 v209, v209, v125
    ds_read_b128 a[176:179], v176 offset:20480
    v_add_f32 v209, v209, v126
    v_add_f32 v209, v209, v127
    ds_read_b128 a[180:183], v177 offset:20480
    v_cvt_pk_bf16_f32 v146, v124, v125
    v_cvt_pk_bf16_f32 v147, v126, v127
    v_exp_f32 v128, v128
    v_exp_f32 v129, v129
    v_exp_f32 v130, v130
    s_cbranch_vccz 1
    s_waitcnt vmcnt(4)
    s_mov_b32 m0, s41
    v_exp_f32 v131, v131
    s_waitcnt lgkmcnt(5)
    v_mfma_f32_16x16x32_bf16 v[96:99], a[160:163], v[16:19], 0
    ds_read_b128 a[184:187], v178 offset:20480
    v_add_f32 v210, v210, v128
    v_add_f32 v210, v210, v129
    v_mfma_f32_16x16x32_bf16 v[100:103], a[160:163], v[32:35], 0
    ds_read_b128 a[188:191], v179 offset:20480
    v_add_f32 v210, v210, v130
    v_add_f32 v210, v210, v131
    v_mfma_f32_16x16x32_bf16 v[104:107], a[160:163], v[48:51], 0
    buffer_load_dwordx4 v194, s[16:19], s34 offen nt lds
    v_cvt_pk_bf16_f32 v150, v128, v129
    v_cvt_pk_bf16_f32 v151, v130, v131
    v_mfma_f32_16x16x32_bf16 v[108:111], a[160:163], v[64:67], 0
    v_exp_f32 v132, v132
    v_mfma_f32_16x16x32_bf16 v[112:115], a[160:163], v[80:83], 0
    v_exp_f32 v133, v133
    s_waitcnt lgkmcnt(6)
    v_mfma_f32_16x16x32_bf16 v[96:99], a[164:167], v[20:23], v[96:99]
    v_exp_f32 v134, v134
    v_mfma_f32_16x16x32_bf16 v[100:103], a[164:167], v[36:39], v[100:103]
    v_exp_f32 v135, v135
    v_mfma_f32_16x16x32_bf16 v[104:107], a[164:167], v[52:55], v[104:107]
    buffer_load_dwordx4 v195, s[16:19], s34 offen offset:1024 nt lds
    v_add_f32 v211, v211, v132
    v_add_f32 v211, v211, v133
    v_mfma_f32_16x16x32_bf16 v[108:111], a[164:167], v[68:71], v[108:111]
    buffer_load_dwordx4 v196, s[16:19], s34 offen offset:2048 nt lds
    v_add_f32 v211, v211, v134
    v_add_f32 v211, v211, v135
    v_mfma_f32_16x16x32_bf16 v[112:115], a[164:167], v[84:87], v[112:115]
    buffer_load_dwordx4 v197, s[16:19], s34 offen offset:3072 nt lds
    s_add_u32 m0, s42, 49152
    v_cvt_pk_bf16_f32 v154, v132, v133
    v_cvt_pk_bf16_f32 v155, v134, v135
    s_waitcnt lgkmcnt(0)
    v_mfma_f32_16x16x32_bf16 v[96:99], a[168:171], v[24:27], v[96:99]
    buffer_load_dwordx4 v198, s[20:23], s35 offen nt lds
    v_mfma_f32_16x16x32_bf16 v[100:103], a[168:171], v[40:43], v[100:103]
    buffer_load_dwordx4 v199, s[20:23], s35 offen offset:1024 nt lds
    v_mfma_f32_16x16x32_bf16 v[104:107], a[168:171], v[56:59], v[104:107]
    buffer_load_dwordx4 v198, s[20:23], s35 offen offset:2048 nt lds
    v_mfma_f32_16x16x32_bf16 v[108:111], a[168:171], v[72:75], v[108:111]
    buffer_load_dwordx4 v199, s[20:23], s35 offen offset:3072 nt lds
    v_mfma_f32_16x16x32_bf16 v[112:115], a[168:171], v[88:91], v[112:115]
    ds_read_b64_tr_b16 a[192:193], v180 offset:0
    v_mfma_f32_16x16x32_bf16 v[96:99], a[172:175], v[28:31], v[96:99]
    ds_read_b64_tr_b16 a[194:195], v180 offset:4096
    v_mfma_f32_16x16x32_bf16 v[100:103], a[172:175], v[44:47], v[100:103]
    ds_read_b64_tr_b16 a[196:197], v181 offset:0
    v_mfma_f32_16x16x32_bf16 v[104:107], a[172:175], v[60:63], v[104:107]
    ds_read_b64_tr_b16 a[198:199], v181 offset:4096
    v_mfma_f32_16x16x32_bf16 v[108:111], a[172:175], v[76:79], v[108:111]
    ds_read_b64_tr_b16 a[200:201], v182 offset:0
    v_mfma_f32_16x16x32_bf16 v[112:115], a[172:175], v[92:95], v[112:115]
    ds_read_b64_tr_b16 a[202:203], v182 offset:4096
    v_mfma_f32_16x16x32_bf16 v[116:119], a[176:179], v[16:19], 0
    s_add_u32 s34, s34, 8192
    v_exp_f32 v96, v96
    v_mfma_f32_16x16x32_bf16 v[120:123], a[176:179], v[32:35], 0
    s_add_u32 s35, s35, 8192
    v_exp_f32 v97, v97
    v_mfma_f32_16x16x32_bf16 v[124:127], a[176:179], v[48:51], 0
    v_exp_f32 v98, v98
    v_mfma_f32_16x16x32_bf16 v[128:131], a[176:179], v[64:67], 0
    v_exp_f32 v99, v99
    v_mfma_f32_16x16x32_bf16 v[132:135], a[176:179], v[80:83], 0
    ds_read_b64_tr_b16 a[204:205], v183 offset:0
    v_add_f32 v207, v207, v96
    v_add_f32 v207, v207, v97
    v_mfma_f32_16x16x32_bf16 v[116:119], a[180:183], v[20:23], v[116:119]
    ds_read_b64_tr_b16 a[206:207], v183 offset:4096
    v_add_f32 v207, v207, v98
    v_add_f32 v207, v207, v99
    v_mfma_f32_16x16x32_bf16 v[120:123], a[180:183], v[36:39], v[120:123]
    ds_read_b64_tr_b16 a[208:209], v184 offset:0
    v_cvt_pk_bf16_f32 v156, v96, v97
    v_cvt_pk_bf16_f32 v157, v98, v99
    v_mfma_f32_16x16x32_bf16 v[124:127], a[180:183], v[52:55], v[124:127]
    v_exp_f32 v100, v100
    v_mfma_f32_16x16x32_bf16 v[128:131], a[180:183], v[68:71], v[128:131]
    v_exp_f32 v101, v101
    v_mfma_f32_16x16x32_bf16 v[132:135], a[180:183], v[84:87], v[132:135]
    v_exp_f32 v102, v102
    v_mfma_f32_16x16x32_bf16 v[116:119], a[184:187], v[24:27], v[116:119]
    v_exp_f32 v103, v103
    v_mfma_f32_16x16x32_bf16 v[120:123], a[184:187], v[40:43], v[120:123]
    ds_read_b64_tr_b16 a[210:211], v184 offset:4096
    v_add_f32 v208, v208, v100
    v_add_f32 v208, v208, v101
    v_mfma_f32_16x16x32_bf16 v[124:127], a[184:187], v[56:59], v[124:127]
    ds_read_b64_tr_b16 a[212:213], v185 offset:0
    v_add_f32 v208, v208, v102
    v_add_f32 v208, v208, v103
    v_mfma_f32_16x16x32_bf16 v[128:131], a[184:187], v[72:75], v[128:131]
    ds_read_b64_tr_b16 a[214:215], v185 offset:4096
    v_cvt_pk_bf16_f32 v160, v100, v101
    v_cvt_pk_bf16_f32 v161, v102, v103
    v_mfma_f32_16x16x32_bf16 v[132:135], a[184:187], v[88:91], v[132:135]
    v_exp_f32 v104, v104
    v_mfma_f32_16x16x32_bf16 v[116:119], a[188:191], v[28:31], v[116:119]
    v_exp_f32 v105, v105
    v_mfma_f32_16x16x32_bf16 v[120:123], a[188:191], v[44:47], v[120:123]
    v_exp_f32 v106, v106
    v_mfma_f32_16x16x32_bf16 v[124:127], a[188:191], v[60:63], v[124:127]
    v_exp_f32 v107, v107
    v_mfma_f32_16x16x32_bf16 v[128:131], a[188:191], v[76:79], v[128:131]
    ds_read_b64_tr_b16 a[216:217], v186 offset:0
    v_add_f32 v209, v209, v104
    v_add_f32 v209, v209, v105
    v_mfma_f32_16x16x32_bf16 v[132:135], a[188:191], v[92:95], v[132:135]
    ds_read_b64_tr_b16 a[218:219], v186 offset:4096
    v_add_f32 v209, v209, v106
    v_add_f32 v209, v209, v107
    s_waitcnt lgkmcnt(2)
    v_mfma_f32_16x16x32_bf16 a[0:3], a[192:195], v[136:139], 0
    ds_read_b64_tr_b16 a[220:221], v187 offset:0
    v_cvt_pk_bf16_f32 v164, v104, v105
    v_cvt_pk_bf16_f32 v165, v106, v107
    v_mfma_f32_16x16x32_bf16 a[4:7], a[192:195], v[140:143], 0
    v_exp_f32 v108, v108
    v_mfma_f32_16x16x32_bf16 a[8:11], a[192:195], v[144:147], 0
    v_exp_f32 v109, v109
    v_mfma_f32_16x16x32_bf16 a[12:15], a[192:195], v[148:151], 0
    v_exp_f32 v110, v110
    v_mfma_f32_16x16x32_bf16 a[16:19], a[192:195], v[152:155], 0
    v_exp_f32 v111, v111
    v_mfma_f32_16x16x32_bf16 a[20:23], a[196:199], v[136:139], 0
    ds_read_b64_tr_b16 a[222:223], v187 offset:4096
    v_add_f32 v210, v210, v108
    v_add_f32 v210, v210, v109
    v_mfma_f32_16x16x32_bf16 a[24:27], a[196:199], v[140:143], 0
    v_add_f32 v210, v210, v110
    v_add_f32 v210, v210, v111
    v_mfma_f32_16x16x32_bf16 a[28:31], a[196:199], v[144:147], 0
    v_cvt_pk_bf16_f32 v168, v108, v109
    v_cvt_pk_bf16_f32 v169, v110, v111
    v_mfma_f32_16x16x32_bf16 a[32:35], a[196:199], v[148:151], 0
    v_exp_f32 v112, v112
    v_mfma_f32_16x16x32_bf16 a[36:39], a[196:199], v[152:155], 0
    v_exp_f32 v113, v113
    v_mfma_f32_16x16x32_bf16 a[40:43], a[200:203], v[136:139], 0
    v_exp_f32 v114, v114
    v_mfma_f32_16x16x32_bf16 a[44:47], a[200:203], v[140:143], 0
    v_exp_f32 v115, v115
    v_mfma_f32_16x16x32_bf16 a[48:51], a[200:203], v[144:147], 0
    v_add_f32 v211, v211, v112
    v_add_f32 v211, v211, v113
    v_mfma_f32_16x16x32_bf16 a[52:55], a[200:203], v[148:151], 0
    v_add_f32 v211, v211, v114
    v_add_f32 v211, v211, v115
    v_mfma_f32_16x16x32_bf16 a[56:59], a[200:203], v[152:155], 0
    v_cvt_pk_bf16_f32 v172, v112, v113
    v_cvt_pk_bf16_f32 v173, v114, v115
    v_mfma_f32_16x16x32_bf16 a[60:63], a[204:207], v[136:139], 0
    v_exp_f32 v116, v116
    v_mfma_f32_16x16x32_bf16 a[64:67], a[204:207], v[140:143], 0
    v_exp_f32 v117, v117
    v_mfma_f32_16x16x32_bf16 a[68:71], a[204:207], v[144:147], 0
    v_exp_f32 v118, v118
    v_mfma_f32_16x16x32_bf16 a[72:75], a[204:207], v[148:151], 0
    v_exp_f32 v119, v119
    v_mfma_f32_16x16x32_bf16 a[76:79], a[204:207], v[152:155], 0
    v_add_f32 v207, v207, v116
    v_add_f32 v207, v207, v117
    v_mfma_f32_16x16x32_bf16 a[80:83], a[208:211], v[136:139], 0
    v_add_f32 v207, v207, v118
    v_add_f32 v207, v207, v119
    v_mfma_f32_16x16x32_bf16 a[84:87], a[208:211], v[140:143], 0
    v_cvt_pk_bf16_f32 v158, v116, v117
    v_cvt_pk_bf16_f32 v159, v118, v119
    v_mfma_f32_16x16x32_bf16 a[88:91], a[208:211], v[144:147], 0
    v_exp_f32 v120, v120
    v_mfma_f32_16x16x32_bf16 a[92:95], a[208:211], v[148:151], 0
    s_waitcnt lgkmcnt(0)
    v_exp_f32 v121, v121
    v_mfma_f32_16x16x32_bf16 a[96:99], a[208:211], v[152:155], 0
    s_waitcnt vmcnt(12)
    v_exp_f32 v122, v122
    v_mfma_f32_16x16x32_bf16 a[100:103], a[212:215], v[136:139], 0
    s_barrier
    v_exp_f32 v123, v123
    v_mfma_f32_16x16x32_bf16 a[104:107], a[212:215], v[140:143], 0
    ds_read_b128 a[160:163], v176 offset:32768
    v_add_f32 v208, v208, v120
    v_add_f32 v208, v208, v121
    v_mfma_f32_16x16x32_bf16 a[108:111], a[212:215], v[144:147], 0
    ds_read_b128 a[164:167], v177 offset:32768
    v_add_f32 v208, v208, v122
    v_add_f32 v208, v208, v123
    v_mfma_f32_16x16x32_bf16 a[112:115], a[212:215], v[148:151], 0
    ds_read_b128 a[168:171], v178 offset:32768
    v_cvt_pk_bf16_f32 v162, v120, v121
    v_cvt_pk_bf16_f32 v163, v122, v123
    v_mfma_f32_16x16x32_bf16 a[116:119], a[212:215], v[152:155], 0
    v_exp_f32 v124, v124
    v_mfma_f32_16x16x32_bf16 a[120:123], a[216:219], v[136:139], 0
    v_exp_f32 v125, v125
    v_mfma_f32_16x16x32_bf16 a[124:127], a[216:219], v[140:143], 0
    v_exp_f32 v126, v126
    v_mfma_f32_16x16x32_bf16 a[128:131], a[216:219], v[144:147], 0
    v_exp_f32 v127, v127
    v_mfma_f32_16x16x32_bf16 a[132:135], a[216:219], v[148:151], 0
    ds_read_b128 a[172:175], v179 offset:32768
    v_add_f32 v209, v209, v124
    v_add_f32 v209, v209, v125
    v_mfma_f32_16x16x32_bf16 a[136:139], a[216:219], v[152:155], 0
    ds_read_b128 a[176:179], v176 offset:36864
    v_add_f32 v209, v209, v126
    v_add_f32 v209, v209, v127
    v_mfma_f32_16x16x32_bf16 a[140:143], a[220:223], v[136:139], 0
    ds_read_b128 a[180:183], v177 offset:36864
    v_cvt_pk_bf16_f32 v166, v124, v125
    v_cvt_pk_bf16_f32 v167, v126, v127
    v_mfma_f32_16x16x32_bf16 a[144:147], a[220:223], v[140:143], 0
    v_exp_f32 v128, v128
    v_mfma_f32_16x16x32_bf16 a[148:151], a[220:223], v[144:147], 0
    v_exp_f32 v129, v129
    v_mfma_f32_16x16x32_bf16 a[152:155], a[220:223], v[148:151], 0
    v_exp_f32 v130, v130
    v_mfma_f32_16x16x32_bf16 a[156:159], a[220:223], v[152:155], 0
    s_cbranch_vccz 1
    s_waitcnt vmcnt(4)
    s_add_u32 m0, s41, 16384
    v_exp_f32 v131, v131
    s_mov_b32 s40, 7
.p2align 6
L1_aloop:
    s_waitcnt lgkmcnt(2)
    v_mfma_f32_16x16x32_bf16 v[96:99], a[160:163], v[16:19], 0
    ds_read_b128 a[184:187], v178 offset:36864
    v_add_f32 v210, v210, v128
    v_add_f32 v210, v210, v129
    v_mfma_f32_16x16x32_bf16 v[100:103], a[160:163], v[32:35], 0
    ds_read_b128 a[188:191], v179 offset:36864
    v_add_f32 v210, v210, v130
    v_add_f32 v210, v210, v131
    v_mfma_f32_16x16x32_bf16 v[104:107], a[160:163], v[48:51], 0
    buffer_load_dwordx4 v194, s[16:19], s34 offen nt lds
    v_cvt_pk_bf16_f32 v170, v128, v129
    v_cvt_pk_bf16_f32 v171, v130, v131
    v_mfma_f32_16x16x32_bf16 v[108:111], a[160:163], v[64:67], 0
    v_exp_f32 v132, v132
    v_mfma_f32_16x16x32_bf16 v[112:115], a[160:163], v[80:83], 0
    v_exp_f32 v133, v133
    v_mfma_f32_16x16x32_bf16 v[96:99], a[164:167], v[20:23], v[96:99]
    v_exp_f32 v134, v134
    v_mfma_f32_16x16x32_bf16 v[100:103], a[164:167], v[36:39], v[100:103]
    v_exp_f32 v135, v135
    v_mfma_f32_16x16x32_bf16 v[104:107], a[164:167], v[52:55], v[104:107]
    buffer_load_dwordx4 v195, s[16:19], s34 offen offset:1024 nt lds
    v_add_f32 v211, v211, v132
    v_add_f32 v211, v211, v133
    v_mfma_f32_16x16x32_bf16 v[108:111], a[164:167], v[68:71], v[108:111]
    buffer_load_dwordx4 v196, s[16:19], s34 offen offset:2048 nt lds
    v_add_f32 v211, v211, v134
    v_add_f32 v211, v211, v135
    v_mfma_f32_16x16x32_bf16 v[112:115], a[164:167], v[84:87], v[112:115]
    buffer_load_dwordx4 v197, s[16:19], s34 offen offset:3072 nt lds
    s_mov_b32 m0, s42
    v_cvt_pk_bf16_f32 v174, v132, v133
    v_cvt_pk_bf16_f32 v175, v134, v135
    v_mfma_f32_16x16x32_bf16 v[96:99], a[168:171], v[24:27], v[96:99]
    buffer_load_dwordx4 v198, s[20:23], s35 offen nt lds
    v_mfma_f32_16x16x32_bf16 v[100:103], a[168:171], v[40:43], v[100:103]
    buffer_load_dwordx4 v199, s[20:23], s35 offen offset:1024 nt lds
    v_mfma_f32_16x16x32_bf16 v[104:107], a[168:171], v[56:59], v[104:107]
    buffer_load_dwordx4 v198, s[20:23], s35 offen offset:2048 nt lds
    v_mfma_f32_16x16x32_bf16 v[108:111], a[168:171], v[72:75], v[108:111]
    buffer_load_dwordx4 v199, s[20:23], s35 offen offset:3072 nt lds
    v_mfma_f32_16x16x32_bf16 v[112:115], a[168:171], v[88:91], v[112:115]
    ds_read_b64_tr_b16 a[192:193], v180 offset:16384
    v_mfma_f32_16x16x32_bf16 v[96:99], a[172:175], v[28:31], v[96:99]
    ds_read_b64_tr_b16 a[194:195], v180 offset:20480
    v_mfma_f32_16x16x32_bf16 v[100:103], a[172:175], v[44:47], v[100:103]
    ds_read_b64_tr_b16 a[196:197], v181 offset:16384
    v_mfma_f32_16x16x32_bf16 v[104:107], a[172:175], v[60:63], v[104:107]
    ds_read_b64_tr_b16 a[198:199], v181 offset:20480
    v_mfma_f32_16x16x32_bf16 v[108:111], a[172:175], v[76:79], v[108:111]
    ds_read_b64_tr_b16 a[200:201], v182 offset:16384
    v_mfma_f32_16x16x32_bf16 v[112:115], a[172:175], v[92:95], v[112:115]
    ds_read_b64_tr_b16 a[202:203], v182 offset:20480
    s_waitcnt lgkmcnt(6)
    v_mfma_f32_16x16x32_bf16 v[116:119], a[176:179], v[16:19], 0
    s_add_u32 s34, s34, 8192
    v_exp_f32 v96, v96
    v_mfma_f32_16x16x32_bf16 v[120:123], a[176:179], v[32:35], 0
    s_add_u32 s35, s35, 8192
    v_exp_f32 v97, v97
    v_mfma_f32_16x16x32_bf16 v[124:127], a[176:179], v[48:51], 0
    v_exp_f32 v98, v98
    v_mfma_f32_16x16x32_bf16 v[128:131], a[176:179], v[64:67], 0
    v_exp_f32 v99, v99
    v_mfma_f32_16x16x32_bf16 v[132:135], a[176:179], v[80:83], 0
    ds_read_b64_tr_b16 a[204:205], v183 offset:16384
    v_add_f32 v207, v207, v96
    v_add_f32 v207, v207, v97
    v_mfma_f32_16x16x32_bf16 v[116:119], a[180:183], v[20:23], v[116:119]
    ds_read_b64_tr_b16 a[206:207], v183 offset:20480
    v_add_f32 v207, v207, v98
    v_add_f32 v207, v207, v99
    v_mfma_f32_16x16x32_bf16 v[120:123], a[180:183], v[36:39], v[120:123]
    ds_read_b64_tr_b16 a[208:209], v184 offset:16384
    v_cvt_pk_bf16_f32 v136, v96, v97
    v_cvt_pk_bf16_f32 v137, v98, v99
    v_mfma_f32_16x16x32_bf16 v[124:127], a[180:183], v[52:55], v[124:127]
    v_exp_f32 v100, v100
    v_mfma_f32_16x16x32_bf16 v[128:131], a[180:183], v[68:71], v[128:131]
    v_exp_f32 v101, v101
    v_mfma_f32_16x16x32_bf16 v[132:135], a[180:183], v[84:87], v[132:135]
    v_exp_f32 v102, v102
    v_mfma_f32_16x16x32_bf16 v[116:119], a[184:187], v[24:27], v[116:119]
    v_exp_f32 v103, v103
    v_mfma_f32_16x16x32_bf16 v[120:123], a[184:187], v[40:43], v[120:123]
    ds_read_b64_tr_b16 a[210:211], v184 offset:20480
    v_add_f32 v208, v208, v100
    v_add_f32 v208, v208, v101
    v_mfma_f32_16x16x32_bf16 v[124:127], a[184:187], v[56:59], v[124:127]
    ds_read_b64_tr_b16 a[212:213], v185 offset:16384
    v_add_f32 v208, v208, v102
    v_add_f32 v208, v208, v103
    v_mfma_f32_16x16x32_bf16 v[128:131], a[184:187], v[72:75], v[128:131]
    ds_read_b64_tr_b16 a[214:215], v185 offset:20480
    v_cvt_pk_bf16_f32 v140, v100, v101
    v_cvt_pk_bf16_f32 v141, v102, v103
    v_mfma_f32_16x16x32_bf16 v[132:135], a[184:187], v[88:91], v[132:135]
    v_exp_f32 v104, v104
    v_mfma_f32_16x16x32_bf16 v[116:119], a[188:191], v[28:31], v[116:119]
    v_exp_f32 v105, v105
    v_mfma_f32_16x16x32_bf16 v[120:123], a[188:191], v[44:47], v[120:123]
    v_exp_f32 v106, v106
    v_mfma_f32_16x16x32_bf16 v[124:127], a[188:191], v[60:63], v[124:127]
    v_exp_f32 v107, v107
    v_mfma_f32_16x16x32_bf16 v[128:131], a[188:191], v[76:79], v[128:131]
    ds_read_b64_tr_b16 a[216:217], v186 offset:16384
    v_add_f32 v209, v209, v104
    v_add_f32 v209, v209, v105
    v_mfma_f32_16x16x32_bf16 v[132:135], a[188:191], v[92:95], v[132:135]
    ds_read_b64_tr_b16 a[218:219], v186 offset:20480
    v_add_f32 v209, v209, v106
    v_add_f32 v209, v209, v107
    s_waitcnt lgkmcnt(2)
    v_mfma_f32_16x16x32_bf16 a[0:3], a[192:195], v[156:159], a[0:3]
    ds_read_b64_tr_b16 a[220:221], v187 offset:16384
    v_cvt_pk_bf16_f32 v144, v104, v105
    v_cvt_pk_bf16_f32 v145, v106, v107
    v_mfma_f32_16x16x32_bf16 a[4:7], a[192:195], v[160:163], a[4:7]
    v_exp_f32 v108, v108
    v_mfma_f32_16x16x32_bf16 a[8:11], a[192:195], v[164:167], a[8:11]
    v_exp_f32 v109, v109
    v_mfma_f32_16x16x32_bf16 a[12:15], a[192:195], v[168:171], a[12:15]
    v_exp_f32 v110, v110
    v_mfma_f32_16x16x32_bf16 a[16:19], a[192:195], v[172:175], a[16:19]
    v_exp_f32 v111, v111
    v_mfma_f32_16x16x32_bf16 a[20:23], a[196:199], v[156:159], a[20:23]
    ds_read_b64_tr_b16 a[222:223], v187 offset:20480
    v_add_f32 v210, v210, v108
    v_add_f32 v210, v210, v109
    v_mfma_f32_16x16x32_bf16 a[24:27], a[196:199], v[160:163], a[24:27]
    v_add_f32 v210, v210, v110
    v_add_f32 v210, v210, v111
    v_mfma_f32_16x16x32_bf16 a[28:31], a[196:199], v[164:167], a[28:31]
    v_cvt_pk_bf16_f32 v148, v108, v109
    v_cvt_pk_bf16_f32 v149, v110, v111
    v_mfma_f32_16x16x32_bf16 a[32:35], a[196:199], v[168:171], a[32:35]
    v_exp_f32 v112, v112
    v_mfma_f32_16x16x32_bf16 a[36:39], a[196:199], v[172:175], a[36:39]
    v_exp_f32 v113, v113
    v_mfma_f32_16x16x32_bf16 a[40:43], a[200:203], v[156:159], a[40:43]
    v_exp_f32 v114, v114
    v_mfma_f32_16x16x32_bf16 a[44:47], a[200:203], v[160:163], a[44:47]
    v_exp_f32 v115, v115
    v_mfma_f32_16x16x32_bf16 a[48:51], a[200:203], v[164:167], a[48:51]
    v_add_f32 v211, v211, v112
    v_add_f32 v211, v211, v113
    v_mfma_f32_16x16x32_bf16 a[52:55], a[200:203], v[168:171], a[52:55]
    v_add_f32 v211, v211, v114
    v_add_f32 v211, v211, v115
    v_mfma_f32_16x16x32_bf16 a[56:59], a[200:203], v[172:175], a[56:59]
    v_cvt_pk_bf16_f32 v152, v112, v113
    v_cvt_pk_bf16_f32 v153, v114, v115
    v_mfma_f32_16x16x32_bf16 a[60:63], a[204:207], v[156:159], a[60:63]
    v_exp_f32 v116, v116
    v_mfma_f32_16x16x32_bf16 a[64:67], a[204:207], v[160:163], a[64:67]
    v_exp_f32 v117, v117
    v_mfma_f32_16x16x32_bf16 a[68:71], a[204:207], v[164:167], a[68:71]
    v_exp_f32 v118, v118
    v_mfma_f32_16x16x32_bf16 a[72:75], a[204:207], v[168:171], a[72:75]
    v_exp_f32 v119, v119
    v_mfma_f32_16x16x32_bf16 a[76:79], a[204:207], v[172:175], a[76:79]
    v_add_f32 v207, v207, v116
    v_add_f32 v207, v207, v117
    v_mfma_f32_16x16x32_bf16 a[80:83], a[208:211], v[156:159], a[80:83]
    v_add_f32 v207, v207, v118
    v_add_f32 v207, v207, v119
    v_mfma_f32_16x16x32_bf16 a[84:87], a[208:211], v[160:163], a[84:87]
    v_cvt_pk_bf16_f32 v138, v116, v117
    v_cvt_pk_bf16_f32 v139, v118, v119
    v_mfma_f32_16x16x32_bf16 a[88:91], a[208:211], v[164:167], a[88:91]
    v_exp_f32 v120, v120
    v_mfma_f32_16x16x32_bf16 a[92:95], a[208:211], v[168:171], a[92:95]
    s_waitcnt lgkmcnt(0)
    v_exp_f32 v121, v121
    v_mfma_f32_16x16x32_bf16 a[96:99], a[208:211], v[172:175], a[96:99]
    s_waitcnt vmcnt(16)
    v_exp_f32 v122, v122
    v_mfma_f32_16x16x32_bf16 a[100:103], a[212:215], v[156:159], a[100:103]
    s_barrier
    v_exp_f32 v123, v123
    v_mfma_f32_16x16x32_bf16 a[104:107], a[212:215], v[160:163], a[104:107]
    ds_read_b128 a[160:163], v176 offset:49152
    v_add_f32 v208, v208, v120
    v_add_f32 v208, v208, v121
    v_mfma_f32_16x16x32_bf16 a[108:111], a[212:215], v[164:167], a[108:111]
    ds_read_b128 a[164:167], v177 offset:49152
    v_add_f32 v208, v208, v122
    v_add_f32 v208, v208, v123
    v_mfma_f32_16x16x32_bf16 a[112:115], a[212:215], v[168:171], a[112:115]
    ds_read_b128 a[168:171], v178 offset:49152
    v_cvt_pk_bf16_f32 v142, v120, v121
    v_cvt_pk_bf16_f32 v143, v122, v123
    v_mfma_f32_16x16x32_bf16 a[116:119], a[212:215], v[172:175], a[116:119]
    v_exp_f32 v124, v124
    v_mfma_f32_16x16x32_bf16 a[120:123], a[216:219], v[156:159], a[120:123]
    v_exp_f32 v125, v125
    v_mfma_f32_16x16x32_bf16 a[124:127], a[216:219], v[160:163], a[124:127]
    v_exp_f32 v126, v126
    v_mfma_f32_16x16x32_bf16 a[128:131], a[216:219], v[164:167], a[128:131]
    v_exp_f32 v127, v127
    v_mfma_f32_16x16x32_bf16 a[132:135], a[216:219], v[168:171], a[132:135]
    ds_read_b128 a[172:175], v179 offset:49152
    v_add_f32 v209, v209, v124
    v_add_f32 v209, v209, v125
    v_mfma_f32_16x16x32_bf16 a[136:139], a[216:219], v[172:175], a[136:139]
    ds_read_b128 a[176:179], v176 offset:53248
    v_add_f32 v209, v209, v126
    v_add_f32 v209, v209, v127
    v_mfma_f32_16x16x32_bf16 a[140:143], a[220:223], v[156:159], a[140:143]
    ds_read_b128 a[180:183], v177 offset:53248
    v_cvt_pk_bf16_f32 v146, v124, v125
    v_cvt_pk_bf16_f32 v147, v126, v127
    v_mfma_f32_16x16x32_bf16 a[144:147], a[220:223], v[160:163], a[144:147]
    v_exp_f32 v128, v128
    v_mfma_f32_16x16x32_bf16 a[148:151], a[220:223], v[164:167], a[148:151]
    v_exp_f32 v129, v129
    v_mfma_f32_16x16x32_bf16 a[152:155], a[220:223], v[168:171], a[152:155]
    v_exp_f32 v130, v130
    v_mfma_f32_16x16x32_bf16 a[156:159], a[220:223], v[172:175], a[156:159]
    s_cbranch_vccz 1
    s_waitcnt vmcnt(4)
    s_add_u32 m0, s41, 32768
    v_exp_f32 v131, v131
    s_waitcnt lgkmcnt(2)
    v_mfma_f32_16x16x32_bf16 v[96:99], a[160:163], v[16:19], 0
    ds_read_b128 a[184:187], v178 offset:53248
    v_add_f32 v210, v210, v128
    v_add_f32 v210, v210, v129
    v_mfma_f32_16x16x32_bf16 v[100:103], a[160:163], v[32:35], 0
    ds_read_b128 a[188:191], v179 offset:53248
    v_add_f32 v210, v210, v130
    v_add_f32 v210, v210, v131
    v_mfma_f32_16x16x32_bf16 v[104:107], a[160:163], v[48:51], 0
    buffer_load_dwordx4 v194, s[16:19], s34 offen nt lds
    v_cvt_pk_bf16_f32 v150, v128, v129
    v_cvt_pk_bf16_f32 v151, v130, v131
    v_mfma_f32_16x16x32_bf16 v[108:111], a[160:163], v[64:67], 0
    v_exp_f32 v132, v132
    v_mfma_f32_16x16x32_bf16 v[112:115], a[160:163], v[80:83], 0
    v_exp_f32 v133, v133
    v_mfma_f32_16x16x32_bf16 v[96:99], a[164:167], v[20:23], v[96:99]
    v_exp_f32 v134, v134
    v_mfma_f32_16x16x32_bf16 v[100:103], a[164:167], v[36:39], v[100:103]
    v_exp_f32 v135, v135
    v_mfma_f32_16x16x32_bf16 v[104:107], a[164:167], v[52:55], v[104:107]
    buffer_load_dwordx4 v195, s[16:19], s34 offen offset:1024 nt lds
    v_add_f32 v211, v211, v132
    v_add_f32 v211, v211, v133
    v_mfma_f32_16x16x32_bf16 v[108:111], a[164:167], v[68:71], v[108:111]
    buffer_load_dwordx4 v196, s[16:19], s34 offen offset:2048 nt lds
    v_add_f32 v211, v211, v134
    v_add_f32 v211, v211, v135
    v_mfma_f32_16x16x32_bf16 v[112:115], a[164:167], v[84:87], v[112:115]
    buffer_load_dwordx4 v197, s[16:19], s34 offen offset:3072 nt lds
    s_add_u32 m0, s42, 16384
    v_cvt_pk_bf16_f32 v154, v132, v133
    v_cvt_pk_bf16_f32 v155, v134, v135
    v_mfma_f32_16x16x32_bf16 v[96:99], a[168:171], v[24:27], v[96:99]
    buffer_load_dwordx4 v198, s[20:23], s35 offen nt lds
    v_mfma_f32_16x16x32_bf16 v[100:103], a[168:171], v[40:43], v[100:103]
    buffer_load_dwordx4 v199, s[20:23], s35 offen offset:1024 nt lds
    v_mfma_f32_16x16x32_bf16 v[104:107], a[168:171], v[56:59], v[104:107]
    buffer_load_dwordx4 v198, s[20:23], s35 offen offset:2048 nt lds
    v_mfma_f32_16x16x32_bf16 v[108:111], a[168:171], v[72:75], v[108:111]
    buffer_load_dwordx4 v199, s[20:23], s35 offen offset:3072 nt lds
    v_mfma_f32_16x16x32_bf16 v[112:115], a[168:171], v[88:91], v[112:115]
    ds_read_b64_tr_b16 a[192:193], v180 offset:32768
    v_mfma_f32_16x16x32_bf16 v[96:99], a[172:175], v[28:31], v[96:99]
    ds_read_b64_tr_b16 a[194:195], v180 offset:36864
    v_mfma_f32_16x16x32_bf16 v[100:103], a[172:175], v[44:47], v[100:103]
    ds_read_b64_tr_b16 a[196:197], v181 offset:32768
    v_mfma_f32_16x16x32_bf16 v[104:107], a[172:175], v[60:63], v[104:107]
    ds_read_b64_tr_b16 a[198:199], v181 offset:36864
    v_mfma_f32_16x16x32_bf16 v[108:111], a[172:175], v[76:79], v[108:111]
    ds_read_b64_tr_b16 a[200:201], v182 offset:32768
    v_mfma_f32_16x16x32_bf16 v[112:115], a[172:175], v[92:95], v[112:115]
    ds_read_b64_tr_b16 a[202:203], v182 offset:36864
    s_waitcnt lgkmcnt(6)
    v_mfma_f32_16x16x32_bf16 v[116:119], a[176:179], v[16:19], 0
    s_add_u32 s34, s34, 8192
    v_exp_f32 v96, v96
    v_mfma_f32_16x16x32_bf16 v[120:123], a[176:179], v[32:35], 0
    s_add_u32 s35, s35, 8192
    v_exp_f32 v97, v97
    v_mfma_f32_16x16x32_bf16 v[124:127], a[176:179], v[48:51], 0
    v_exp_f32 v98, v98
    v_mfma_f32_16x16x32_bf16 v[128:131], a[176:179], v[64:67], 0
    v_exp_f32 v99, v99
    v_mfma_f32_16x16x32_bf16 v[132:135], a[176:179], v[80:83], 0
    ds_read_b64_tr_b16 a[204:205], v183 offset:32768
    v_add_f32 v207, v207, v96
    v_add_f32 v207, v207, v97
    v_mfma_f32_16x16x32_bf16 v[116:119], a[180:183], v[20:23], v[116:119]
    ds_read_b64_tr_b16 a[206:207], v183 offset:36864
    v_add_f32 v207, v207, v98
    v_add_f32 v207, v207, v99
    v_mfma_f32_16x16x32_bf16 v[120:123], a[180:183], v[36:39], v[120:123]
    ds_read_b64_tr_b16 a[208:209], v184 offset:32768
    v_cvt_pk_bf16_f32 v156, v96, v97
    v_cvt_pk_bf16_f32 v157, v98, v99
    v_mfma_f32_16x16x32_bf16 v[124:127], a[180:183], v[52:55], v[124:127]
    v_exp_f32 v100, v100
    v_mfma_f32_16x16x32_bf16 v[128:131], a[180:183], v[68:71], v[128:131]
    v_exp_f32 v101, v101
    v_mfma_f32_16x16x32_bf16 v[132:135], a[180:183], v[84:87], v[132:135]
    v_exp_f32 v102, v102
    v_mfma_f32_16x16x32_bf16 v[116:119], a[184:187], v[24:27], v[116:119]
    v_exp_f32 v103, v103
    v_mfma_f32_16x16x32_bf16 v[120:123], a[184:187], v[40:43], v[120:123]
    ds_read_b64_tr_b16 a[210:211], v184 offset:36864
    v_add_f32 v208, v208, v100
    v_add_f32 v208, v208, v101
    v_mfma_f32_16x16x32_bf16 v[124:127], a[184:187], v[56:59], v[124:127]
    ds_read_b64_tr_b16 a[212:213], v185 offset:32768
    v_add_f32 v208, v208, v102
    v_add_f32 v208, v208, v103
    v_mfma_f32_16x16x32_bf16 v[128:131], a[184:187], v[72:75], v[128:131]
    ds_read_b64_tr_b16 a[214:215], v185 offset:36864
    v_cvt_pk_bf16_f32 v160, v100, v101
    v_cvt_pk_bf16_f32 v161, v102, v103
    v_mfma_f32_16x16x32_bf16 v[132:135], a[184:187], v[88:91], v[132:135]
    v_exp_f32 v104, v104
    v_mfma_f32_16x16x32_bf16 v[116:119], a[188:191], v[28:31], v[116:119]
    v_exp_f32 v105, v105
    v_mfma_f32_16x16x32_bf16 v[120:123], a[188:191], v[44:47], v[120:123]
    v_exp_f32 v106, v106
    v_mfma_f32_16x16x32_bf16 v[124:127], a[188:191], v[60:63], v[124:127]
    v_exp_f32 v107, v107
    v_mfma_f32_16x16x32_bf16 v[128:131], a[188:191], v[76:79], v[128:131]
    ds_read_b64_tr_b16 a[216:217], v186 offset:32768
    v_add_f32 v209, v209, v104
    v_add_f32 v209, v209, v105
    v_mfma_f32_16x16x32_bf16 v[132:135], a[188:191], v[92:95], v[132:135]
    ds_read_b64_tr_b16 a[218:219], v186 offset:36864
    v_add_f32 v209, v209, v106
    v_add_f32 v209, v209, v107
    s_waitcnt lgkmcnt(2)
    v_mfma_f32_16x16x32_bf16 a[0:3], a[192:195], v[136:139], a[0:3]
    ds_read_b64_tr_b16 a[220:221], v187 offset:32768
    v_cvt_pk_bf16_f32 v164, v104, v105
    v_cvt_pk_bf16_f32 v165, v106, v107
    v_mfma_f32_16x16x32_bf16 a[4:7], a[192:195], v[140:143], a[4:7]
    v_exp_f32 v108, v108
    v_mfma_f32_16x16x32_bf16 a[8:11], a[192:195], v[144:147], a[8:11]
    v_exp_f32 v109, v109
    v_mfma_f32_16x16x32_bf16 a[12:15], a[192:195], v[148:151], a[12:15]
    v_exp_f32 v110, v110
    v_mfma_f32_16x16x32_bf16 a[16:19], a[192:195], v[152:155], a[16:19]
    v_exp_f32 v111, v111
    v_mfma_f32_16x16x32_bf16 a[20:23], a[196:199], v[136:139], a[20:23]
    ds_read_b64_tr_b16 a[222:223], v187 offset:36864
    v_add_f32 v210, v210, v108
    v_add_f32 v210, v210, v109
    v_mfma_f32_16x16x32_bf16 a[24:27], a[196:199], v[140:143], a[24:27]
    v_add_f32 v210, v210, v110
    v_add_f32 v210, v210, v111
    v_mfma_f32_16x16x32_bf16 a[28:31], a[196:199], v[144:147], a[28:31]
    v_cvt_pk_bf16_f32 v168, v108, v109
    v_cvt_pk_bf16_f32 v169, v110, v111
    v_mfma_f32_16x16x32_bf16 a[32:35], a[196:199], v[148:151], a[32:35]
    v_exp_f32 v112, v112
    v_mfma_f32_16x16x32_bf16 a[36:39], a[196:199], v[152:155], a[36:39]
    v_exp_f32 v113, v113
    v_mfma_f32_16x16x32_bf16 a[40:43], a[200:203], v[136:139], a[40:43]
    v_exp_f32 v114, v114
    v_mfma_f32_16x16x32_bf16 a[44:47], a[200:203], v[140:143], a[44:47]
    v_exp_f32 v115, v115
    v_mfma_f32_16x16x32_bf16 a[48:51], a[200:203], v[144:147], a[48:51]
    v_add_f32 v211, v211, v112
    v_add_f32 v211, v211, v113
    v_mfma_f32_16x16x32_bf16 a[52:55], a[200:203], v[148:151], a[52:55]
    v_add_f32 v211, v211, v114
    v_add_f32 v211, v211, v115
    v_mfma_f32_16x16x32_bf16 a[56:59], a[200:203], v[152:155], a[56:59]
    v_cvt_pk_bf16_f32 v172, v112, v113
    v_cvt_pk_bf16_f32 v173, v114, v115
    v_mfma_f32_16x16x32_bf16 a[60:63], a[204:207], v[136:139], a[60:63]
    v_exp_f32 v116, v116
    v_mfma_f32_16x16x32_bf16 a[64:67], a[204:207], v[140:143], a[64:67]
    v_exp_f32 v117, v117
    v_mfma_f32_16x16x32_bf16 a[68:71], a[204:207], v[144:147], a[68:71]
    v_exp_f32 v118, v118
    v_mfma_f32_16x16x32_bf16 a[72:75], a[204:207], v[148:151], a[72:75]
    v_exp_f32 v119, v119
    v_mfma_f32_16x16x32_bf16 a[76:79], a[204:207], v[152:155], a[76:79]
    v_add_f32 v207, v207, v116
    v_add_f32 v207, v207, v117
    v_mfma_f32_16x16x32_bf16 a[80:83], a[208:211], v[136:139], a[80:83]
    v_add_f32 v207, v207, v118
    v_add_f32 v207, v207, v119
    v_mfma_f32_16x16x32_bf16 a[84:87], a[208:211], v[140:143], a[84:87]
    v_cvt_pk_bf16_f32 v158, v116, v117
    v_cvt_pk_bf16_f32 v159, v118, v119
    v_mfma_f32_16x16x32_bf16 a[88:91], a[208:211], v[144:147], a[88:91]
    v_exp_f32 v120, v120
    v_mfma_f32_16x16x32_bf16 a[92:95], a[208:211], v[148:151], a[92:95]
    s_waitcnt lgkmcnt(0)
    v_exp_f32 v121, v121
    v_mfma_f32_16x16x32_bf16 a[96:99], a[208:211], v[152:155], a[96:99]
    s_waitcnt vmcnt(16)
    v_exp_f32 v122, v122
    v_mfma_f32_16x16x32_bf16 a[100:103], a[212:215], v[136:139], a[100:103]
    s_barrier
    v_exp_f32 v123, v123
    v_mfma_f32_16x16x32_bf16 a[104:107], a[212:215], v[140:143], a[104:107]
    ds_read_b128 a[160:163], v176 offset:0
    v_add_f32 v208, v208, v120
    v_add_f32 v208, v208, v121
    v_mfma_f32_16x16x32_bf16 a[108:111], a[212:215], v[144:147], a[108:111]
    ds_read_b128 a[164:167], v177 offset:0
    v_add_f32 v208, v208, v122
    v_add_f32 v208, v208, v123
    v_mfma_f32_16x16x32_bf16 a[112:115], a[212:215], v[148:151], a[112:115]
    ds_read_b128 a[168:171], v178 offset:0
    v_cvt_pk_bf16_f32 v162, v120, v121
    v_cvt_pk_bf16_f32 v163, v122, v123
    v_mfma_f32_16x16x32_bf16 a[116:119], a[212:215], v[152:155], a[116:119]
    v_exp_f32 v124, v124
    v_mfma_f32_16x16x32_bf16 a[120:123], a[216:219], v[136:139], a[120:123]
    v_exp_f32 v125, v125
    v_mfma_f32_16x16x32_bf16 a[124:127], a[216:219], v[140:143], a[124:127]
    v_exp_f32 v126, v126
    v_mfma_f32_16x16x32_bf16 a[128:131], a[216:219], v[144:147], a[128:131]
    v_exp_f32 v127, v127
    v_mfma_f32_16x16x32_bf16 a[132:135], a[216:219], v[148:151], a[132:135]
    ds_read_b128 a[172:175], v179 offset:0
    v_add_f32 v209, v209, v124
    v_add_f32 v209, v209, v125
    v_mfma_f32_16x16x32_bf16 a[136:139], a[216:219], v[152:155], a[136:139]
    ds_read_b128 a[176:179], v176 offset:4096
    v_add_f32 v209, v209, v126
    v_add_f32 v209, v209, v127
    v_mfma_f32_16x16x32_bf16 a[140:143], a[220:223], v[136:139], a[140:143]
    ds_read_b128 a[180:183], v177 offset:4096
    v_cvt_pk_bf16_f32 v166, v124, v125
    v_cvt_pk_bf16_f32 v167, v126, v127
    v_mfma_f32_16x16x32_bf16 a[144:147], a[220:223], v[140:143], a[144:147]
    v_exp_f32 v128, v128
    v_mfma_f32_16x16x32_bf16 a[148:151], a[220:223], v[144:147], a[148:151]
    v_exp_f32 v129, v129
    v_mfma_f32_16x16x32_bf16 a[152:155], a[220:223], v[148:151], a[152:155]
    v_exp_f32 v130, v130
    v_mfma_f32_16x16x32_bf16 a[156:159], a[220:223], v[152:155], a[156:159]
    s_cbranch_vccz 1
    s_waitcnt vmcnt(4)
    s_add_u32 m0, s41, 49152
    v_exp_f32 v131, v131
    s_waitcnt lgkmcnt(2)
    v_mfma_f32_16x16x32_bf16 v[96:99], a[160:163], v[16:19], 0
    ds_read_b128 a[184:187], v178 offset:4096
    v_add_f32 v210, v210, v128
    v_add_f32 v210, v210, v129
    v_mfma_f32_16x16x32_bf16 v[100:103], a[160:163], v[32:35], 0
    ds_read_b128 a[188:191], v179 offset:4096
    v_add_f32 v210, v210, v130
    v_add_f32 v210, v210, v131
    v_mfma_f32_16x16x32_bf16 v[104:107], a[160:163], v[48:51], 0
    buffer_load_dwordx4 v194, s[16:19], s34 offen nt lds
    v_cvt_pk_bf16_f32 v170, v128, v129
    v_cvt_pk_bf16_f32 v171, v130, v131
    v_mfma_f32_16x16x32_bf16 v[108:111], a[160:163], v[64:67], 0
    v_exp_f32 v132, v132
    v_mfma_f32_16x16x32_bf16 v[112:115], a[160:163], v[80:83], 0
    v_exp_f32 v133, v133
    v_mfma_f32_16x16x32_bf16 v[96:99], a[164:167], v[20:23], v[96:99]
    v_exp_f32 v134, v134
    v_mfma_f32_16x16x32_bf16 v[100:103], a[164:167], v[36:39], v[100:103]
    v_exp_f32 v135, v135
    v_mfma_f32_16x16x32_bf16 v[104:107], a[164:167], v[52:55], v[104:107]
    buffer_load_dwordx4 v195, s[16:19], s34 offen offset:1024 nt lds
    v_add_f32 v211, v211, v132
    v_add_f32 v211, v211, v133
    v_mfma_f32_16x16x32_bf16 v[108:111], a[164:167], v[68:71], v[108:111]
    buffer_load_dwordx4 v196, s[16:19], s34 offen offset:2048 nt lds
    v_add_f32 v211, v211, v134
    v_add_f32 v211, v211, v135
    v_mfma_f32_16x16x32_bf16 v[112:115], a[164:167], v[84:87], v[112:115]
    buffer_load_dwordx4 v197, s[16:19], s34 offen offset:3072 nt lds
    s_add_u32 m0, s42, 32768
    v_cvt_pk_bf16_f32 v174, v132, v133
    v_cvt_pk_bf16_f32 v175, v134, v135
    v_mfma_f32_16x16x32_bf16 v[96:99], a[168:171], v[24:27], v[96:99]
    buffer_load_dwordx4 v198, s[20:23], s35 offen nt lds
    v_mfma_f32_16x16x32_bf16 v[100:103], a[168:171], v[40:43], v[100:103]
    buffer_load_dwordx4 v199, s[20:23], s35 offen offset:1024 nt lds
    v_mfma_f32_16x16x32_bf16 v[104:107], a[168:171], v[56:59], v[104:107]
    buffer_load_dwordx4 v198, s[20:23], s35 offen offset:2048 nt lds
    v_mfma_f32_16x16x32_bf16 v[108:111], a[168:171], v[72:75], v[108:111]
    buffer_load_dwordx4 v199, s[20:23], s35 offen offset:3072 nt lds
    v_mfma_f32_16x16x32_bf16 v[112:115], a[168:171], v[88:91], v[112:115]
    ds_read_b64_tr_b16 a[192:193], v180 offset:49152
    v_mfma_f32_16x16x32_bf16 v[96:99], a[172:175], v[28:31], v[96:99]
    ds_read_b64_tr_b16 a[194:195], v180 offset:53248
    v_mfma_f32_16x16x32_bf16 v[100:103], a[172:175], v[44:47], v[100:103]
    ds_read_b64_tr_b16 a[196:197], v181 offset:49152
    v_mfma_f32_16x16x32_bf16 v[104:107], a[172:175], v[60:63], v[104:107]
    ds_read_b64_tr_b16 a[198:199], v181 offset:53248
    v_mfma_f32_16x16x32_bf16 v[108:111], a[172:175], v[76:79], v[108:111]
    ds_read_b64_tr_b16 a[200:201], v182 offset:49152
    v_mfma_f32_16x16x32_bf16 v[112:115], a[172:175], v[92:95], v[112:115]
    ds_read_b64_tr_b16 a[202:203], v182 offset:53248
    s_waitcnt lgkmcnt(6)
    v_mfma_f32_16x16x32_bf16 v[116:119], a[176:179], v[16:19], 0
    s_add_u32 s34, s34, 8192
    v_exp_f32 v96, v96
    v_mfma_f32_16x16x32_bf16 v[120:123], a[176:179], v[32:35], 0
    s_add_u32 s35, s35, 8192
    v_exp_f32 v97, v97
    v_mfma_f32_16x16x32_bf16 v[124:127], a[176:179], v[48:51], 0
    v_exp_f32 v98, v98
    v_mfma_f32_16x16x32_bf16 v[128:131], a[176:179], v[64:67], 0
    v_exp_f32 v99, v99
    v_mfma_f32_16x16x32_bf16 v[132:135], a[176:179], v[80:83], 0
    ds_read_b64_tr_b16 a[204:205], v183 offset:49152
    v_add_f32 v207, v207, v96
    v_add_f32 v207, v207, v97
    v_mfma_f32_16x16x32_bf16 v[116:119], a[180:183], v[20:23], v[116:119]
    ds_read_b64_tr_b16 a[206:207], v183 offset:53248
    v_add_f32 v207, v207, v98
    v_add_f32 v207, v207, v99
    v_mfma_f32_16x16x32_bf16 v[120:123], a[180:183], v[36:39], v[120:123]
    ds_read_b64_tr_b16 a[208:209], v184 offset:49152
    v_cvt_pk_bf16_f32 v136, v96, v97
    v_cvt_pk_bf16_f32 v137, v98, v99
    v_mfma_f32_16x16x32_bf16 v[124:127], a[180:183], v[52:55], v[124:127]
    v_exp_f32 v100, v100
    v_mfma_f32_16x16x32_bf16 v[128:131], a[180:183], v[68:71], v[128:131]
    v_exp_f32 v101, v101
    v_mfma_f32_16x16x32_bf16 v[132:135], a[180:183], v[84:87], v[132:135]
    v_exp_f32 v102, v102
    v_mfma_f32_16x16x32_bf16 v[116:119], a[184:187], v[24:27], v[116:119]
    v_exp_f32 v103, v103
    v_mfma_f32_16x16x32_bf16 v[120:123], a[184:187], v[40:43], v[120:123]
    ds_read_b64_tr_b16 a[210:211], v184 offset:53248
    v_add_f32 v208, v208, v100
    v_add_f32 v208, v208, v101
    v_mfma_f32_16x16x32_bf16 v[124:127], a[184:187], v[56:59], v[124:127]
    ds_read_b64_tr_b16 a[212:213], v185 offset:49152
    v_add_f32 v208, v208, v102
    v_add_f32 v208, v208, v103
    v_mfma_f32_16x16x32_bf16 v[128:131], a[184:187], v[72:75], v[128:131]
    ds_read_b64_tr_b16 a[214:215], v185 offset:53248
    v_cvt_pk_bf16_f32 v140, v100, v101
    v_cvt_pk_bf16_f32 v141, v102, v103
    v_mfma_f32_16x16x32_bf16 v[132:135], a[184:187], v[88:91], v[132:135]
    v_exp_f32 v104, v104
    v_mfma_f32_16x16x32_bf16 v[116:119], a[188:191], v[28:31], v[116:119]
    v_exp_f32 v105, v105
    v_mfma_f32_16x16x32_bf16 v[120:123], a[188:191], v[44:47], v[120:123]
    v_exp_f32 v106, v106
    v_mfma_f32_16x16x32_bf16 v[124:127], a[188:191], v[60:63], v[124:127]
    v_exp_f32 v107, v107
    v_mfma_f32_16x16x32_bf16 v[128:131], a[188:191], v[76:79], v[128:131]
    ds_read_b64_tr_b16 a[216:217], v186 offset:49152
    v_add_f32 v209, v209, v104
    v_add_f32 v209, v209, v105
    v_mfma_f32_16x16x32_bf16 v[132:135], a[188:191], v[92:95], v[132:135]
    ds_read_b64_tr_b16 a[218:219], v186 offset:53248
    v_add_f32 v209, v209, v106
    v_add_f32 v209, v209, v107
    s_waitcnt lgkmcnt(2)
    v_mfma_f32_16x16x32_bf16 a[0:3], a[192:195], v[156:159], a[0:3]
    ds_read_b64_tr_b16 a[220:221], v187 offset:49152
    v_cvt_pk_bf16_f32 v144, v104, v105
    v_cvt_pk_bf16_f32 v145, v106, v107
    v_mfma_f32_16x16x32_bf16 a[4:7], a[192:195], v[160:163], a[4:7]
    v_exp_f32 v108, v108
    v_mfma_f32_16x16x32_bf16 a[8:11], a[192:195], v[164:167], a[8:11]
    v_exp_f32 v109, v109
    v_mfma_f32_16x16x32_bf16 a[12:15], a[192:195], v[168:171], a[12:15]
    v_exp_f32 v110, v110
    v_mfma_f32_16x16x32_bf16 a[16:19], a[192:195], v[172:175], a[16:19]
    v_exp_f32 v111, v111
    v_mfma_f32_16x16x32_bf16 a[20:23], a[196:199], v[156:159], a[20:23]
    ds_read_b64_tr_b16 a[222:223], v187 offset:53248
    v_add_f32 v210, v210, v108
    v_add_f32 v210, v210, v109
    v_mfma_f32_16x16x32_bf16 a[24:27], a[196:199], v[160:163], a[24:27]
    v_add_f32 v210, v210, v110
    v_add_f32 v210, v210, v111
    v_mfma_f32_16x16x32_bf16 a[28:31], a[196:199], v[164:167], a[28:31]
    v_cvt_pk_bf16_f32 v148, v108, v109
    v_cvt_pk_bf16_f32 v149, v110, v111
    v_mfma_f32_16x16x32_bf16 a[32:35], a[196:199], v[168:171], a[32:35]
    v_exp_f32 v112, v112
    v_mfma_f32_16x16x32_bf16 a[36:39], a[196:199], v[172:175], a[36:39]
    v_exp_f32 v113, v113
    v_mfma_f32_16x16x32_bf16 a[40:43], a[200:203], v[156:159], a[40:43]
    v_exp_f32 v114, v114
    v_mfma_f32_16x16x32_bf16 a[44:47], a[200:203], v[160:163], a[44:47]
    v_exp_f32 v115, v115
    v_mfma_f32_16x16x32_bf16 a[48:51], a[200:203], v[164:167], a[48:51]
    v_add_f32 v211, v211, v112
    v_add_f32 v211, v211, v113
    v_mfma_f32_16x16x32_bf16 a[52:55], a[200:203], v[168:171], a[52:55]
    v_add_f32 v211, v211, v114
    v_add_f32 v211, v211, v115
    v_mfma_f32_16x16x32_bf16 a[56:59], a[200:203], v[172:175], a[56:59]
    v_cvt_pk_bf16_f32 v152, v112, v113
    v_cvt_pk_bf16_f32 v153, v114, v115
    v_mfma_f32_16x16x32_bf16 a[60:63], a[204:207], v[156:159], a[60:63]
    v_exp_f32 v116, v116
    v_mfma_f32_16x16x32_bf16 a[64:67], a[204:207], v[160:163], a[64:67]
    v_exp_f32 v117, v117
    v_mfma_f32_16x16x32_bf16 a[68:71], a[204:207], v[164:167], a[68:71]
    v_exp_f32 v118, v118
    v_mfma_f32_16x16x32_bf16 a[72:75], a[204:207], v[168:171], a[72:75]
    v_exp_f32 v119, v119
    v_mfma_f32_16x16x32_bf16 a[76:79], a[204:207], v[172:175], a[76:79]
    v_add_f32 v207, v207, v116
    v_add_f32 v207, v207, v117
    v_mfma_f32_16x16x32_bf16 a[80:83], a[208:211], v[156:159], a[80:83]
    v_add_f32 v207, v207, v118
    v_add_f32 v207, v207, v119
    v_mfma_f32_16x16x32_bf16 a[84:87], a[208:211], v[160:163], a[84:87]
    v_cvt_pk_bf16_f32 v138, v116, v117
    v_cvt_pk_bf16_f32 v139, v118, v119
    v_mfma_f32_16x16x32_bf16 a[88:91], a[208:211], v[164:167], a[88:91]
    v_exp_f32 v120, v120
    v_mfma_f32_16x16x32_bf16 a[92:95], a[208:211], v[168:171], a[92:95]
    s_waitcnt lgkmcnt(0)
    v_exp_f32 v121, v121
    v_mfma_f32_16x16x32_bf16 a[96:99], a[208:211], v[172:175], a[96:99]
    s_waitcnt vmcnt(16)
    v_exp_f32 v122, v122
    v_mfma_f32_16x16x32_bf16 a[100:103], a[212:215], v[156:159], a[100:103]
    s_barrier
    v_exp_f32 v123, v123
    v_mfma_f32_16x16x32_bf16 a[104:107], a[212:215], v[160:163], a[104:107]
    ds_read_b128 a[160:163], v176 offset:16384
    v_add_f32 v208, v208, v120
    v_add_f32 v208, v208, v121
    v_mfma_f32_16x16x32_bf16 a[108:111], a[212:215], v[164:167], a[108:111]
    ds_read_b128 a[164:167], v177 offset:16384
    v_add_f32 v208, v208, v122
    v_add_f32 v208, v208, v123
    v_mfma_f32_16x16x32_bf16 a[112:115], a[212:215], v[168:171], a[112:115]
    ds_read_b128 a[168:171], v178 offset:16384
    v_cvt_pk_bf16_f32 v142, v120, v121
    v_cvt_pk_bf16_f32 v143, v122, v123
    v_mfma_f32_16x16x32_bf16 a[116:119], a[212:215], v[172:175], a[116:119]
    v_exp_f32 v124, v124
    v_mfma_f32_16x16x32_bf16 a[120:123], a[216:219], v[156:159], a[120:123]
    v_exp_f32 v125, v125
    v_mfma_f32_16x16x32_bf16 a[124:127], a[216:219], v[160:163], a[124:127]
    v_exp_f32 v126, v126
    v_mfma_f32_16x16x32_bf16 a[128:131], a[216:219], v[164:167], a[128:131]
    v_exp_f32 v127, v127
    v_mfma_f32_16x16x32_bf16 a[132:135], a[216:219], v[168:171], a[132:135]
    ds_read_b128 a[172:175], v179 offset:16384
    v_add_f32 v209, v209, v124
    v_add_f32 v209, v209, v125
    v_mfma_f32_16x16x32_bf16 a[136:139], a[216:219], v[172:175], a[136:139]
    ds_read_b128 a[176:179], v176 offset:20480
    v_add_f32 v209, v209, v126
    v_add_f32 v209, v209, v127
    v_mfma_f32_16x16x32_bf16 a[140:143], a[220:223], v[156:159], a[140:143]
    ds_read_b128 a[180:183], v177 offset:20480
    v_cvt_pk_bf16_f32 v146, v124, v125
    v_cvt_pk_bf16_f32 v147, v126, v127
    v_mfma_f32_16x16x32_bf16 a[144:147], a[220:223], v[160:163], a[144:147]
    v_exp_f32 v128, v128
    v_mfma_f32_16x16x32_bf16 a[148:151], a[220:223], v[164:167], a[148:151]
    v_exp_f32 v129, v129
    v_mfma_f32_16x16x32_bf16 a[152:155], a[220:223], v[168:171], a[152:155]
    v_exp_f32 v130, v130
    v_mfma_f32_16x16x32_bf16 a[156:159], a[220:223], v[172:175], a[156:159]
    s_cbranch_vccz 1
    s_waitcnt vmcnt(4)
    s_mov_b32 m0, s41
    v_exp_f32 v131, v131
    s_waitcnt lgkmcnt(2)
    v_mfma_f32_16x16x32_bf16 v[96:99], a[160:163], v[16:19], 0
    ds_read_b128 a[184:187], v178 offset:20480
    v_add_f32 v210, v210, v128
    v_add_f32 v210, v210, v129
    v_mfma_f32_16x16x32_bf16 v[100:103], a[160:163], v[32:35], 0
    ds_read_b128 a[188:191], v179 offset:20480
    v_add_f32 v210, v210, v130
    v_add_f32 v210, v210, v131
    v_mfma_f32_16x16x32_bf16 v[104:107], a[160:163], v[48:51], 0
    buffer_load_dwordx4 v194, s[16:19], s34 offen nt lds
    v_cvt_pk_bf16_f32 v150, v128, v129
    v_cvt_pk_bf16_f32 v151, v130, v131
    v_mfma_f32_16x16x32_bf16 v[108:111], a[160:163], v[64:67], 0
    v_exp_f32 v132, v132
    v_mfma_f32_16x16x32_bf16 v[112:115], a[160:163], v[80:83], 0
    v_exp_f32 v133, v133
    v_mfma_f32_16x16x32_bf16 v[96:99], a[164:167], v[20:23], v[96:99]
    v_exp_f32 v134, v134
    v_mfma_f32_16x16x32_bf16 v[100:103], a[164:167], v[36:39], v[100:103]
    v_exp_f32 v135, v135
    v_mfma_f32_16x16x32_bf16 v[104:107], a[164:167], v[52:55], v[104:107]
    buffer_load_dwordx4 v195, s[16:19], s34 offen offset:1024 nt lds
    v_add_f32 v211, v211, v132
    v_add_f32 v211, v211, v133
    v_mfma_f32_16x16x32_bf16 v[108:111], a[164:167], v[68:71], v[108:111]
    buffer_load_dwordx4 v196, s[16:19], s34 offen offset:2048 nt lds
    v_add_f32 v211, v211, v134
    v_add_f32 v211, v211, v135
    v_mfma_f32_16x16x32_bf16 v[112:115], a[164:167], v[84:87], v[112:115]
    buffer_load_dwordx4 v197, s[16:19], s34 offen offset:3072 nt lds
    s_add_u32 m0, s42, 49152
    v_cvt_pk_bf16_f32 v154, v132, v133
    v_cvt_pk_bf16_f32 v155, v134, v135
    v_mfma_f32_16x16x32_bf16 v[96:99], a[168:171], v[24:27], v[96:99]
    buffer_load_dwordx4 v198, s[20:23], s35 offen nt lds
    v_mfma_f32_16x16x32_bf16 v[100:103], a[168:171], v[40:43], v[100:103]
    buffer_load_dwordx4 v199, s[20:23], s35 offen offset:1024 nt lds
    v_mfma_f32_16x16x32_bf16 v[104:107], a[168:171], v[56:59], v[104:107]
    buffer_load_dwordx4 v198, s[20:23], s35 offen offset:2048 nt lds
    v_mfma_f32_16x16x32_bf16 v[108:111], a[168:171], v[72:75], v[108:111]
    buffer_load_dwordx4 v199, s[20:23], s35 offen offset:3072 nt lds
    v_mfma_f32_16x16x32_bf16 v[112:115], a[168:171], v[88:91], v[112:115]
    ds_read_b64_tr_b16 a[192:193], v180 offset:0
    v_mfma_f32_16x16x32_bf16 v[96:99], a[172:175], v[28:31], v[96:99]
    ds_read_b64_tr_b16 a[194:195], v180 offset:4096
    v_mfma_f32_16x16x32_bf16 v[100:103], a[172:175], v[44:47], v[100:103]
    ds_read_b64_tr_b16 a[196:197], v181 offset:0
    v_mfma_f32_16x16x32_bf16 v[104:107], a[172:175], v[60:63], v[104:107]
    ds_read_b64_tr_b16 a[198:199], v181 offset:4096
    v_mfma_f32_16x16x32_bf16 v[108:111], a[172:175], v[76:79], v[108:111]
    ds_read_b64_tr_b16 a[200:201], v182 offset:0
    v_mfma_f32_16x16x32_bf16 v[112:115], a[172:175], v[92:95], v[112:115]
    ds_read_b64_tr_b16 a[202:203], v182 offset:4096
    s_waitcnt lgkmcnt(6)
    v_mfma_f32_16x16x32_bf16 v[116:119], a[176:179], v[16:19], 0
    s_add_u32 s34, s34, 8192
    v_exp_f32 v96, v96
    v_mfma_f32_16x16x32_bf16 v[120:123], a[176:179], v[32:35], 0
    s_add_u32 s35, s35, 8192
    v_exp_f32 v97, v97
    v_mfma_f32_16x16x32_bf16 v[124:127], a[176:179], v[48:51], 0
    v_exp_f32 v98, v98
    v_mfma_f32_16x16x32_bf16 v[128:131], a[176:179], v[64:67], 0
    v_exp_f32 v99, v99
    v_mfma_f32_16x16x32_bf16 v[132:135], a[176:179], v[80:83], 0
    ds_read_b64_tr_b16 a[204:205], v183 offset:0
    v_add_f32 v207, v207, v96
    v_add_f32 v207, v207, v97
    v_mfma_f32_16x16x32_bf16 v[116:119], a[180:183], v[20:23], v[116:119]
    ds_read_b64_tr_b16 a[206:207], v183 offset:4096
    v_add_f32 v207, v207, v98
    v_add_f32 v207, v207, v99
    v_mfma_f32_16x16x32_bf16 v[120:123], a[180:183], v[36:39], v[120:123]
    ds_read_b64_tr_b16 a[208:209], v184 offset:0
    v_cvt_pk_bf16_f32 v156, v96, v97
    v_cvt_pk_bf16_f32 v157, v98, v99
    v_mfma_f32_16x16x32_bf16 v[124:127], a[180:183], v[52:55], v[124:127]
    v_exp_f32 v100, v100
    v_mfma_f32_16x16x32_bf16 v[128:131], a[180:183], v[68:71], v[128:131]
    v_exp_f32 v101, v101
    v_mfma_f32_16x16x32_bf16 v[132:135], a[180:183], v[84:87], v[132:135]
    v_exp_f32 v102, v102
    v_mfma_f32_16x16x32_bf16 v[116:119], a[184:187], v[24:27], v[116:119]
    v_exp_f32 v103, v103
    v_mfma_f32_16x16x32_bf16 v[120:123], a[184:187], v[40:43], v[120:123]
    ds_read_b64_tr_b16 a[210:211], v184 offset:4096
    v_add_f32 v208, v208, v100
    v_add_f32 v208, v208, v101
    v_mfma_f32_16x16x32_bf16 v[124:127], a[184:187], v[56:59], v[124:127]
    ds_read_b64_tr_b16 a[212:213], v185 offset:0
    v_add_f32 v208, v208, v102
    v_add_f32 v208, v208, v103
    v_mfma_f32_16x16x32_bf16 v[128:131], a[184:187], v[72:75], v[128:131]
    ds_read_b64_tr_b16 a[214:215], v185 offset:4096
    v_cvt_pk_bf16_f32 v160, v100, v101
    v_cvt_pk_bf16_f32 v161, v102, v103
    v_mfma_f32_16x16x32_bf16 v[132:135], a[184:187], v[88:91], v[132:135]
    v_exp_f32 v104, v104
    v_mfma_f32_16x16x32_bf16 v[116:119], a[188:191], v[28:31], v[116:119]
    v_exp_f32 v105, v105
    v_mfma_f32_16x16x32_bf16 v[120:123], a[188:191], v[44:47], v[120:123]
    v_exp_f32 v106, v106
    v_mfma_f32_16x16x32_bf16 v[124:127], a[188:191], v[60:63], v[124:127]
    v_exp_f32 v107, v107
    v_mfma_f32_16x16x32_bf16 v[128:131], a[188:191], v[76:79], v[128:131]
    ds_read_b64_tr_b16 a[216:217], v186 offset:0
    v_add_f32 v209, v209, v104
    v_add_f32 v209, v209, v105
    v_mfma_f32_16x16x32_bf16 v[132:135], a[188:191], v[92:95], v[132:135]
    ds_read_b64_tr_b16 a[218:219], v186 offset:4096
    v_add_f32 v209, v209, v106
    v_add_f32 v209, v209, v107
    s_waitcnt lgkmcnt(2)
    v_mfma_f32_16x16x32_bf16 a[0:3], a[192:195], v[136:139], a[0:3]
    ds_read_b64_tr_b16 a[220:221], v187 offset:0
    v_cvt_pk_bf16_f32 v164, v104, v105
    v_cvt_pk_bf16_f32 v165, v106, v107
    v_mfma_f32_16x16x32_bf16 a[4:7], a[192:195], v[140:143], a[4:7]
    v_exp_f32 v108, v108
    v_mfma_f32_16x16x32_bf16 a[8:11], a[192:195], v[144:147], a[8:11]
    v_exp_f32 v109, v109
    v_mfma_f32_16x16x32_bf16 a[12:15], a[192:195], v[148:151], a[12:15]
    v_exp_f32 v110, v110
    v_mfma_f32_16x16x32_bf16 a[16:19], a[192:195], v[152:155], a[16:19]
    v_exp_f32 v111, v111
    v_mfma_f32_16x16x32_bf16 a[20:23], a[196:199], v[136:139], a[20:23]
    ds_read_b64_tr_b16 a[222:223], v187 offset:4096
    v_add_f32 v210, v210, v108
    v_add_f32 v210, v210, v109
    v_mfma_f32_16x16x32_bf16 a[24:27], a[196:199], v[140:143], a[24:27]
    v_add_f32 v210, v210, v110
    v_add_f32 v210, v210, v111
    v_mfma_f32_16x16x32_bf16 a[28:31], a[196:199], v[144:147], a[28:31]
    v_cvt_pk_bf16_f32 v168, v108, v109
    v_cvt_pk_bf16_f32 v169, v110, v111
    v_mfma_f32_16x16x32_bf16 a[32:35], a[196:199], v[148:151], a[32:35]
    v_exp_f32 v112, v112
    v_mfma_f32_16x16x32_bf16 a[36:39], a[196:199], v[152:155], a[36:39]
    v_exp_f32 v113, v113
    v_mfma_f32_16x16x32_bf16 a[40:43], a[200:203], v[136:139], a[40:43]
    v_exp_f32 v114, v114
    v_mfma_f32_16x16x32_bf16 a[44:47], a[200:203], v[140:143], a[44:47]
    v_exp_f32 v115, v115
    v_mfma_f32_16x16x32_bf16 a[48:51], a[200:203], v[144:147], a[48:51]
    v_add_f32 v211, v211, v112
    v_add_f32 v211, v211, v113
    v_mfma_f32_16x16x32_bf16 a[52:55], a[200:203], v[148:151], a[52:55]
    v_add_f32 v211, v211, v114
    v_add_f32 v211, v211, v115
    v_mfma_f32_16x16x32_bf16 a[56:59], a[200:203], v[152:155], a[56:59]
    v_cvt_pk_bf16_f32 v172, v112, v113
    v_cvt_pk_bf16_f32 v173, v114, v115
    v_mfma_f32_16x16x32_bf16 a[60:63], a[204:207], v[136:139], a[60:63]
    v_exp_f32 v116, v116
    v_mfma_f32_16x16x32_bf16 a[64:67], a[204:207], v[140:143], a[64:67]
    v_exp_f32 v117, v117
    v_mfma_f32_16x16x32_bf16 a[68:71], a[204:207], v[144:147], a[68:71]
    v_exp_f32 v118, v118
    v_mfma_f32_16x16x32_bf16 a[72:75], a[204:207], v[148:151], a[72:75]
    v_exp_f32 v119, v119
    v_mfma_f32_16x16x32_bf16 a[76:79], a[204:207], v[152:155], a[76:79]
    v_add_f32 v207, v207, v116
    v_add_f32 v207, v207, v117
    v_mfma_f32_16x16x32_bf16 a[80:83], a[208:211], v[136:139], a[80:83]
    v_add_f32 v207, v207, v118
    v_add_f32 v207, v207, v119
    v_mfma_f32_16x16x32_bf16 a[84:87], a[208:211], v[140:143], a[84:87]
    v_cvt_pk_bf16_f32 v158, v116, v117
    v_cvt_pk_bf16_f32 v159, v118, v119
    v_mfma_f32_16x16x32_bf16 a[88:91], a[208:211], v[144:147], a[88:91]
    v_exp_f32 v120, v120
    v_mfma_f32_16x16x32_bf16 a[92:95], a[208:211], v[148:151], a[92:95]
    s_waitcnt lgkmcnt(0)
    v_exp_f32 v121, v121
    v_mfma_f32_16x16x32_bf16 a[96:99], a[208:211], v[152:155], a[96:99]
    s_waitcnt vmcnt(16)
    v_exp_f32 v122, v122
    v_mfma_f32_16x16x32_bf16 a[100:103], a[212:215], v[136:139], a[100:103]
    s_barrier
    v_exp_f32 v123, v123
    v_mfma_f32_16x16x32_bf16 a[104:107], a[212:215], v[140:143], a[104:107]
    ds_read_b128 a[160:163], v176 offset:32768
    v_add_f32 v208, v208, v120
    v_add_f32 v208, v208, v121
    v_mfma_f32_16x16x32_bf16 a[108:111], a[212:215], v[144:147], a[108:111]
    ds_read_b128 a[164:167], v177 offset:32768
    v_add_f32 v208, v208, v122
    v_add_f32 v208, v208, v123
    v_mfma_f32_16x16x32_bf16 a[112:115], a[212:215], v[148:151], a[112:115]
    ds_read_b128 a[168:171], v178 offset:32768
    v_cvt_pk_bf16_f32 v162, v120, v121
    v_cvt_pk_bf16_f32 v163, v122, v123
    v_mfma_f32_16x16x32_bf16 a[116:119], a[212:215], v[152:155], a[116:119]
    v_exp_f32 v124, v124
    v_mfma_f32_16x16x32_bf16 a[120:123], a[216:219], v[136:139], a[120:123]
    v_exp_f32 v125, v125
    v_mfma_f32_16x16x32_bf16 a[124:127], a[216:219], v[140:143], a[124:127]
    v_exp_f32 v126, v126
    v_mfma_f32_16x16x32_bf16 a[128:131], a[216:219], v[144:147], a[128:131]
    v_exp_f32 v127, v127
    v_mfma_f32_16x16x32_bf16 a[132:135], a[216:219], v[148:151], a[132:135]
    ds_read_b128 a[172:175], v179 offset:32768
    v_add_f32 v209, v209, v124
    v_add_f32 v209, v209, v125
    v_mfma_f32_16x16x32_bf16 a[136:139], a[216:219], v[152:155], a[136:139]
    ds_read_b128 a[176:179], v176 offset:36864
    v_add_f32 v209, v209, v126
    v_add_f32 v209, v209, v127
    v_mfma_f32_16x16x32_bf16 a[140:143], a[220:223], v[136:139], a[140:143]
    ds_read_b128 a[180:183], v177 offset:36864
    v_cvt_pk_bf16_f32 v166, v124, v125
    v_cvt_pk_bf16_f32 v167, v126, v127
    v_mfma_f32_16x16x32_bf16 a[144:147], a[220:223], v[140:143], a[144:147]
    v_exp_f32 v128, v128
    v_mfma_f32_16x16x32_bf16 a[148:151], a[220:223], v[144:147], a[148:151]
    v_exp_f32 v129, v129
    v_mfma_f32_16x16x32_bf16 a[152:155], a[220:223], v[148:151], a[152:155]
    v_exp_f32 v130, v130
    v_mfma_f32_16x16x32_bf16 a[156:159], a[220:223], v[152:155], a[156:159]
    s_cbranch_vccz 1
    s_waitcnt vmcnt(4)
    s_add_u32 m0, s41, 16384
    v_exp_f32 v131, v131
    s_sub_u32 s40, s40, 1
    s_cmp_lg_u32 s40, 0
    s_cbranch_scc1 L1_aloop
    s_waitcnt lgkmcnt(2)
    v_mfma_f32_16x16x32_bf16 v[96:99], a[160:163], v[16:19], 0
    ds_read_b128 a[184:187], v178 offset:36864
    v_add_f32 v210, v210, v128
    v_add_f32 v210, v210, v129
    v_mfma_f32_16x16x32_bf16 v[100:103], a[160:163], v[32:35], 0
    ds_read_b128 a[188:191], v179 offset:36864
    v_add_f32 v210, v210, v130
    v_add_f32 v210, v210, v131
    v_mfma_f32_16x16x32_bf16 v[104:107], a[160:163], v[48:51], 0
    buffer_load_dwordx4 v194, s[16:19], s34 offen nt lds
    v_cvt_pk_bf16_f32 v170, v128, v129
    v_cvt_pk_bf16_f32 v171, v130, v131
    v_mfma_f32_16x16x32_bf16 v[108:111], a[160:163], v[64:67], 0
    v_exp_f32 v132, v132
    v_mfma_f32_16x16x32_bf16 v[112:115], a[160:163], v[80:83], 0
    v_exp_f32 v133, v133
    v_mfma_f32_16x16x32_bf16 v[96:99], a[164:167], v[20:23], v[96:99]
    v_exp_f32 v134, v134
    v_mfma_f32_16x16x32_bf16 v[100:103], a[164:167], v[36:39], v[100:103]
    v_exp_f32 v135, v135
    v_mfma_f32_16x16x32_bf16 v[104:107], a[164:167], v[52:55], v[104:107]
    buffer_load_dwordx4 v195, s[16:19], s34 offen offset:1024 nt lds
    v_add_f32 v211, v211, v132
    v_add_f32 v211, v211, v133
    v_mfma_f32_16x16x32_bf16 v[108:111], a[164:167], v[68:71], v[108:111]
    buffer_load_dwordx4 v196, s[16:19], s34 offen offset:2048 nt lds
    v_add_f32 v211, v211, v134
    v_add_f32 v211, v211, v135
    v_mfma_f32_16x16x32_bf16 v[112:115], a[164:167], v[84:87], v[112:115]
    buffer_load_dwordx4 v197, s[16:19], s34 offen offset:3072 nt lds
    s_mov_b32 m0, s42
    v_cvt_pk_bf16_f32 v174, v132, v133
    v_cvt_pk_bf16_f32 v175, v134, v135
    v_mfma_f32_16x16x32_bf16 v[96:99], a[168:171], v[24:27], v[96:99]
    buffer_load_dwordx4 v198, s[20:23], s35 offen nt lds
    v_mfma_f32_16x16x32_bf16 v[100:103], a[168:171], v[40:43], v[100:103]
    buffer_load_dwordx4 v199, s[20:23], s35 offen offset:1024 nt lds
    v_mfma_f32_16x16x32_bf16 v[104:107], a[168:171], v[56:59], v[104:107]
    buffer_load_dwordx4 v198, s[20:23], s35 offen offset:2048 nt lds
    v_mfma_f32_16x16x32_bf16 v[108:111], a[168:171], v[72:75], v[108:111]
    buffer_load_dwordx4 v199, s[20:23], s35 offen offset:3072 nt lds
    v_mfma_f32_16x16x32_bf16 v[112:115], a[168:171], v[88:91], v[112:115]
    ds_read_b64_tr_b16 a[192:193], v180 offset:16384
    v_mfma_f32_16x16x32_bf16 v[96:99], a[172:175], v[28:31], v[96:99]
    ds_read_b64_tr_b16 a[194:195], v180 offset:20480
    v_mfma_f32_16x16x32_bf16 v[100:103], a[172:175], v[44:47], v[100:103]
    ds_read_b64_tr_b16 a[196:197], v181 offset:16384
    v_mfma_f32_16x16x32_bf16 v[104:107], a[172:175], v[60:63], v[104:107]
    ds_read_b64_tr_b16 a[198:199], v181 offset:20480
    v_mfma_f32_16x16x32_bf16 v[108:111], a[172:175], v[76:79], v[108:111]
    ds_read_b64_tr_b16 a[200:201], v182 offset:16384
    v_mfma_f32_16x16x32_bf16 v[112:115], a[172:175], v[92:95], v[112:115]
    ds_read_b64_tr_b16 a[202:203], v182 offset:20480
    s_waitcnt lgkmcnt(6)
    v_mfma_f32_16x16x32_bf16 v[116:119], a[176:179], v[16:19], 0
    s_add_u32 s34, s34, 8192
    v_exp_f32 v96, v96
    v_mfma_f32_16x16x32_bf16 v[120:123], a[176:179], v[32:35], 0
    s_add_u32 s35, s35, 8192
    v_exp_f32 v97, v97
    v_mfma_f32_16x16x32_bf16 v[124:127], a[176:179], v[48:51], 0
    v_exp_f32 v98, v98
    v_mfma_f32_16x16x32_bf16 v[128:131], a[176:179], v[64:67], 0
    v_exp_f32 v99, v99
    v_mfma_f32_16x16x32_bf16 v[132:135], a[176:179], v[80:83], 0
    ds_read_b64_tr_b16 a[204:205], v183 offset:16384
    v_add_f32 v207, v207, v96
    v_add_f32 v207, v207, v97
    v_mfma_f32_16x16x32_bf16 v[116:119], a[180:183], v[20:23], v[116:119]
    ds_read_b64_tr_b16 a[206:207], v183 offset:20480
    v_add_f32 v207, v207, v98
    v_add_f32 v207, v207, v99
    v_mfma_f32_16x16x32_bf16 v[120:123], a[180:183], v[36:39], v[120:123]
    ds_read_b64_tr_b16 a[208:209], v184 offset:16384
    v_cvt_pk_bf16_f32 v136, v96, v97
    v_cvt_pk_bf16_f32 v137, v98, v99
    v_mfma_f32_16x16x32_bf16 v[124:127], a[180:183], v[52:55], v[124:127]
    v_exp_f32 v100, v100
    v_mfma_f32_16x16x32_bf16 v[128:131], a[180:183], v[68:71], v[128:131]
    v_exp_f32 v101, v101
    v_mfma_f32_16x16x32_bf16 v[132:135], a[180:183], v[84:87], v[132:135]
    v_exp_f32 v102, v102
    v_mfma_f32_16x16x32_bf16 v[116:119], a[184:187], v[24:27], v[116:119]
    v_exp_f32 v103, v103
    v_mfma_f32_16x16x32_bf16 v[120:123], a[184:187], v[40:43], v[120:123]
    ds_read_b64_tr_b16 a[210:211], v184 offset:20480
    v_add_f32 v208, v208, v100
    v_add_f32 v208, v208, v101
    v_mfma_f32_16x16x32_bf16 v[124:127], a[184:187], v[56:59], v[124:127]
    ds_read_b64_tr_b16 a[212:213], v185 offset:16384
    v_add_f32 v208, v208, v102
    v_add_f32 v208, v208, v103
    v_mfma_f32_16x16x32_bf16 v[128:131], a[184:187], v[72:75], v[128:131]
    ds_read_b64_tr_b16 a[214:215], v185 offset:20480
    v_cvt_pk_bf16_f32 v140, v100, v101
    v_cvt_pk_bf16_f32 v141, v102, v103
    v_mfma_f32_16x16x32_bf16 v[132:135], a[184:187], v[88:91], v[132:135]
    v_exp_f32 v104, v104
    v_mfma_f32_16x16x32_bf16 v[116:119], a[188:191], v[28:31], v[116:119]
    v_exp_f32 v105, v105
    v_mfma_f32_16x16x32_bf16 v[120:123], a[188:191], v[44:47], v[120:123]
    v_exp_f32 v106, v106
    v_mfma_f32_16x16x32_bf16 v[124:127], a[188:191], v[60:63], v[124:127]
    v_exp_f32 v107, v107
    v_mfma_f32_16x16x32_bf16 v[128:131], a[188:191], v[76:79], v[128:131]
    ds_read_b64_tr_b16 a[216:217], v186 offset:16384
    v_add_f32 v209, v209, v104
    v_add_f32 v209, v209, v105
    v_mfma_f32_16x16x32_bf16 v[132:135], a[188:191], v[92:95], v[132:135]
    ds_read_b64_tr_b16 a[218:219], v186 offset:20480
    v_add_f32 v209, v209, v106
    v_add_f32 v209, v209, v107
    s_waitcnt lgkmcnt(2)
    v_mfma_f32_16x16x32_bf16 a[0:3], a[192:195], v[156:159], a[0:3]
    ds_read_b64_tr_b16 a[220:221], v187 offset:16384
    v_cvt_pk_bf16_f32 v144, v104, v105
    v_cvt_pk_bf16_f32 v145, v106, v107
    v_mfma_f32_16x16x32_bf16 a[4:7], a[192:195], v[160:163], a[4:7]
    v_exp_f32 v108, v108
    v_mfma_f32_16x16x32_bf16 a[8:11], a[192:195], v[164:167], a[8:11]
    v_exp_f32 v109, v109
    v_mfma_f32_16x16x32_bf16 a[12:15], a[192:195], v[168:171], a[12:15]
    v_exp_f32 v110, v110
    v_mfma_f32_16x16x32_bf16 a[16:19], a[192:195], v[172:175], a[16:19]
    v_exp_f32 v111, v111
    v_mfma_f32_16x16x32_bf16 a[20:23], a[196:199], v[156:159], a[20:23]
    ds_read_b64_tr_b16 a[222:223], v187 offset:20480
    v_add_f32 v210, v210, v108
    v_add_f32 v210, v210, v109
    v_mfma_f32_16x16x32_bf16 a[24:27], a[196:199], v[160:163], a[24:27]
    v_add_f32 v210, v210, v110
    v_add_f32 v210, v210, v111
    v_mfma_f32_16x16x32_bf16 a[28:31], a[196:199], v[164:167], a[28:31]
    v_cvt_pk_bf16_f32 v148, v108, v109
    v_cvt_pk_bf16_f32 v149, v110, v111
    v_mfma_f32_16x16x32_bf16 a[32:35], a[196:199], v[168:171], a[32:35]
    v_exp_f32 v112, v112
    v_mfma_f32_16x16x32_bf16 a[36:39], a[196:199], v[172:175], a[36:39]
    v_exp_f32 v113, v113
    v_mfma_f32_16x16x32_bf16 a[40:43], a[200:203], v[156:159], a[40:43]
    v_exp_f32 v114, v114
    v_mfma_f32_16x16x32_bf16 a[44:47], a[200:203], v[160:163], a[44:47]
    v_exp_f32 v115, v115
    v_mfma_f32_16x16x32_bf16 a[48:51], a[200:203], v[164:167], a[48:51]
    v_add_f32 v211, v211, v112
    v_add_f32 v211, v211, v113
    v_mfma_f32_16x16x32_bf16 a[52:55], a[200:203], v[168:171], a[52:55]
    v_add_f32 v211, v211, v114
    v_add_f32 v211, v211, v115
    v_mfma_f32_16x16x32_bf16 a[56:59], a[200:203], v[172:175], a[56:59]
    v_cvt_pk_bf16_f32 v152, v112, v113
    v_cvt_pk_bf16_f32 v153, v114, v115
    v_mfma_f32_16x16x32_bf16 a[60:63], a[204:207], v[156:159], a[60:63]
    v_exp_f32 v116, v116
    v_mfma_f32_16x16x32_bf16 a[64:67], a[204:207], v[160:163], a[64:67]
    v_exp_f32 v117, v117
    v_mfma_f32_16x16x32_bf16 a[68:71], a[204:207], v[164:167], a[68:71]
    v_exp_f32 v118, v118
    v_mfma_f32_16x16x32_bf16 a[72:75], a[204:207], v[168:171], a[72:75]
    v_exp_f32 v119, v119
    v_mfma_f32_16x16x32_bf16 a[76:79], a[204:207], v[172:175], a[76:79]
    v_add_f32 v207, v207, v116
    v_add_f32 v207, v207, v117
    v_mfma_f32_16x16x32_bf16 a[80:83], a[208:211], v[156:159], a[80:83]
    v_add_f32 v207, v207, v118
    v_add_f32 v207, v207, v119
    v_mfma_f32_16x16x32_bf16 a[84:87], a[208:211], v[160:163], a[84:87]
    v_cvt_pk_bf16_f32 v138, v116, v117
    v_cvt_pk_bf16_f32 v139, v118, v119
    v_mfma_f32_16x16x32_bf16 a[88:91], a[208:211], v[164:167], a[88:91]
    v_exp_f32 v120, v120
    v_mfma_f32_16x16x32_bf16 a[92:95], a[208:211], v[168:171], a[92:95]
    s_waitcnt lgkmcnt(0)
    v_exp_f32 v121, v121
    v_mfma_f32_16x16x32_bf16 a[96:99], a[208:211], v[172:175], a[96:99]
    s_waitcnt vmcnt(16)
    v_exp_f32 v122, v122
    v_mfma_f32_16x16x32_bf16 a[100:103], a[212:215], v[156:159], a[100:103]
    s_barrier
    v_exp_f32 v123, v123
    v_mfma_f32_16x16x32_bf16 a[104:107], a[212:215], v[160:163], a[104:107]
    ds_read_b128 a[160:163], v176 offset:49152
    v_add_f32 v208, v208, v120
    v_add_f32 v208, v208, v121
    v_mfma_f32_16x16x32_bf16 a[108:111], a[212:215], v[164:167], a[108:111]
    ds_read_b128 a[164:167], v177 offset:49152
    v_add_f32 v208, v208, v122
    v_add_f32 v208, v208, v123
    v_mfma_f32_16x16x32_bf16 a[112:115], a[212:215], v[168:171], a[112:115]
    ds_read_b128 a[168:171], v178 offset:49152
    v_cvt_pk_bf16_f32 v142, v120, v121
    v_cvt_pk_bf16_f32 v143, v122, v123
    v_mfma_f32_16x16x32_bf16 a[116:119], a[212:215], v[172:175], a[116:119]
    v_exp_f32 v124, v124
    v_mfma_f32_16x16x32_bf16 a[120:123], a[216:219], v[156:159], a[120:123]
    v_exp_f32 v125, v125
    v_mfma_f32_16x16x32_bf16 a[124:127], a[216:219], v[160:163], a[124:127]
    v_exp_f32 v126, v126
    v_mfma_f32_16x16x32_bf16 a[128:131], a[216:219], v[164:167], a[128:131]
    v_exp_f32 v127, v127
    v_mfma_f32_16x16x32_bf16 a[132:135], a[216:219], v[168:171], a[132:135]
    ds_read_b128 a[172:175], v179 offset:49152
    v_add_f32 v209, v209, v124
    v_add_f32 v209, v209, v125
    v_mfma_f32_16x16x32_bf16 a[136:139], a[216:219], v[172:175], a[136:139]
    ds_read_b128 a[176:179], v176 offset:53248
    v_add_f32 v209, v209, v126
    v_add_f32 v209, v209, v127
    v_mfma_f32_16x16x32_bf16 a[140:143], a[220:223], v[156:159], a[140:143]
    ds_read_b128 a[180:183], v177 offset:53248
    v_cvt_pk_bf16_f32 v146, v124, v125
    v_cvt_pk_bf16_f32 v147, v126, v127
    v_mfma_f32_16x16x32_bf16 a[144:147], a[220:223], v[160:163], a[144:147]
    v_exp_f32 v128, v128
    v_mfma_f32_16x16x32_bf16 a[148:151], a[220:223], v[164:167], a[148:151]
    v_exp_f32 v129, v129
    v_mfma_f32_16x16x32_bf16 a[152:155], a[220:223], v[168:171], a[152:155]
    v_exp_f32 v130, v130
    v_mfma_f32_16x16x32_bf16 a[156:159], a[220:223], v[172:175], a[156:159]
    v_exp_f32 v131, v131
    s_waitcnt lgkmcnt(2)
    v_mfma_f32_16x16x32_bf16 v[96:99], a[160:163], v[16:19], 0
    ds_read_b128 a[184:187], v178 offset:53248
    v_add_f32 v210, v210, v128
    v_add_f32 v210, v210, v129
    v_mfma_f32_16x16x32_bf16 v[100:103], a[160:163], v[32:35], 0
    ds_read_b128 a[188:191], v179 offset:53248
    v_add_f32 v210, v210, v130
    v_add_f32 v210, v210, v131
    v_mfma_f32_16x16x32_bf16 v[104:107], a[160:163], v[48:51], 0
    v_cvt_pk_bf16_f32 v150, v128, v129
    v_cvt_pk_bf16_f32 v151, v130, v131
    v_mfma_f32_16x16x32_bf16 v[108:111], a[160:163], v[64:67], 0
    v_exp_f32 v132, v132
    v_mfma_f32_16x16x32_bf16 v[112:115], a[160:163], v[80:83], 0
    v_exp_f32 v133, v133
    v_mfma_f32_16x16x32_bf16 v[96:99], a[164:167], v[20:23], v[96:99]
    v_exp_f32 v134, v134
    v_mfma_f32_16x16x32_bf16 v[100:103], a[164:167], v[36:39], v[100:103]
    v_exp_f32 v135, v135
    v_mfma_f32_16x16x32_bf16 v[104:107], a[164:167], v[52:55], v[104:107]
    v_add_f32 v211, v211, v132
    v_add_f32 v211, v211, v133
    v_mfma_f32_16x16x32_bf16 v[108:111], a[164:167], v[68:71], v[108:111]
    v_add_f32 v211, v211, v134
    v_add_f32 v211, v211, v135
    v_mfma_f32_16x16x32_bf16 v[112:115], a[164:167], v[84:87], v[112:115]
    v_cvt_pk_bf16_f32 v154, v132, v133
    v_cvt_pk_bf16_f32 v155, v134, v135
    v_mfma_f32_16x16x32_bf16 v[96:99], a[168:171], v[24:27], v[96:99]
    v_mfma_f32_16x16x32_bf16 v[100:103], a[168:171], v[40:43], v[100:103]
    v_mfma_f32_16x16x32_bf16 v[104:107], a[168:171], v[56:59], v[104:107]
    v_mfma_f32_16x16x32_bf16 v[108:111], a[168:171], v[72:75], v[108:111]
    v_mfma_f32_16x16x32_bf16 v[112:115], a[168:171], v[88:91], v[112:115]
    ds_read_b64_tr_b16 a[192:193], v180 offset:32768
    v_mfma_f32_16x16x32_bf16 v[96:99], a[172:175], v[28:31], v[96:99]
    ds_read_b64_tr_b16 a[194:195], v180 offset:36864
    v_mfma_f32_16x16x32_bf16 v[100:103], a[172:175], v[44:47], v[100:103]
    ds_read_b64_tr_b16 a[196:197], v181 offset:32768
    v_mfma_f32_16x16x32_bf16 v[104:107], a[172:175], v[60:63], v[104:107]
    ds_read_b64_tr_b16 a[198:199], v181 offset:36864
    v_mfma_f32_16x16x32_bf16 v[108:111], a[172:175], v[76:79], v[108:111]
    ds_read_b64_tr_b16 a[200:201], v182 offset:32768
    v_mfma_f32_16x16x32_bf16 v[112:115], a[172:175], v[92:95], v[112:115]
    ds_read_b64_tr_b16 a[202:203], v182 offset:36864
    s_waitcnt lgkmcnt(6)
    v_mfma_f32_16x16x32_bf16 v[116:119], a[176:179], v[16:19], 0
    v_exp_f32 v96, v96
    v_mfma_f32_16x16x32_bf16 v[120:123], a[176:179], v[32:35], 0
    v_exp_f32 v97, v97
    v_mfma_f32_16x16x32_bf16 v[124:127], a[176:179], v[48:51], 0
    v_exp_f32 v98, v98
    v_mfma_f32_16x16x32_bf16 v[128:131], a[176:179], v[64:67], 0
    v_exp_f32 v99, v99
    v_mfma_f32_16x16x32_bf16 v[132:135], a[176:179], v[80:83], 0
    ds_read_b64_tr_b16 a[204:205], v183 offset:32768
    v_add_f32 v207, v207, v96
    v_add_f32 v207, v207, v97
    v_mfma_f32_16x16x32_bf16 v[116:119], a[180:183], v[20:23], v[116:119]
    ds_read_b64_tr_b16 a[206:207], v183 offset:36864
    v_add_f32 v207, v207, v98
    v_add_f32 v207, v207, v99
    v_mfma_f32_16x16x32_bf16 v[120:123], a[180:183], v[36:39], v[120:123]
    ds_read_b64_tr_b16 a[208:209], v184 offset:32768
    v_cvt_pk_bf16_f32 v156, v96, v97
    v_cvt_pk_bf16_f32 v157, v98, v99
    v_mfma_f32_16x16x32_bf16 v[124:127], a[180:183], v[52:55], v[124:127]
    v_exp_f32 v100, v100
    v_mfma_f32_16x16x32_bf16 v[128:131], a[180:183], v[68:71], v[128:131]
    v_exp_f32 v101, v101
    v_mfma_f32_16x16x32_bf16 v[132:135], a[180:183], v[84:87], v[132:135]
    v_exp_f32 v102, v102
    v_mfma_f32_16x16x32_bf16 v[116:119], a[184:187], v[24:27], v[116:119]
    v_exp_f32 v103, v103
    v_mfma_f32_16x16x32_bf16 v[120:123], a[184:187], v[40:43], v[120:123]
    ds_read_b64_tr_b16 a[210:211], v184 offset:36864
    v_add_f32 v208, v208, v100
    v_add_f32 v208, v208, v101
    v_mfma_f32_16x16x32_bf16 v[124:127], a[184:187], v[56:59], v[124:127]
    ds_read_b64_tr_b16 a[212:213], v185 offset:32768
    v_add_f32 v208, v208, v102
    v_add_f32 v208, v208, v103
    v_mfma_f32_16x16x32_bf16 v[128:131], a[184:187], v[72:75], v[128:131]
    ds_read_b64_tr_b16 a[214:215], v185 offset:36864
    v_cvt_pk_bf16_f32 v160, v100, v101
    v_cvt_pk_bf16_f32 v161, v102, v103
    v_mfma_f32_16x16x32_bf16 v[132:135], a[184:187], v[88:91], v[132:135]
    v_exp_f32 v104, v104
    v_mfma_f32_16x16x32_bf16 v[116:119], a[188:191], v[28:31], v[116:119]
    v_exp_f32 v105, v105
    v_mfma_f32_16x16x32_bf16 v[120:123], a[188:191], v[44:47], v[120:123]
    v_exp_f32 v106, v106
    v_mfma_f32_16x16x32_bf16 v[124:127], a[188:191], v[60:63], v[124:127]
    v_exp_f32 v107, v107
    v_mfma_f32_16x16x32_bf16 v[128:131], a[188:191], v[76:79], v[128:131]
    ds_read_b64_tr_b16 a[216:217], v186 offset:32768
    v_add_f32 v209, v209, v104
    v_add_f32 v209, v209, v105
    v_mfma_f32_16x16x32_bf16 v[132:135], a[188:191], v[92:95], v[132:135]
    ds_read_b64_tr_b16 a[218:219], v186 offset:36864
    v_add_f32 v209, v209, v106
    v_add_f32 v209, v209, v107
    s_waitcnt lgkmcnt(2)
    v_mfma_f32_16x16x32_bf16 a[0:3], a[192:195], v[136:139], a[0:3]
    ds_read_b64_tr_b16 a[220:221], v187 offset:32768
    v_cvt_pk_bf16_f32 v164, v104, v105
    v_cvt_pk_bf16_f32 v165, v106, v107
    v_mfma_f32_16x16x32_bf16 a[4:7], a[192:195], v[140:143], a[4:7]
    v_exp_f32 v108, v108
    v_mfma_f32_16x16x32_bf16 a[8:11], a[192:195], v[144:147], a[8:11]
    v_exp_f32 v109, v109
    v_mfma_f32_16x16x32_bf16 a[12:15], a[192:195], v[148:151], a[12:15]
    v_exp_f32 v110, v110
    v_mfma_f32_16x16x32_bf16 a[16:19], a[192:195], v[152:155], a[16:19]
    v_exp_f32 v111, v111
    v_mfma_f32_16x16x32_bf16 a[20:23], a[196:199], v[136:139], a[20:23]
    ds_read_b64_tr_b16 a[222:223], v187 offset:36864
    v_add_f32 v210, v210, v108
    v_add_f32 v210, v210, v109
    v_mfma_f32_16x16x32_bf16 a[24:27], a[196:199], v[140:143], a[24:27]
    v_add_f32 v210, v210, v110
    v_add_f32 v210, v210, v111
    v_mfma_f32_16x16x32_bf16 a[28:31], a[196:199], v[144:147], a[28:31]
    v_cvt_pk_bf16_f32 v168, v108, v109
    v_cvt_pk_bf16_f32 v169, v110, v111
    v_mfma_f32_16x16x32_bf16 a[32:35], a[196:199], v[148:151], a[32:35]
    v_exp_f32 v112, v112
    v_mfma_f32_16x16x32_bf16 a[36:39], a[196:199], v[152:155], a[36:39]
    v_exp_f32 v113, v113
    v_mfma_f32_16x16x32_bf16 a[40:43], a[200:203], v[136:139], a[40:43]
    v_exp_f32 v114, v114
    v_mfma_f32_16x16x32_bf16 a[44:47], a[200:203], v[140:143], a[44:47]
    v_exp_f32 v115, v115
    v_mfma_f32_16x16x32_bf16 a[48:51], a[200:203], v[144:147], a[48:51]
    v_add_f32 v211, v211, v112
    v_add_f32 v211, v211, v113
    v_mfma_f32_16x16x32_bf16 a[52:55], a[200:203], v[148:151], a[52:55]
    v_add_f32 v211, v211, v114
    v_add_f32 v211, v211, v115
    v_mfma_f32_16x16x32_bf16 a[56:59], a[200:203], v[152:155], a[56:59]
    v_cvt_pk_bf16_f32 v172, v112, v113
    v_cvt_pk_bf16_f32 v173, v114, v115
    v_mfma_f32_16x16x32_bf16 a[60:63], a[204:207], v[136:139], a[60:63]
    v_exp_f32 v116, v116
    v_mfma_f32_16x16x32_bf16 a[64:67], a[204:207], v[140:143], a[64:67]
    v_exp_f32 v117, v117
    v_mfma_f32_16x16x32_bf16 a[68:71], a[204:207], v[144:147], a[68:71]
    v_exp_f32 v118, v118
    v_mfma_f32_16x16x32_bf16 a[72:75], a[204:207], v[148:151], a[72:75]
    v_exp_f32 v119, v119
    v_mfma_f32_16x16x32_bf16 a[76:79], a[204:207], v[152:155], a[76:79]
    v_add_f32 v207, v207, v116
    v_add_f32 v207, v207, v117
    v_mfma_f32_16x16x32_bf16 a[80:83], a[208:211], v[136:139], a[80:83]
    v_add_f32 v207, v207, v118
    v_add_f32 v207, v207, v119
    v_mfma_f32_16x16x32_bf16 a[84:87], a[208:211], v[140:143], a[84:87]
    v_cvt_pk_bf16_f32 v158, v116, v117
    v_cvt_pk_bf16_f32 v159, v118, v119
    v_mfma_f32_16x16x32_bf16 a[88:91], a[208:211], v[144:147], a[88:91]
    v_exp_f32 v120, v120
    v_mfma_f32_16x16x32_bf16 a[92:95], a[208:211], v[148:151], a[92:95]
    s_waitcnt lgkmcnt(0)
    v_exp_f32 v121, v121
    v_mfma_f32_16x16x32_bf16 a[96:99], a[208:211], v[152:155], a[96:99]
    s_waitcnt vmcnt(0)
    v_exp_f32 v122, v122
    v_mfma_f32_16x16x32_bf16 a[100:103], a[212:215], v[136:139], a[100:103]
    s_barrier
    v_exp_f32 v123, v123
    v_mfma_f32_16x16x32_bf16 a[104:107], a[212:215], v[140:143], a[104:107]
    s_cmp_eq_u32 s99, 1
    s_cbranch_scc1 L1_hlast
    s_mov_b32 s100, s83
    s_mul_i32 s68, s100, 160
    s_mul_i32 s69, s28, 40
    s_add_u32 s68, s68, s69
    s_mul_i32 s94, s68, 1280
    s_add_u32 s95, s94, 1280
    s_lshl_b32 s68, s96, 6
    s_add_u32 s36, s94, s68
    s_lshl_b32 s68, s30, 17
    s_lshl_b32 s69, s33, 8
    s_add_u32 s92, s68, s69
    s_add_u32 s93, s92, 5242880
    s_lshl_b32 s68, s96, 18
    s_add_u32 s37, s92, s68
    s_mul_i32 s68, s100, 160
    s_mul_i32 s69, s82, 40
    s_add_u32 s68, s68, s69
    s_mul_i32 s68, s68, 1280
    s_mul_i32 s69, s28, 12800
    s_add_u32 s80, s68, s69
    s_mul_i32 s68, s51, 80
    s_mul_i32 s69, s28, 20
    s_add_u32 s68, s68, s69
    s_lshl_b32 s68, s68, 13
    s_sub_u32 s69, s33, s29
    s_lshl_b32 s69, s69, 8
    s_add_u32 s81, s68, s69
    s_mov_b32 m0, s42
    s_nop 0
    buffer_load_dwordx4 v200, s[12:15], s37 offen lds
    buffer_load_dwordx4 v201, s[12:15], s37 offen offset:1024 lds
    buffer_load_dwordx4 v202, s[12:15], s37 offen offset:2048 lds
    buffer_load_dwordx4 v203, s[12:15], s37 offen offset:3072 lds
    s_add_u32 s37, s37, 262144
    s_cmp_lt_u32 s37, s93
    s_cselect_b32 s37, s37, s92
    s_add_u32 m0, s43, 40960
    s_nop 0
    buffer_load_dwordx4 v234, s[8:11], s36 offen lds
    buffer_load_dwordx4 v235, s[8:11], s36 offen offset:1024 lds
    buffer_load_dwordx4 v236, s[8:11], s36 offen offset:2048 lds
    buffer_load_dwordx4 v237, s[8:11], s36 offen offset:3072 lds
    s_add_u32 m0, m0, 4096
    s_nop 0
    buffer_load_dwordx4 v238, s[8:11], s36 offen lds
    s_add_u32 s36, s36, 128
    s_cmp_lt_u32 s36, s95
    s_cselect_b32 s36, s36, s94
    s_add_u32 m0, s42, 16384
    s_nop 0
    buffer_load_dwordx4 v200, s[12:15], s37 offen lds
    buffer_load_dwordx4 v201, s[12:15], s37 offen offset:1024 lds
    buffer_load_dwordx4 v202, s[12:15], s37 offen offset:2048 lds
    buffer_load_dwordx4 v203, s[12:15], s37 offen offset:3072 lds
    s_add_u32 s37, s37, 262144
    s_cmp_lt_u32 s37, s93
    s_cselect_b32 s37, s37, s92
    s_add_u32 m0, s42, 32768
    s_nop 0
    buffer_load_dwordx4 v200, s[12:15], s37 offen lds
    buffer_load_dwordx4 v201, s[12:15], s37 offen offset:1024 lds
    buffer_load_dwordx4 v202, s[12:15], s37 offen offset:2048 lds
    buffer_load_dwordx4 v203, s[12:15], s37 offen offset:3072 lds
    s_add_u32 s37, s37, 262144
    s_cmp_lt_u32 s37, s93
    s_cselect_b32 s37, s37, s92
    s_mov_b32 m0, s43
    s_nop 0
    buffer_load_dwordx4 v234, s[8:11], s36 offen lds
    buffer_load_dwordx4 v235, s[8:11], s36 offen offset:1024 lds
    buffer_load_dwordx4 v236, s[8:11], s36 offen offset:2048 lds
    buffer_load_dwordx4 v237, s[8:11], s36 offen offset:3072 lds
    s_add_u32 m0, m0, 4096
    s_nop 0
    buffer_load_dwordx4 v238, s[8:11], s36 offen lds
    s_add_u32 s36, s36, 128
    s_cmp_lt_u32 s36, s95
    s_cselect_b32 s36, s36, s94
    buffer_load_dword v12, v213, s[8:11], s80 offen
    buffer_load_dword v12, v214, s[12:15], s81 offen
    buffer_load_dword v12, v239, s[8:11], s80 offen
    buffer_load_dword v12, v240, s[12:15], s81 offen
    s_add_u32 s38, s43, 20480
    s_mov_b32 s39, 40960
    s_branch L1_hend
L1_hlast:
    s_and_b32 s68, s2, 127
    s_mul_i32 s68, s68, 40960
    s_mul_i32 s69, s28, 10240
    s_add_u32 s68, s68, s69
    s_add_u32 m0, s69, 0
    s_nop 0
    buffer_load_dwordx4 v212, s[88:91], s68 offen lds
    buffer_load_dwordx4 v212, s[88:91], s68 offen offset:1024 lds
    buffer_load_dwordx4 v212, s[88:91], s68 offen offset:2048 lds
    buffer_load_dwordx4 v212, s[88:91], s68 offen offset:3072 lds
    s_add_u32 s68, s68, 4096
    s_add_u32 m0, s69, 4096
    s_nop 0
    buffer_load_dwordx4 v212, s[88:91], s68 offen lds
    buffer_load_dwordx4 v212, s[88:91], s68 offen offset:1024 lds
    buffer_load_dwordx4 v212, s[88:91], s68 offen offset:2048 lds
    buffer_load_dwordx4 v212, s[88:91], s68 offen offset:3072 lds
    s_add_u32 s68, s68, 4096
    s_add_u32 m0, s69, 8192
    s_nop 0
    buffer_load_dwordx4 v212, s[88:91], s68 offen lds
    buffer_load_dwordx4 v212, s[88:91], s68 offen offset:1024 lds
    s_add_u32 s68, s68, 4096
L1_hend:
    v_add_f32 v208, v208, v120
    v_add_f32 v208, v208, v121
    v_mfma_f32_16x16x32_bf16 a[108:111], a[212:215], v[144:147], a[108:111]
    v_add_f32 v208, v208, v122
    v_add_f32 v208, v208, v123
    v_mfma_f32_16x16x32_bf16 a[112:115], a[212:215], v[148:151], a[112:115]
    v_cvt_pk_bf16_f32 v162, v120, v121
    v_cvt_pk_bf16_f32 v163, v122, v123
    v_mfma_f32_16x16x32_bf16 a[116:119], a[212:215], v[152:155], a[116:119]
    v_exp_f32 v124, v124
    v_mfma_f32_16x16x32_bf16 a[120:123], a[216:219], v[136:139], a[120:123]
    v_exp_f32 v125, v125
    v_mfma_f32_16x16x32_bf16 a[124:127], a[216:219], v[140:143], a[124:127]
    v_exp_f32 v126, v126
    v_mfma_f32_16x16x32_bf16 a[128:131], a[216:219], v[144:147], a[128:131]
    v_exp_f32 v127, v127
    v_mfma_f32_16x16x32_bf16 a[132:135], a[216:219], v[148:151], a[132:135]
    v_add_f32 v209, v209, v124
    v_add_f32 v209, v209, v125
    v_mfma_f32_16x16x32_bf16 a[136:139], a[216:219], v[152:155], a[136:139]
    v_add_f32 v209, v209, v126
    v_add_f32 v209, v209, v127
    v_mfma_f32_16x16x32_bf16 a[140:143], a[220:223], v[136:139], a[140:143]
    v_cvt_pk_bf16_f32 v166, v124, v125
    v_cvt_pk_bf16_f32 v167, v126, v127
    v_mfma_f32_16x16x32_bf16 a[144:147], a[220:223], v[140:143], a[144:147]
    v_exp_f32 v128, v128
    v_mfma_f32_16x16x32_bf16 a[148:151], a[220:223], v[144:147], a[148:151]
    v_exp_f32 v129, v129
    v_mfma_f32_16x16x32_bf16 a[152:155], a[220:223], v[148:151], a[152:155]
    v_exp_f32 v130, v130
    v_mfma_f32_16x16x32_bf16 a[156:159], a[220:223], v[152:155], a[156:159]
    v_exp_f32 v131, v131
    v_add_f32 v210, v210, v128
    v_add_f32 v210, v210, v129
    v_add_f32 v210, v210, v130
    v_add_f32 v210, v210, v131
    v_cvt_pk_bf16_f32 v170, v128, v129
    v_cvt_pk_bf16_f32 v171, v130, v131
    v_exp_f32 v132, v132
    v_exp_f32 v133, v133
    v_exp_f32 v134, v134
    v_exp_f32 v135, v135
    v_add_f32 v211, v211, v132
    v_add_f32 v211, v211, v133
    v_add_f32 v211, v211, v134
    v_add_f32 v211, v211, v135
    v_cvt_pk_bf16_f32 v174, v132, v133
    v_cvt_pk_bf16_f32 v175, v134, v135
    ds_read_b64_tr_b16 a[192:193], v180 offset:49152
    ds_read_b64_tr_b16 a[194:195], v180 offset:53248
    ds_read_b64_tr_b16 a[196:197], v181 offset:49152
    ds_read_b64_tr_b16 a[198:199], v181 offset:53248
    ds_read_b64_tr_b16 a[200:201], v182 offset:49152
    ds_read_b64_tr_b16 a[202:203], v182 offset:53248
    ds_read_b64_tr_b16 a[204:205], v183 offset:49152
    ds_read_b64_tr_b16 a[206:207], v183 offset:53248
    ds_read_b64_tr_b16 a[208:209], v184 offset:49152
    ds_read_b64_tr_b16 a[210:211], v184 offset:53248
    ds_read_b64_tr_b16 a[212:213], v185 offset:49152
    ds_read_b64_tr_b16 a[214:215], v185 offset:53248
    ds_read_b64_tr_b16 a[216:217], v186 offset:49152
    ds_read_b64_tr_b16 a[218:219], v186 offset:53248
    s_waitcnt lgkmcnt(12)
    v_mfma_f32_16x16x32_bf16 a[0:3], a[192:195], v[156:159], a[0:3]
    ds_read_b64_tr_b16 a[220:221], v187 offset:49152
    v_mfma_f32_16x16x32_bf16 a[4:7], a[192:195], v[160:163], a[4:7]
    v_mfma_f32_16x16x32_bf16 a[8:11], a[192:195], v[164:167], a[8:11]
    v_mfma_f32_16x16x32_bf16 a[12:15], a[192:195], v[168:171], a[12:15]
    v_mfma_f32_16x16x32_bf16 a[16:19], a[192:195], v[172:175], a[16:19]
    s_waitcnt lgkmcnt(11)
    v_mfma_f32_16x16x32_bf16 a[20:23], a[196:199], v[156:159], a[20:23]
    ds_read_b64_tr_b16 a[222:223], v187 offset:53248
    v_mfma_f32_16x16x32_bf16 a[24:27], a[196:199], v[160:163], a[24:27]
    v_mfma_f32_16x16x32_bf16 a[28:31], a[196:199], v[164:167], a[28:31]
    v_mfma_f32_16x16x32_bf16 a[32:35], a[196:199], v[168:171], a[32:35]
    v_mfma_f32_16x16x32_bf16 a[36:39], a[196:199], v[172:175], a[36:39]
    s_waitcnt lgkmcnt(1)
    v_mfma_f32_16x16x32_bf16 a[40:43], a[200:203], v[156:159], a[40:43]
    v_mfma_f32_16x16x32_bf16 a[44:47], a[200:203], v[160:163], a[44:47]
    v_mfma_f32_16x16x32_bf16 a[48:51], a[200:203], v[164:167], a[48:51]
    v_mfma_f32_16x16x32_bf16 a[52:55], a[200:203], v[168:171], a[52:55]
    v_mfma_f32_16x16x32_bf16 a[56:59], a[200:203], v[172:175], a[56:59]
    v_mfma_f32_16x16x32_bf16 a[60:63], a[204:207], v[156:159], a[60:63]
    v_mfma_f32_16x16x32_bf16 a[64:67], a[204:207], v[160:163], a[64:67]
    v_mfma_f32_16x16x32_bf16 a[68:71], a[204:207], v[164:167], a[68:71]
    v_mfma_f32_16x16x32_bf16 a[72:75], a[204:207], v[168:171], a[72:75]
    v_mfma_f32_16x16x32_bf16 a[76:79], a[204:207], v[172:175], a[76:79]
    v_mfma_f32_16x16x32_bf16 a[80:83], a[208:211], v[156:159], a[80:83]
    v_mfma_f32_16x16x32_bf16 a[84:87], a[208:211], v[160:163], a[84:87]
    v_mfma_f32_16x16x32_bf16 a[88:91], a[208:211], v[164:167], a[88:91]
    v_mfma_f32_16x16x32_bf16 a[92:95], a[208:211], v[168:171], a[92:95]
    v_mfma_f32_16x16x32_bf16 a[96:99], a[208:211], v[172:175], a[96:99]
    v_mfma_f32_16x16x32_bf16 a[100:103], a[212:215], v[156:159], a[100:103]
    v_mfma_f32_16x16x32_bf16 a[104:107], a[212:215], v[160:163], a[104:107]
    v_mfma_f32_16x16x32_bf16 a[108:111], a[212:215], v[164:167], a[108:111]
    v_mfma_f32_16x16x32_bf16 a[112:115], a[212:215], v[168:171], a[112:115]
    v_mfma_f32_16x16x32_bf16 a[116:119], a[212:215], v[172:175], a[116:119]
    v_mfma_f32_16x16x32_bf16 a[120:123], a[216:219], v[156:159], a[120:123]
    v_mfma_f32_16x16x32_bf16 a[124:127], a[216:219], v[160:163], a[124:127]
    v_mfma_f32_16x16x32_bf16 a[128:131], a[216:219], v[164:167], a[128:131]
    v_mfma_f32_16x16x32_bf16 a[132:135], a[216:219], v[168:171], a[132:135]
    v_mfma_f32_16x16x32_bf16 a[136:139], a[216:219], v[172:175], a[136:139]
    s_waitcnt lgkmcnt(0)
    v_mfma_f32_16x16x32_bf16 a[140:143], a[220:223], v[156:159], a[140:143]
    v_mfma_f32_16x16x32_bf16 a[144:147], a[220:223], v[160:163], a[144:147]
    v_mfma_f32_16x16x32_bf16 a[148:151], a[220:223], v[164:167], a[148:151]
    v_mfma_f32_16x16x32_bf16 a[152:155], a[220:223], v[168:171], a[152:155]
    v_mfma_f32_16x16x32_bf16 a[156:159], a[220:223], v[172:175], a[156:159]
    s_mov_b32 s49, 0
L1_epi:
    s_nop 7
    v_mov_b32 v216, v207
    v_mov_b32 v217, v207
    v_mov_b32 v218, v208
    v_mov_b32 v219, v208
    v_mov_b32 v220, v209
    v_mov_b32 v221, v209
    v_mov_b32 v222, v210
    v_mov_b32 v223, v210
    v_mov_b32 v224, v211
    v_mov_b32 v225, v211
    s_nop 1
    v_permlane32_swap_b32 v216, v217
    v_permlane32_swap_b32 v218, v219
    v_permlane32_swap_b32 v220, v221
    v_permlane32_swap_b32 v222, v223
    v_permlane32_swap_b32 v224, v225
    s_nop 1
    v_add_f32 v216, v216, v217
    v_add_f32 v218, v218, v219
    v_add_f32 v220, v220, v221
    v_add_f32 v222, v222, v223
    v_add_f32 v224, v224, v225
    v_mov_b32 v217, v216
    v_mov_b32 v219, v218
    v_mov_b32 v221, v220
    v_mov_b32 v223, v222
    v_mov_b32 v225, v224
    s_nop 1
    v_permlane16_swap_b32 v216, v217
    v_permlane16_swap_b32 v218, v219
    v_permlane16_swap_b32 v220, v221
    v_permlane16_swap_b32 v222, v223
    v_permlane16_swap_b32 v224, v225
    s_nop 1
    v_add_f32 v207, v216, v217
    v_add_f32 v208, v218, v219
    v_add_f32 v209, v220, v221
    v_add_f32 v210, v222, v223
    v_add_f32 v211, v224, v225
    s_mov_b32 s68, 0x38800000
    s_mov_b32 s69, 0x49800000
    v_mov_b32 v133, s69
    s_mov_b64 s[74:75], 0
    v_med3_f32 v132, v207, s68, v133
    v_cmp_neq_f32 vcc, v132, v207
    s_nop 1
    s_or_b64 s[74:75], s[74:75], vcc
    v_med3_f32 v132, v208, s68, v133
    v_cmp_neq_f32 vcc, v132, v208
    s_nop 1
    s_or_b64 s[74:75], s[74:75], vcc
    v_med3_f32 v132, v209, s68, v133
    v_cmp_neq_f32 vcc, v132, v209
    s_nop 1
    s_or_b64 s[74:75], s[74:75], vcc
    v_med3_f32 v132, v210, s68, v133
    v_cmp_neq_f32 vcc, v132, v210
    s_nop 1
    s_or_b64 s[74:75], s[74:75], vcc
    v_med3_f32 v132, v211, s68, v133
    v_cmp_neq_f32 vcc, v132, v211
    s_nop 1
    s_or_b64 s[74:75], s[74:75], vcc
    s_cmp_lg_u64 s[74:75], 0
    s_cselect_b32 s68, 1, 0
    s_lshl_b32 s69, s28, 2
    s_add_u32 s69, s69, 61440
    v_mov_b32 v132, s68
    v_mov_b32 v133, s69
    ds_write_b32 v133, v132
    v_rcp_f32 v216, v207
    v_rcp_f32 v218, v208
    v_rcp_f32 v220, v209
    v_rcp_f32 v222, v210
    v_rcp_f32 v224, v211
    s_nop 0
    v_mov_b32 v217, v216
    v_mov_b32 v219, v218
    v_mov_b32 v221, v220
    v_mov_b32 v223, v222
    v_mov_b32 v225, v224
    v_accvgpr_read_b32 v96, a0
    v_accvgpr_read_b32 v97, a1
    v_accvgpr_read_b32 v98, a2
    v_accvgpr_read_b32 v99, a3
    v_accvgpr_read_b32 v100, a20
    v_accvgpr_read_b32 v101, a21
    v_accvgpr_read_b32 v102, a22
    v_accvgpr_read_b32 v103, a23
    v_pk_mul_f32 v[96:97], v[96:97], v[216:217]
    v_pk_mul_f32 v[98:99], v[98:99], v[216:217]
    v_pk_mul_f32 v[100:101], v[100:101], v[216:217]
    v_pk_mul_f32 v[102:103], v[102:103], v[216:217]
    v_cvt_pk_bf16_f32 v104, v96, v97
    v_cvt_pk_bf16_f32 v105, v98, v99
    v_cvt_pk_bf16_f32 v106, v100, v101
    v_cvt_pk_bf16_f32 v107, v102, v103
    s_add_u32 s68, s48, 0
    buffer_store_dwordx4 v[104:107], v212, s[24:27], s68 offen sc1
    v_accvgpr_read_b32 v108, a40
    v_accvgpr_read_b32 v109, a41
    v_accvgpr_read_b32 v110, a42
    v_accvgpr_read_b32 v111, a43
    v_accvgpr_read_b32 v112, a60
    v_accvgpr_read_b32 v113, a61
    v_accvgpr_read_b32 v114, a62
    v_accvgpr_read_b32 v115, a63
    v_pk_mul_f32 v[108:109], v[108:109], v[216:217]
    v_pk_mul_f32 v[110:111], v[110:111], v[216:217]
    v_pk_mul_f32 v[112:113], v[112:113], v[216:217]
    v_pk_mul_f32 v[114:115], v[114:115], v[216:217]
    v_cvt_pk_bf16_f32 v116, v108, v109
    v_cvt_pk_bf16_f32 v117, v110, v111
    v_cvt_pk_bf16_f32 v118, v112, v113
    v_cvt_pk_bf16_f32 v119, v114, v115
    s_add_u32 s68, s48, 1024
    buffer_store_dwordx4 v[116:119], v212, s[24:27], s68 offen sc1
    v_accvgpr_read_b32 v120, a80
    v_accvgpr_read_b32 v121, a81
    v_accvgpr_read_b32 v122, a82
    v_accvgpr_read_b32 v123, a83
    v_accvgpr_read_b32 v124, a100
    v_accvgpr_read_b32 v125, a101
    v_accvgpr_read_b32 v126, a102
    v_accvgpr_read_b32 v127, a103
    v_pk_mul_f32 v[120:121], v[120:121], v[216:217]
    v_pk_mul_f32 v[122:123], v[122:123], v[216:217]
    v_pk_mul_f32 v[124:125], v[124:125], v[216:217]
    v_pk_mul_f32 v[126:127], v[126:127], v[216:217]
    v_cvt_pk_bf16_f32 v128, v120, v121
    v_cvt_pk_bf16_f32 v129, v122, v123
    v_cvt_pk_bf16_f32 v130, v124, v125
    v_cvt_pk_bf16_f32 v131, v126, v127
    s_add_u32 s68, s48, 2048
    buffer_store_dwordx4 v[128:131], v212, s[24:27], s68 offen sc1
    v_accvgpr_read_b32 v96, a120
    v_accvgpr_read_b32 v97, a121
    v_accvgpr_read_b32 v98, a122
    v_accvgpr_read_b32 v99, a123
    v_accvgpr_read_b32 v100, a140
    v_accvgpr_read_b32 v101, a141
    v_accvgpr_read_b32 v102, a142
    v_accvgpr_read_b32 v103, a143
    v_pk_mul_f32 v[96:97], v[96:97], v[216:217]
    v_pk_mul_f32 v[98:99], v[98:99], v[216:217]
    v_pk_mul_f32 v[100:101], v[100:101], v[216:217]
    v_pk_mul_f32 v[102:103], v[102:103], v[216:217]
    v_cvt_pk_bf16_f32 v104, v96, v97
    v_cvt_pk_bf16_f32 v105, v98, v99
    v_cvt_pk_bf16_f32 v106, v100, v101
    v_cvt_pk_bf16_f32 v107, v102, v103
    s_add_u32 s68, s48, 3072
    buffer_store_dwordx4 v[104:107], v212, s[24:27], s68 offen sc1
    v_accvgpr_read_b32 v108, a4
    v_accvgpr_read_b32 v109, a5
    v_accvgpr_read_b32 v110, a6
    v_accvgpr_read_b32 v111, a7
    v_accvgpr_read_b32 v112, a24
    v_accvgpr_read_b32 v113, a25
    v_accvgpr_read_b32 v114, a26
    v_accvgpr_read_b32 v115, a27
    v_pk_mul_f32 v[108:109], v[108:109], v[218:219]
    v_pk_mul_f32 v[110:111], v[110:111], v[218:219]
    v_pk_mul_f32 v[112:113], v[112:113], v[218:219]
    v_pk_mul_f32 v[114:115], v[114:115], v[218:219]
    v_cvt_pk_bf16_f32 v116, v108, v109
    v_cvt_pk_bf16_f32 v117, v110, v111
    v_cvt_pk_bf16_f32 v118, v112, v113
    v_cvt_pk_bf16_f32 v119, v114, v115
    s_add_u32 s68, s48, 131072
    buffer_store_dwordx4 v[116:119], v212, s[24:27], s68 offen sc1
    v_accvgpr_read_b32 v120, a44
    v_accvgpr_read_b32 v121, a45
    v_accvgpr_read_b32 v122, a46
    v_accvgpr_read_b32 v123, a47
    v_accvgpr_read_b32 v124, a64
    v_accvgpr_read_b32 v125, a65
    v_accvgpr_read_b32 v126, a66
    v_accvgpr_read_b32 v127, a67
    v_pk_mul_f32 v[120:121], v[120:121], v[218:219]
    v_pk_mul_f32 v[122:123], v[122:123], v[218:219]
    v_pk_mul_f32 v[124:125], v[124:125], v[218:219]
    v_pk_mul_f32 v[126:127], v[126:127], v[218:219]
    v_cvt_pk_bf16_f32 v128, v120, v121
    v_cvt_pk_bf16_f32 v129, v122, v123
    v_cvt_pk_bf16_f32 v130, v124, v125
    v_cvt_pk_bf16_f32 v131, v126, v127
    s_add_u32 s68, s48, 132096
    buffer_store_dwordx4 v[128:131], v212, s[24:27], s68 offen sc1
    v_accvgpr_read_b32 v96, a84
    v_accvgpr_read_b32 v97, a85
    v_accvgpr_read_b32 v98, a86
    v_accvgpr_read_b32 v99, a87
    v_accvgpr_read_b32 v100, a104
    v_accvgpr_read_b32 v101, a105
    v_accvgpr_read_b32 v102, a106
    v_accvgpr_read_b32 v103, a107
    v_pk_mul_f32 v[96:97], v[96:97], v[218:219]
    v_pk_mul_f32 v[98:99], v[98:99], v[218:219]
    v_pk_mul_f32 v[100:101], v[100:101], v[218:219]
    v_pk_mul_f32 v[102:103], v[102:103], v[218:219]
    v_cvt_pk_bf16_f32 v104, v96, v97
    v_cvt_pk_bf16_f32 v105, v98, v99
    v_cvt_pk_bf16_f32 v106, v100, v101
    v_cvt_pk_bf16_f32 v107, v102, v103
    s_add_u32 s68, s48, 133120
    buffer_store_dwordx4 v[104:107], v212, s[24:27], s68 offen sc1
    v_accvgpr_read_b32 v108, a124
    v_accvgpr_read_b32 v109, a125
    v_accvgpr_read_b32 v110, a126
    v_accvgpr_read_b32 v111, a127
    v_accvgpr_read_b32 v112, a144
    v_accvgpr_read_b32 v113, a145
    v_accvgpr_read_b32 v114, a146
    v_accvgpr_read_b32 v115, a147
    v_pk_mul_f32 v[108:109], v[108:109], v[218:219]
    v_pk_mul_f32 v[110:111], v[110:111], v[218:219]
    v_pk_mul_f32 v[112:113], v[112:113], v[218:219]
    v_pk_mul_f32 v[114:115], v[114:115], v[218:219]
    v_cvt_pk_bf16_f32 v116, v108, v109
    v_cvt_pk_bf16_f32 v117, v110, v111
    v_cvt_pk_bf16_f32 v118, v112, v113
    v_cvt_pk_bf16_f32 v119, v114, v115
    s_add_u32 s68, s48, 134144
    buffer_store_dwordx4 v[116:119], v212, s[24:27], s68 offen sc1
    v_accvgpr_read_b32 v120, a8
    v_accvgpr_read_b32 v121, a9
    v_accvgpr_read_b32 v122, a10
    v_accvgpr_read_b32 v123, a11
    v_accvgpr_read_b32 v124, a28
    v_accvgpr_read_b32 v125, a29
    v_accvgpr_read_b32 v126, a30
    v_accvgpr_read_b32 v127, a31
    v_pk_mul_f32 v[120:121], v[120:121], v[220:221]
    v_pk_mul_f32 v[122:123], v[122:123], v[220:221]
    v_pk_mul_f32 v[124:125], v[124:125], v[220:221]
    v_pk_mul_f32 v[126:127], v[126:127], v[220:221]
    v_cvt_pk_bf16_f32 v128, v120, v121
    v_cvt_pk_bf16_f32 v129, v122, v123
    v_cvt_pk_bf16_f32 v130, v124, v125
    v_cvt_pk_bf16_f32 v131, v126, v127
    s_add_u32 s68, s48, 262144
    buffer_store_dwordx4 v[128:131], v212, s[24:27], s68 offen sc1
    v_accvgpr_read_b32 v96, a48
    v_accvgpr_read_b32 v97, a49
    v_accvgpr_read_b32 v98, a50
    v_accvgpr_read_b32 v99, a51
    v_accvgpr_read_b32 v100, a68
    v_accvgpr_read_b32 v101, a69
    v_accvgpr_read_b32 v102, a70
    v_accvgpr_read_b32 v103, a71
    v_pk_mul_f32 v[96:97], v[96:97], v[220:221]
    v_pk_mul_f32 v[98:99], v[98:99], v[220:221]
    v_pk_mul_f32 v[100:101], v[100:101], v[220:221]
    v_pk_mul_f32 v[102:103], v[102:103], v[220:221]
    v_cvt_pk_bf16_f32 v104, v96, v97
    v_cvt_pk_bf16_f32 v105, v98, v99
    v_cvt_pk_bf16_f32 v106, v100, v101
    v_cvt_pk_bf16_f32 v107, v102, v103
    s_add_u32 s68, s48, 263168
    buffer_store_dwordx4 v[104:107], v212, s[24:27], s68 offen sc1
    v_accvgpr_read_b32 v108, a88
    v_accvgpr_read_b32 v109, a89
    v_accvgpr_read_b32 v110, a90
    v_accvgpr_read_b32 v111, a91
    v_accvgpr_read_b32 v112, a108
    v_accvgpr_read_b32 v113, a109
    v_accvgpr_read_b32 v114, a110
    v_accvgpr_read_b32 v115, a111
    v_pk_mul_f32 v[108:109], v[108:109], v[220:221]
    v_pk_mul_f32 v[110:111], v[110:111], v[220:221]
    v_pk_mul_f32 v[112:113], v[112:113], v[220:221]
    v_pk_mul_f32 v[114:115], v[114:115], v[220:221]
    v_cvt_pk_bf16_f32 v116, v108, v109
    v_cvt_pk_bf16_f32 v117, v110, v111
    v_cvt_pk_bf16_f32 v118, v112, v113
    v_cvt_pk_bf16_f32 v119, v114, v115
    s_add_u32 s68, s48, 264192
    buffer_store_dwordx4 v[116:119], v212, s[24:27], s68 offen sc1
    v_accvgpr_read_b32 v120, a128
    v_accvgpr_read_b32 v121, a129
    v_accvgpr_read_b32 v122, a130
    v_accvgpr_read_b32 v123, a131
    v_accvgpr_read_b32 v124, a148
    v_accvgpr_read_b32 v125, a149
    v_accvgpr_read_b32 v126, a150
    v_accvgpr_read_b32 v127, a151
    v_pk_mul_f32 v[120:121], v[120:121], v[220:221]
    v_pk_mul_f32 v[122:123], v[122:123], v[220:221]
    v_pk_mul_f32 v[124:125], v[124:125], v[220:221]
    v_pk_mul_f32 v[126:127], v[126:127], v[220:221]
    v_cvt_pk_bf16_f32 v128, v120, v121
    v_cvt_pk_bf16_f32 v129, v122, v123
    v_cvt_pk_bf16_f32 v130, v124, v125
    v_cvt_pk_bf16_f32 v131, v126, v127
    s_add_u32 s68, s48, 265216
    buffer_store_dwordx4 v[128:131], v212, s[24:27], s68 offen sc1
    v_accvgpr_read_b32 v96, a12
    v_accvgpr_read_b32 v97, a13
    v_accvgpr_read_b32 v98, a14
    v_accvgpr_read_b32 v99, a15
    v_accvgpr_read_b32 v100, a32
    v_accvgpr_read_b32 v101, a33
    v_accvgpr_read_b32 v102, a34
    v_accvgpr_read_b32 v103, a35
    v_pk_mul_f32 v[96:97], v[96:97], v[222:223]
    v_pk_mul_f32 v[98:99], v[98:99], v[222:223]
    v_pk_mul_f32 v[100:101], v[100:101], v[222:223]
    v_pk_mul_f32 v[102:103], v[102:103], v[222:223]
    v_cvt_pk_bf16_f32 v104, v96, v97
    v_cvt_pk_bf16_f32 v105, v98, v99
    v_cvt_pk_bf16_f32 v106, v100, v101
    v_cvt_pk_bf16_f32 v107, v102, v103
    s_add_u32 s68, s48, 393216
    buffer_store_dwordx4 v[104:107], v212, s[24:27], s68 offen sc1
    v_accvgpr_read_b32 v108, a52
    v_accvgpr_read_b32 v109, a53
    v_accvgpr_read_b32 v110, a54
    v_accvgpr_read_b32 v111, a55
    v_accvgpr_read_b32 v112, a72
    v_accvgpr_read_b32 v113, a73
    v_accvgpr_read_b32 v114, a74
    v_accvgpr_read_b32 v115, a75
    v_pk_mul_f32 v[108:109], v[108:109], v[222:223]
    v_pk_mul_f32 v[110:111], v[110:111], v[222:223]
    v_pk_mul_f32 v[112:113], v[112:113], v[222:223]
    v_pk_mul_f32 v[114:115], v[114:115], v[222:223]
    v_cvt_pk_bf16_f32 v116, v108, v109
    v_cvt_pk_bf16_f32 v117, v110, v111
    v_cvt_pk_bf16_f32 v118, v112, v113
    v_cvt_pk_bf16_f32 v119, v114, v115
    s_add_u32 s68, s48, 394240
    buffer_store_dwordx4 v[116:119], v212, s[24:27], s68 offen sc1
    v_accvgpr_read_b32 v120, a92
    v_accvgpr_read_b32 v121, a93
    v_accvgpr_read_b32 v122, a94
    v_accvgpr_read_b32 v123, a95
    v_accvgpr_read_b32 v124, a112
    v_accvgpr_read_b32 v125, a113
    v_accvgpr_read_b32 v126, a114
    v_accvgpr_read_b32 v127, a115
    v_pk_mul_f32 v[120:121], v[120:121], v[222:223]
    v_pk_mul_f32 v[122:123], v[122:123], v[222:223]
    v_pk_mul_f32 v[124:125], v[124:125], v[222:223]
    v_pk_mul_f32 v[126:127], v[126:127], v[222:223]
    v_cvt_pk_bf16_f32 v128, v120, v121
    v_cvt_pk_bf16_f32 v129, v122, v123
    v_cvt_pk_bf16_f32 v130, v124, v125
    v_cvt_pk_bf16_f32 v131, v126, v127
    s_add_u32 s68, s48, 395264
    buffer_store_dwordx4 v[128:131], v212, s[24:27], s68 offen sc1
    v_accvgpr_read_b32 v96, a132
    v_accvgpr_read_b32 v97, a133
    v_accvgpr_read_b32 v98, a134
    v_accvgpr_read_b32 v99, a135
    v_accvgpr_read_b32 v100, a152
    v_accvgpr_read_b32 v101, a153
    v_accvgpr_read_b32 v102, a154
    v_accvgpr_read_b32 v103, a155
    v_pk_mul_f32 v[96:97], v[96:97], v[222:223]
    v_pk_mul_f32 v[98:99], v[98:99], v[222:223]
    v_pk_mul_f32 v[100:101], v[100:101], v[222:223]
    v_pk_mul_f32 v[102:103], v[102:103], v[222:223]
    v_cvt_pk_bf16_f32 v104, v96, v97
    v_cvt_pk_bf16_f32 v105, v98, v99
    v_cvt_pk_bf16_f32 v106, v100, v101
    v_cvt_pk_bf16_f32 v107, v102, v103
    s_add_u32 s68, s48, 396288
    buffer_store_dwordx4 v[104:107], v212, s[24:27], s68 offen sc1
    v_accvgpr_read_b32 v108, a16
    v_accvgpr_read_b32 v109, a17
    v_accvgpr_read_b32 v110, a18
    v_accvgpr_read_b32 v111, a19
    v_accvgpr_read_b32 v112, a36
    v_accvgpr_read_b32 v113, a37
    v_accvgpr_read_b32 v114, a38
    v_accvgpr_read_b32 v115, a39
    v_pk_mul_f32 v[108:109], v[108:109], v[224:225]
    v_pk_mul_f32 v[110:111], v[110:111], v[224:225]
    v_pk_mul_f32 v[112:113], v[112:113], v[224:225]
    v_pk_mul_f32 v[114:115], v[114:115], v[224:225]
    v_cvt_pk_bf16_f32 v116, v108, v109
    v_cvt_pk_bf16_f32 v117, v110, v111
    v_cvt_pk_bf16_f32 v118, v112, v113
    v_cvt_pk_bf16_f32 v119, v114, v115
    s_add_u32 s68, s48, 524288
    buffer_store_dwordx4 v[116:119], v212, s[24:27], s68 offen sc1
    v_accvgpr_read_b32 v120, a56
    v_accvgpr_read_b32 v121, a57
    v_accvgpr_read_b32 v122, a58
    v_accvgpr_read_b32 v123, a59
    v_accvgpr_read_b32 v124, a76
    v_accvgpr_read_b32 v125, a77
    v_accvgpr_read_b32 v126, a78
    v_accvgpr_read_b32 v127, a79
    v_pk_mul_f32 v[120:121], v[120:121], v[224:225]
    v_pk_mul_f32 v[122:123], v[122:123], v[224:225]
    v_pk_mul_f32 v[124:125], v[124:125], v[224:225]
    v_pk_mul_f32 v[126:127], v[126:127], v[224:225]
    v_cvt_pk_bf16_f32 v128, v120, v121
    v_cvt_pk_bf16_f32 v129, v122, v123
    v_cvt_pk_bf16_f32 v130, v124, v125
    v_cvt_pk_bf16_f32 v131, v126, v127
    s_add_u32 s68, s48, 525312
    buffer_store_dwordx4 v[128:131], v212, s[24:27], s68 offen sc1
    v_accvgpr_read_b32 v96, a96
    v_accvgpr_read_b32 v97, a97
    v_accvgpr_read_b32 v98, a98
    v_accvgpr_read_b32 v99, a99
    v_accvgpr_read_b32 v100, a116
    v_accvgpr_read_b32 v101, a117
    v_accvgpr_read_b32 v102, a118
    v_accvgpr_read_b32 v103, a119
    v_pk_mul_f32 v[96:97], v[96:97], v[224:225]
    v_pk_mul_f32 v[98:99], v[98:99], v[224:225]
    v_pk_mul_f32 v[100:101], v[100:101], v[224:225]
    v_pk_mul_f32 v[102:103], v[102:103], v[224:225]
    v_cvt_pk_bf16_f32 v104, v96, v97
    v_cvt_pk_bf16_f32 v105, v98, v99
    v_cvt_pk_bf16_f32 v106, v100, v101
    v_cvt_pk_bf16_f32 v107, v102, v103
    s_add_u32 s68, s48, 526336
    buffer_store_dwordx4 v[104:107], v212, s[24:27], s68 offen sc1
    v_accvgpr_read_b32 v108, a136
    v_accvgpr_read_b32 v109, a137
    v_accvgpr_read_b32 v110, a138
    v_accvgpr_read_b32 v111, a139
    v_accvgpr_read_b32 v112, a156
    v_accvgpr_read_b32 v113, a157
    v_accvgpr_read_b32 v114, a158
    v_accvgpr_read_b32 v115, a159
    v_pk_mul_f32 v[108:109], v[108:109], v[224:225]
    v_pk_mul_f32 v[110:111], v[110:111], v[224:225]
    v_pk_mul_f32 v[112:113], v[112:113], v[224:225]
    v_pk_mul_f32 v[114:115], v[114:115], v[224:225]
    v_cvt_pk_bf16_f32 v116, v108, v109
    v_cvt_pk_bf16_f32 v117, v110, v111
    v_cvt_pk_bf16_f32 v118, v112, v113
    v_cvt_pk_bf16_f32 v119, v114, v115
    s_add_u32 s68, s48, 527360
    buffer_store_dwordx4 v[116:119], v212, s[24:27], s68 offen sc1
    s_waitcnt lgkmcnt(0)
    s_barrier
    v_mov_b32 v96, 61440
    ds_read_b128 v[98:101], v96
    s_waitcnt lgkmcnt(0)
    v_or3_b32 v96, v98, v99, v100
    v_or_b32 v96, v96, v101
    s_nop 0
    v_readfirstlane_b32 s68, v96
    s_nop 3
    s_cmp_eq_u32 s68, 0
    s_cbranch_scc1 L1_ok
    s_cmp_eq_u32 s49, 0
    s_cbranch_scc1 L1_fallback
L1_ok:
    s_cmp_eq_u32 s99, 1
    s_cbranch_scc1 L1_fin
    s_mov_b32 s99, 1
    s_mov_b32 s32, s83
    s_branch L1_q
L1_fallback:
    s_mov_b32 s49, 1
    s_nop 7
    v_add_u32 v156, 131072, v176
    v_add_u32 v157, 131072, v177
    v_add_u32 v158, 131072, v178
    v_add_u32 v159, 131072, v179
    v_add_u32 v160, 81920, v180
    v_add_u32 v161, 81920, v181
    v_add_u32 v162, 81920, v182
    v_add_u32 v163, 81920, v183
    v_add_u32 v164, 81920, v184
    v_add_u32 v165, 81920, v185
    v_add_u32 v166, 81920, v186
    v_add_u32 v167, 81920, v187
    v_mov_b32 v168, 0xff800000
    v_mov_b32 v169, 0xff800000
    v_mov_b32 v170, 0xff800000
    v_mov_b32 v171, 0xff800000
    v_mov_b32 v172, 0xff800000
    s_lshl_b32 s68, s30, 12
    s_add_u32 s46, s47, s68
    s_mov_b32 s40, 32
L1_fb1:
    s_add_u32 m0, s41, 131072
    s_nop 0
    buffer_load_dwordx4 v194, s[16:19], s46 offen lds
    buffer_load_dwordx4 v195, s[16:19], s46 offen offset:1024 lds
    buffer_load_dwordx4 v196, s[16:19], s46 offen offset:2048 lds
    buffer_load_dwordx4 v197, s[16:19], s46 offen offset:3072 lds
    s_waitcnt vmcnt(0)
    s_barrier
    ds_read_b128 a[160:163], v156 offset:0
    ds_read_b128 a[164:167], v157 offset:0
    ds_read_b128 a[168:171], v158 offset:0
    ds_read_b128 a[172:175], v159 offset:0
    ds_read_b128 a[176:179], v156 offset:4096
    ds_read_b128 a[180:183], v157 offset:4096
    ds_read_b128 a[184:187], v158 offset:4096
    ds_read_b128 a[188:191], v159 offset:4096
    s_waitcnt lgkmcnt(0)
    v_mfma_f32_16x16x32_bf16 v[96:99], a[160:163], v[16:19], 0
    v_mfma_f32_16x16x32_bf16 v[100:103], a[160:163], v[32:35], 0
    v_mfma_f32_16x16x32_bf16 v[104:107], a[160:163], v[48:51], 0
    v_mfma_f32_16x16x32_bf16 v[108:111], a[160:163], v[64:67], 0
    v_mfma_f32_16x16x32_bf16 v[112:115], a[160:163], v[80:83], 0
    v_mfma_f32_16x16x32_bf16 v[96:99], a[164:167], v[20:23], v[96:99]
    v_mfma_f32_16x16x32_bf16 v[100:103], a[164:167], v[36:39], v[100:103]
    v_mfma_f32_16x16x32_bf16 v[104:107], a[164:167], v[52:55], v[104:107]
    v_mfma_f32_16x16x32_bf16 v[108:111], a[164:167], v[68:71], v[108:111]
    v_mfma_f32_16x16x32_bf16 v[112:115], a[164:167], v[84:87], v[112:115]
    v_mfma_f32_16x16x32_bf16 v[96:99], a[168:171], v[24:27], v[96:99]
    v_mfma_f32_16x16x32_bf16 v[100:103], a[168:171], v[40:43], v[100:103]
    v_mfma_f32_16x16x32_bf16 v[104:107], a[168:171], v[56:59], v[104:107]
    v_mfma_f32_16x16x32_bf16 v[108:111], a[168:171], v[72:75], v[108:111]
    v_mfma_f32_16x16x32_bf16 v[112:115], a[168:171], v[88:91], v[112:115]
    v_mfma_f32_16x16x32_bf16 v[96:99], a[172:175], v[28:31], v[96:99]
    v_mfma_f32_16x16x32_bf16 v[100:103], a[172:175], v[44:47], v[100:103]
    v_mfma_f32_16x16x32_bf16 v[104:107], a[172:175], v[60:63], v[104:107]
    v_mfma_f32_16x16x32_bf16 v[108:111], a[172:175], v[76:79], v[108:111]
    v_mfma_f32_16x16x32_bf16 v[112:115], a[172:175], v[92:95], v[112:115]
    v_mfma_f32_16x16x32_bf16 v[116:119], a[176:179], v[16:19], 0
    v_mfma_f32_16x16x32_bf16 v[120:123], a[176:179], v[32:35], 0
    v_mfma_f32_16x16x32_bf16 v[124:127], a[176:179], v[48:51], 0
    v_mfma_f32_16x16x32_bf16 v[128:131], a[176:179], v[64:67], 0
    v_mfma_f32_16x16x32_bf16 v[132:135], a[176:179], v[80:83], 0
    v_mfma_f32_16x16x32_bf16 v[116:119], a[180:183], v[20:23], v[116:119]
    v_mfma_f32_16x16x32_bf16 v[120:123], a[180:183], v[36:39], v[120:123]
    v_mfma_f32_16x16x32_bf16 v[124:127], a[180:183], v[52:55], v[124:127]
    v_mfma_f32_16x16x32_bf16 v[128:131], a[180:183], v[68:71], v[128:131]
    v_mfma_f32_16x16x32_bf16 v[132:135], a[180:183], v[84:87], v[132:135]
    v_mfma_f32_16x16x32_bf16 v[116:119], a[184:187], v[24:27], v[116:119]
    v_mfma_f32_16x16x32_bf16 v[120:123], a[184:187], v[40:43], v[120:123]
    v_mfma_f32_16x16x32_bf16 v[124:127], a[184:187], v[56:59], v[124:127]
    v_mfma_f32_16x16x32_bf16 v[128:131], a[184:187], v[72:75], v[128:131]
    v_mfma_f32_16x16x32_bf16 v[132:135], a[184:187], v[88:91], v[132:135]
    v_mfma_f32_16x16x32_bf16 v[116:119], a[188:191], v[28:31], v[116:119]
    v_mfma_f32_16x16x32_bf16 v[120:123], a[188:191], v[44:47], v[120:123]
    v_mfma_f32_16x16x32_bf16 v[124:127], a[188:191], v[60:63], v[124:127]
    v_mfma_f32_16x16x32_bf16 v[128:131], a[188:191], v[76:79], v[128:131]
    v_mfma_f32_16x16x32_bf16 v[132:135], a[188:191], v[92:95], v[132:135]
    v_max3_f32 v168, v168, v96, v97
    v_max3_f32 v168, v168, v98, v99
    s_nop 1
    v_max3_f32 v168, v168, v116, v117
    v_max3_f32 v168, v168, v118, v119
    v_max3_f32 v169, v169, v100, v101
    v_max3_f32 v169, v169, v102, v103
    v_max3_f32 v169, v169, v120, v121
    v_max3_f32 v169, v169, v122, v123
    v_max3_f32 v170, v170, v104, v105
    v_max3_f32 v170, v170, v106, v107
    v_max3_f32 v170, v170, v124, v125
    v_max3_f32 v170, v170, v126, v127
    v_max3_f32 v171, v171, v108, v109
    v_max3_f32 v171, v171, v110, v111
    v_max3_f32 v171, v171, v128, v129
    v_max3_f32 v171, v171, v130, v131
    v_max3_f32 v172, v172, v112, v113
    v_max3_f32 v172, v172, v114, v115
    v_max3_f32 v172, v172, v132, v133
    v_max3_f32 v172, v172, v134, v135
    s_barrier
    s_add_u32 s46, s46, 8192
    s_sub_u32 s40, s40, 1
    s_cmp_lg_u32 s40, 0
    s_cbranch_scc1 L1_fb1
    v_mov_b32 v216, v168
    v_mov_b32 v217, v168
    v_mov_b32 v218, v169
    v_mov_b32 v219, v169
    v_mov_b32 v220, v170
    v_mov_b32 v221, v170
    v_mov_b32 v222, v171
    v_mov_b32 v223, v171
    v_mov_b32 v224, v172
    v_mov_b32 v225, v172
    v_permlane32_swap_b32 v216, v217
    v_permlane32_swap_b32 v218, v219
    v_permlane32_swap_b32 v220, v221
    v_permlane32_swap_b32 v222, v223
    v_permlane32_swap_b32 v224, v225
    v_max_f32 v216, v216, v217
    v_max_f32 v218, v218, v219
    v_max_f32 v220, v220, v221
    v_max_f32 v222, v222, v223
    v_max_f32 v224, v224, v225
    v_mov_b32 v217, v216
    v_mov_b32 v219, v218
    v_mov_b32 v221, v220
    v_mov_b32 v223, v222
    v_mov_b32 v225, v224
    v_permlane16_swap_b32 v216, v217
    v_permlane16_swap_b32 v218, v219
    v_permlane16_swap_b32 v220, v221
    v_permlane16_swap_b32 v222, v223
    v_permlane16_swap_b32 v224, v225
    v_max_f32 v168, v216, v217
    v_max_f32 v169, v218, v219
    v_max_f32 v170, v220, v221
    v_max_f32 v171, v222, v223
    v_max_f32 v172, v224, v225
    v_accvgpr_write_b32 a0, 0
    v_accvgpr_write_b32 a1, 0
    v_accvgpr_write_b32 a2, 0
    v_accvgpr_write_b32 a3, 0
    v_accvgpr_write_b32 a4, 0
    v_accvgpr_write_b32 a5, 0
    v_accvgpr_write_b32 a6, 0
    v_accvgpr_write_b32 a7, 0
    v_accvgpr_write_b32 a8, 0
    v_accvgpr_write_b32 a9, 0
    v_accvgpr_write_b32 a10, 0
    v_accvgpr_write_b32 a11, 0
    v_accvgpr_write_b32 a12, 0
    v_accvgpr_write_b32 a13, 0
    v_accvgpr_write_b32 a14, 0
    v_accvgpr_write_b32 a15, 0
    v_accvgpr_write_b32 a16, 0
    v_accvgpr_write_b32 a17, 0
    v_accvgpr_write_b32 a18, 0
    v_accvgpr_write_b32 a19, 0
    v_accvgpr_write_b32 a20, 0
    v_accvgpr_write_b32 a21, 0
    v_accvgpr_write_b32 a22, 0
    v_accvgpr_write_b32 a23, 0
    v_accvgpr_write_b32 a24, 0
    v_accvgpr_write_b32 a25, 0
    v_accvgpr_write_b32 a26, 0
    v_accvgpr_write_b32 a27, 0
    v_accvgpr_write_b32 a28, 0
    v_accvgpr_write_b32 a29, 0
    v_accvgpr_write_b32 a30, 0
    v_accvgpr_write_b32 a31, 0
    v_accvgpr_write_b32 a32, 0
    v_accvgpr_write_b32 a33, 0
    v_accvgpr_write_b32 a34, 0
    v_accvgpr_write_b32 a35, 0
    v_accvgpr_write_b32 a36, 0
    v_accvgpr_write_b32 a37, 0
    v_accvgpr_write_b32 a38, 0
    v_accvgpr_write_b32 a39, 0
    v_accvgpr_write_b32 a40, 0
    v_accvgpr_write_b32 a41, 0
    v_accvgpr_write_b32 a42, 0
    v_accvgpr_write_b32 a43, 0
    v_accvgpr_write_b32 a44, 0
    v_accvgpr_write_b32 a45, 0
    v_accvgpr_write_b32 a46, 0
    v_accvgpr_write_b32 a47, 0
    v_accvgpr_write_b32 a48, 0
    v_accvgpr_write_b32 a49, 0
    v_accvgpr_write_b32 a50, 0
    v_accvgpr_write_b32 a51, 0
    v_accvgpr_write_b32 a52, 0
    v_accvgpr_write_b32 a53, 0
    v_accvgpr_write_b32 a54, 0
    v_accvgpr_write_b32 a55, 0
    v_accvgpr_write_b32 a56, 0
    v_accvgpr_write_b32 a57, 0
    v_accvgpr_write_b32 a58, 0
    v_accvgpr_write_b32 a59, 0
    v_accvgpr_write_b32 a60, 0
    v_accvgpr_write_b32 a61, 0
    v_accvgpr_write_b32 a62, 0
    v_accvgpr_write_b32 a63, 0
    v_accvgpr_write_b32 a64, 0
    v_accvgpr_write_b32 a65, 0
    v_accvgpr_write_b32 a66, 0
    v_accvgpr_write_b32 a67, 0
    v_accvgpr_write_b32 a68, 0
    v_accvgpr_write_b32 a69, 0
    v_accvgpr_write_b32 a70, 0
    v_accvgpr_write_b32 a71, 0
    v_accvgpr_write_b32 a72, 0
    v_accvgpr_write_b32 a73, 0
    v_accvgpr_write_b32 a74, 0
    v_accvgpr_write_b32 a75, 0
    v_accvgpr_write_b32 a76, 0
    v_accvgpr_write_b32 a77, 0
    v_accvgpr_write_b32 a78, 0
    v_accvgpr_write_b32 a79, 0
    v_accvgpr_write_b32 a80, 0
    v_accvgpr_write_b32 a81, 0
    v_accvgpr_write_b32 a82, 0
    v_accvgpr_write_b32 a83, 0
    v_accvgpr_write_b32 a84, 0
    v_accvgpr_write_b32 a85, 0
    v_accvgpr_write_b32 a86, 0
    v_accvgpr_write_b32 a87, 0
    v_accvgpr_write_b32 a88, 0
    v_accvgpr_write_b32 a89, 0
    v_accvgpr_write_b32 a90, 0
    v_accvgpr_write_b32 a91, 0
    v_accvgpr_write_b32 a92, 0
    v_accvgpr_write_b32 a93, 0
    v_accvgpr_write_b32 a94, 0
    v_accvgpr_write_b32 a95, 0
    v_accvgpr_write_b32 a96, 0
    v_accvgpr_write_b32 a97, 0
    v_accvgpr_write_b32 a98, 0
    v_accvgpr_write_b32 a99, 0
    v_accvgpr_write_b32 a100, 0
    v_accvgpr_write_b32 a101, 0
    v_accvgpr_write_b32 a102, 0
    v_accvgpr_write_b32 a103, 0
    v_accvgpr_write_b32 a104, 0
    v_accvgpr_write_b32 a105, 0
    v_accvgpr_write_b32 a106, 0
    v_accvgpr_write_b32 a107, 0
    v_accvgpr_write_b32 a108, 0
    v_accvgpr_write_b32 a109, 0
    v_accvgpr_write_b32 a110, 0
    v_accvgpr_write_b32 a111, 0
    v_accvgpr_write_b32 a112, 0
    v_accvgpr_write_b32 a113, 0
    v_accvgpr_write_b32 a114, 0
    v_accvgpr_write_b32 a115, 0
    v_accvgpr_write_b32 a116, 0
    v_accvgpr_write_b32 a117, 0
    v_accvgpr_write_b32 a118, 0
    v_accvgpr_write_b32 a119, 0
    v_accvgpr_write_b32 a120, 0
    v_accvgpr_write_b32 a121, 0
    v_accvgpr_write_b32 a122, 0
    v_accvgpr_write_b32 a123, 0
    v_accvgpr_write_b32 a124, 0
    v_accvgpr_write_b32 a125, 0
    v_accvgpr_write_b32 a126, 0
    v_accvgpr_write_b32 a127, 0
    v_accvgpr_write_b32 a128, 0
    v_accvgpr_write_b32 a129, 0
    v_accvgpr_write_b32 a130, 0
    v_accvgpr_write_b32 a131, 0
    v_accvgpr_write_b32 a132, 0
    v_accvgpr_write_b32 a133, 0
    v_accvgpr_write_b32 a134, 0
    v_accvgpr_write_b32 a135, 0
    v_accvgpr_write_b32 a136, 0
    v_accvgpr_write_b32 a137, 0
    v_accvgpr_write_b32 a138, 0
    v_accvgpr_write_b32 a139, 0
    v_accvgpr_write_b32 a140, 0
    v_accvgpr_write_b32 a141, 0
    v_accvgpr_write_b32 a142, 0
    v_accvgpr_write_b32 a143, 0
    v_accvgpr_write_b32 a144, 0
    v_accvgpr_write_b32 a145, 0
    v_accvgpr_write_b32 a146, 0
    v_accvgpr_write_b32 a147, 0
    v_accvgpr_write_b32 a148, 0
    v_accvgpr_write_b32 a149, 0
    v_accvgpr_write_b32 a150, 0
    v_accvgpr_write_b32 a151, 0
    v_accvgpr_write_b32 a152, 0
    v_accvgpr_write_b32 a153, 0
    v_accvgpr_write_b32 a154, 0
    v_accvgpr_write_b32 a155, 0
    v_accvgpr_write_b32 a156, 0
    v_accvgpr_write_b32 a157, 0
    v_accvgpr_write_b32 a158, 0
    v_accvgpr_write_b32 a159, 0
    v_mov_b32 v207, 0
    v_mov_b32 v208, 0
    v_mov_b32 v209, 0
    v_mov_b32 v210, 0
    v_mov_b32 v211, 0
    s_lshl_b32 s68, s30, 12
    s_add_u32 s46, s47, s68
    s_mov_b32 s40, 32
L1_fb2:
    s_add_u32 m0, s41, 131072
    s_nop 0
    buffer_load_dwordx4 v194, s[16:19], s46 offen lds
    buffer_load_dwordx4 v195, s[16:19], s46 offen offset:1024 lds
    buffer_load_dwordx4 v196, s[16:19], s46 offen offset:2048 lds
    buffer_load_dwordx4 v197, s[16:19], s46 offen offset:3072 lds
    s_add_u32 m0, s41, 147456
    s_nop 0
    buffer_load_dwordx4 v198, s[20:23], s46 offen lds
    buffer_load_dwordx4 v199, s[20:23], s46 offen offset:1024 lds
    buffer_load_dwordx4 v198, s[20:23], s46 offen offset:2048 lds
    buffer_load_dwordx4 v199, s[20:23], s46 offen offset:3072 lds
    s_waitcnt vmcnt(0)
    s_barrier
    ds_read_b128 a[160:163], v156 offset:0
    ds_read_b128 a[164:167], v157 offset:0
    ds_read_b128 a[168:171], v158 offset:0
    ds_read_b128 a[172:175], v159 offset:0
    ds_read_b128 a[176:179], v156 offset:4096
    ds_read_b128 a[180:183], v157 offset:4096
    ds_read_b128 a[184:187], v158 offset:4096
    ds_read_b128 a[188:191], v159 offset:4096
    s_waitcnt lgkmcnt(0)
    v_mfma_f32_16x16x32_bf16 v[96:99], a[160:163], v[16:19], 0
    v_mfma_f32_16x16x32_bf16 v[100:103], a[160:163], v[32:35], 0
    v_mfma_f32_16x16x32_bf16 v[104:107], a[160:163], v[48:51], 0
    v_mfma_f32_16x16x32_bf16 v[108:111], a[160:163], v[64:67], 0
    v_mfma_f32_16x16x32_bf16 v[112:115], a[160:163], v[80:83], 0
    v_mfma_f32_16x16x32_bf16 v[96:99], a[164:167], v[20:23], v[96:99]
    v_mfma_f32_16x16x32_bf16 v[100:103], a[164:167], v[36:39], v[100:103]
    v_mfma_f32_16x16x32_bf16 v[104:107], a[164:167], v[52:55], v[104:107]
    v_mfma_f32_16x16x32_bf16 v[108:111], a[164:167], v[68:71], v[108:111]
    v_mfma_f32_16x16x32_bf16 v[112:115], a[164:167], v[84:87], v[112:115]
    v_mfma_f32_16x16x32_bf16 v[96:99], a[168:171], v[24:27], v[96:99]
    v_mfma_f32_16x16x32_bf16 v[100:103], a[168:171], v[40:43], v[100:103]
    v_mfma_f32_16x16x32_bf16 v[104:107], a[168:171], v[56:59], v[104:107]
    v_mfma_f32_16x16x32_bf16 v[108:111], a[168:171], v[72:75], v[108:111]
    v_mfma_f32_16x16x32_bf16 v[112:115], a[168:171], v[88:91], v[112:115]
    v_mfma_f32_16x16x32_bf16 v[96:99], a[172:175], v[28:31], v[96:99]
    v_mfma_f32_16x16x32_bf16 v[100:103], a[172:175], v[44:47], v[100:103]
    v_mfma_f32_16x16x32_bf16 v[104:107], a[172:175], v[60:63], v[104:107]
    v_mfma_f32_16x16x32_bf16 v[108:111], a[172:175], v[76:79], v[108:111]
    v_mfma_f32_16x16x32_bf16 v[112:115], a[172:175], v[92:95], v[112:115]
    v_mfma_f32_16x16x32_bf16 v[116:119], a[176:179], v[16:19], 0
    v_mfma_f32_16x16x32_bf16 v[120:123], a[176:179], v[32:35], 0
    v_mfma_f32_16x16x32_bf16 v[124:127], a[176:179], v[48:51], 0
    v_mfma_f32_16x16x32_bf16 v[128:131], a[176:179], v[64:67], 0
    v_mfma_f32_16x16x32_bf16 v[132:135], a[176:179], v[80:83], 0
    v_mfma_f32_16x16x32_bf16 v[116:119], a[180:183], v[20:23], v[116:119]
    v_mfma_f32_16x16x32_bf16 v[120:123], a[180:183], v[36:39], v[120:123]
    v_mfma_f32_16x16x32_bf16 v[124:127], a[180:183], v[52:55], v[124:127]
    v_mfma_f32_16x16x32_bf16 v[128:131], a[180:183], v[68:71], v[128:131]
    v_mfma_f32_16x16x32_bf16 v[132:135], a[180:183], v[84:87], v[132:135]
    v_mfma_f32_16x16x32_bf16 v[116:119], a[184:187], v[24:27], v[116:119]
    v_mfma_f32_16x16x32_bf16 v[120:123], a[184:187], v[40:43], v[120:123]
    v_mfma_f32_16x16x32_bf16 v[124:127], a[184:187], v[56:59], v[124:127]
    v_mfma_f32_16x16x32_bf16 v[128:131], a[184:187], v[72:75], v[128:131]
    v_mfma_f32_16x16x32_bf16 v[132:135], a[184:187], v[88:91], v[132:135]
    v_mfma_f32_16x16x32_bf16 v[116:119], a[188:191], v[28:31], v[116:119]
    v_mfma_f32_16x16x32_bf16 v[120:123], a[188:191], v[44:47], v[120:123]
    v_mfma_f32_16x16x32_bf16 v[124:127], a[188:191], v[60:63], v[124:127]
    v_mfma_f32_16x16x32_bf16 v[128:131], a[188:191], v[76:79], v[128:131]
    v_mfma_f32_16x16x32_bf16 v[132:135], a[188:191], v[92:95], v[132:135]
    v_sub_f32 v96, v96, v168
    v_sub_f32 v97, v97, v168
    v_sub_f32 v98, v98, v168
    v_sub_f32 v99, v99, v168
    v_exp_f32 v96, v96
    v_exp_f32 v97, v97
    v_exp_f32 v98, v98
    v_exp_f32 v99, v99
    v_add_f32 v207, v207, v96
    v_add_f32 v207, v207, v97
    v_add_f32 v207, v207, v98
    v_add_f32 v207, v207, v99
    v_cvt_pk_bf16_f32 v136, v96, v97
    v_cvt_pk_bf16_f32 v137, v98, v99
    v_sub_f32 v100, v100, v169
    v_sub_f32 v101, v101, v169
    v_sub_f32 v102, v102, v169
    v_sub_f32 v103, v103, v169
    v_exp_f32 v100, v100
    v_exp_f32 v101, v101
    v_exp_f32 v102, v102
    v_exp_f32 v103, v103
    v_add_f32 v208, v208, v100
    v_add_f32 v208, v208, v101
    v_add_f32 v208, v208, v102
    v_add_f32 v208, v208, v103
    v_cvt_pk_bf16_f32 v140, v100, v101
    v_cvt_pk_bf16_f32 v141, v102, v103
    v_sub_f32 v104, v104, v170
    v_sub_f32 v105, v105, v170
    v_sub_f32 v106, v106, v170
    v_sub_f32 v107, v107, v170
    v_exp_f32 v104, v104
    v_exp_f32 v105, v105
    v_exp_f32 v106, v106
    v_exp_f32 v107, v107
    v_add_f32 v209, v209, v104
    v_add_f32 v209, v209, v105
    v_add_f32 v209, v209, v106
    v_add_f32 v209, v209, v107
    v_cvt_pk_bf16_f32 v144, v104, v105
    v_cvt_pk_bf16_f32 v145, v106, v107
    v_sub_f32 v108, v108, v171
    v_sub_f32 v109, v109, v171
    v_sub_f32 v110, v110, v171
    v_sub_f32 v111, v111, v171
    v_exp_f32 v108, v108
    v_exp_f32 v109, v109
    v_exp_f32 v110, v110
    v_exp_f32 v111, v111
    v_add_f32 v210, v210, v108
    v_add_f32 v210, v210, v109
    v_add_f32 v210, v210, v110
    v_add_f32 v210, v210, v111
    v_cvt_pk_bf16_f32 v148, v108, v109
    v_cvt_pk_bf16_f32 v149, v110, v111
    v_sub_f32 v112, v112, v172
    v_sub_f32 v113, v113, v172
    v_sub_f32 v114, v114, v172
    v_sub_f32 v115, v115, v172
    v_exp_f32 v112, v112
    v_exp_f32 v113, v113
    v_exp_f32 v114, v114
    v_exp_f32 v115, v115
    v_add_f32 v211, v211, v112
    v_add_f32 v211, v211, v113
    v_add_f32 v211, v211, v114
    v_add_f32 v211, v211, v115
    v_cvt_pk_bf16_f32 v152, v112, v113
    v_cvt_pk_bf16_f32 v153, v114, v115
    v_sub_f32 v116, v116, v168
    v_sub_f32 v117, v117, v168
    v_sub_f32 v118, v118, v168
    v_sub_f32 v119, v119, v168
    v_exp_f32 v116, v116
    v_exp_f32 v117, v117
    v_exp_f32 v118, v118
    v_exp_f32 v119, v119
    v_add_f32 v207, v207, v116
    v_add_f32 v207, v207, v117
    v_add_f32 v207, v207, v118
    v_add_f32 v207, v207, v119
    v_cvt_pk_bf16_f32 v138, v116, v117
    v_cvt_pk_bf16_f32 v139, v118, v119
    v_sub_f32 v120, v120, v169
    v_sub_f32 v121, v121, v169
    v_sub_f32 v122, v122, v169
    v_sub_f32 v123, v123, v169
    v_exp_f32 v120, v120
    v_exp_f32 v121, v121
    v_exp_f32 v122, v122
    v_exp_f32 v123, v123
    v_add_f32 v208, v208, v120
    v_add_f32 v208, v208, v121
    v_add_f32 v208, v208, v122
    v_add_f32 v208, v208, v123
    v_cvt_pk_bf16_f32 v142, v120, v121
    v_cvt_pk_bf16_f32 v143, v122, v123
    v_sub_f32 v124, v124, v170
    v_sub_f32 v125, v125, v170
    v_sub_f32 v126, v126, v170
    v_sub_f32 v127, v127, v170
    v_exp_f32 v124, v124
    v_exp_f32 v125, v125
    v_exp_f32 v126, v126
    v_exp_f32 v127, v127
    v_add_f32 v209, v209, v124
    v_add_f32 v209, v209, v125
    v_add_f32 v209, v209, v126
    v_add_f32 v209, v209, v127
    v_cvt_pk_bf16_f32 v146, v124, v125
    v_cvt_pk_bf16_f32 v147, v126, v127
    v_sub_f32 v128, v128, v171
    v_sub_f32 v129, v129, v171
    v_sub_f32 v130, v130, v171
    v_sub_f32 v131, v131, v171
    v_exp_f32 v128, v128
    v_exp_f32 v129, v129
    v_exp_f32 v130, v130
    v_exp_f32 v131, v131
    v_add_f32 v210, v210, v128
    v_add_f32 v210, v210, v129
    v_add_f32 v210, v210, v130
    v_add_f32 v210, v210, v131
    v_cvt_pk_bf16_f32 v150, v128, v129
    v_cvt_pk_bf16_f32 v151, v130, v131
    v_sub_f32 v132, v132, v172
    v_sub_f32 v133, v133, v172
    v_sub_f32 v134, v134, v172
    v_sub_f32 v135, v135, v172
    v_exp_f32 v132, v132
    v_exp_f32 v133, v133
    v_exp_f32 v134, v134
    v_exp_f32 v135, v135
    v_add_f32 v211, v211, v132
    v_add_f32 v211, v211, v133
    v_add_f32 v211, v211, v134
    v_add_f32 v211, v211, v135
    v_cvt_pk_bf16_f32 v154, v132, v133
    v_cvt_pk_bf16_f32 v155, v134, v135
    ds_read_b64_tr_b16 a[192:193], v160 offset:0
    ds_read_b64_tr_b16 a[194:195], v160 offset:4096
    ds_read_b64_tr_b16 a[196:197], v161 offset:0
    ds_read_b64_tr_b16 a[198:199], v161 offset:4096
    ds_read_b64_tr_b16 a[200:201], v162 offset:0
    ds_read_b64_tr_b16 a[202:203], v162 offset:4096
    ds_read_b64_tr_b16 a[204:205], v163 offset:0
    ds_read_b64_tr_b16 a[206:207], v163 offset:4096
    s_waitcnt lgkmcnt(0)
    ds_read_b64_tr_b16 a[208:209], v164 offset:0
    ds_read_b64_tr_b16 a[210:211], v164 offset:4096
    ds_read_b64_tr_b16 a[212:213], v165 offset:0
    ds_read_b64_tr_b16 a[214:215], v165 offset:4096
    ds_read_b64_tr_b16 a[216:217], v166 offset:0
    ds_read_b64_tr_b16 a[218:219], v166 offset:4096
    ds_read_b64_tr_b16 a[220:221], v167 offset:0
    ds_read_b64_tr_b16 a[222:223], v167 offset:4096
    s_waitcnt lgkmcnt(0)
    v_mfma_f32_16x16x32_bf16 a[0:3], a[192:195], v[136:139], a[0:3]
    v_mfma_f32_16x16x32_bf16 a[4:7], a[192:195], v[140:143], a[4:7]
    v_mfma_f32_16x16x32_bf16 a[8:11], a[192:195], v[144:147], a[8:11]
    v_mfma_f32_16x16x32_bf16 a[12:15], a[192:195], v[148:151], a[12:15]
    v_mfma_f32_16x16x32_bf16 a[16:19], a[192:195], v[152:155], a[16:19]
    v_mfma_f32_16x16x32_bf16 a[20:23], a[196:199], v[136:139], a[20:23]
    v_mfma_f32_16x16x32_bf16 a[24:27], a[196:199], v[140:143], a[24:27]
    v_mfma_f32_16x16x32_bf16 a[28:31], a[196:199], v[144:147], a[28:31]
    v_mfma_f32_16x16x32_bf16 a[32:35], a[196:199], v[148:151], a[32:35]
    v_mfma_f32_16x16x32_bf16 a[36:39], a[196:199], v[152:155], a[36:39]
    v_mfma_f32_16x16x32_bf16 a[40:43], a[200:203], v[136:139], a[40:43]
    v_mfma_f32_16x16x32_bf16 a[44:47], a[200:203], v[140:143], a[44:47]
    v_mfma_f32_16x16x32_bf16 a[48:51], a[200:203], v[144:147], a[48:51]
    v_mfma_f32_16x16x32_bf16 a[52:55], a[200:203], v[148:151], a[52:55]
    v_mfma_f32_16x16x32_bf16 a[56:59], a[200:203], v[152:155], a[56:59]
    v_mfma_f32_16x16x32_bf16 a[60:63], a[204:207], v[136:139], a[60:63]
    v_mfma_f32_16x16x32_bf16 a[64:67], a[204:207], v[140:143], a[64:67]
    v_mfma_f32_16x16x32_bf16 a[68:71], a[204:207], v[144:147], a[68:71]
    v_mfma_f32_16x16x32_bf16 a[72:75], a[204:207], v[148:151], a[72:75]
    v_mfma_f32_16x16x32_bf16 a[76:79], a[204:207], v[152:155], a[76:79]
    v_mfma_f32_16x16x32_bf16 a[80:83], a[208:211], v[136:139], a[80:83]
    v_mfma_f32_16x16x32_bf16 a[84:87], a[208:211], v[140:143], a[84:87]
    v_mfma_f32_16x16x32_bf16 a[88:91], a[208:211], v[144:147], a[88:91]
    v_mfma_f32_16x16x32_bf16 a[92:95], a[208:211], v[148:151], a[92:95]
    v_mfma_f32_16x16x32_bf16 a[96:99], a[208:211], v[152:155], a[96:99]
    v_mfma_f32_16x16x32_bf16 a[100:103], a[212:215], v[136:139], a[100:103]
    v_mfma_f32_16x16x32_bf16 a[104:107], a[212:215], v[140:143], a[104:107]
    v_mfma_f32_16x16x32_bf16 a[108:111], a[212:215], v[144:147], a[108:111]
    v_mfma_f32_16x16x32_bf16 a[112:115], a[212:215], v[148:151], a[112:115]
    v_mfma_f32_16x16x32_bf16 a[116:119], a[212:215], v[152:155], a[116:119]
    v_mfma_f32_16x16x32_bf16 a[120:123], a[216:219], v[136:139], a[120:123]
    v_mfma_f32_16x16x32_bf16 a[124:127], a[216:219], v[140:143], a[124:127]
    v_mfma_f32_16x16x32_bf16 a[128:131], a[216:219], v[144:147], a[128:131]
    v_mfma_f32_16x16x32_bf16 a[132:135], a[216:219], v[148:151], a[132:135]
    v_mfma_f32_16x16x32_bf16 a[136:139], a[216:219], v[152:155], a[136:139]
    v_mfma_f32_16x16x32_bf16 a[140:143], a[220:223], v[136:139], a[140:143]
    v_mfma_f32_16x16x32_bf16 a[144:147], a[220:223], v[140:143], a[144:147]
    v_mfma_f32_16x16x32_bf16 a[148:151], a[220:223], v[144:147], a[148:151]
    v_mfma_f32_16x16x32_bf16 a[152:155], a[220:223], v[148:151], a[152:155]
    v_mfma_f32_16x16x32_bf16 a[156:159], a[220:223], v[152:155], a[156:159]
    s_barrier
    s_add_u32 s46, s46, 8192
    s_sub_u32 s40, s40, 1
    s_cmp_lg_u32 s40, 0
    s_cbranch_scc1 L1_fb2
    s_nop 7
    s_branch L1_epi
L1_fin:
    s_waitcnt vmcnt(20)
    s_barrier
    v_lshrrev_b32 v216, 6, v212
    v_mul_u32_u24 v216, 1280, v216
    v_lshrrev_b32 v217, 4, v212
    v_and_b32 v217, 3, v217
    v_lshl_add_u32 v216, v217, 3, v216
    s_mul_i32 s68, s28, 320
    v_add_u32 v216, s68, v216
    ds_read_b64_tr_b16 v[96:97], v216 offset:0
    ds_read_b64_tr_b16 v[98:99], v216 offset:20480
    ds_read_b64_tr_b16 v[100:101], v216 offset:32
    ds_read_b64_tr_b16 v[102:103], v216 offset:20512
    ds_read_b64_tr_b16 v[104:105], v216 offset:64
    ds_read_b64_tr_b16 v[106:107], v216 offset:20544
    ds_read_b64_tr_b16 v[108:109], v216 offset:96
    ds_read_b64_tr_b16 v[110:111], v216 offset:20576
    ds_read_b64_tr_b16 v[112:113], v216 offset:128
    ds_read_b64_tr_b16 v[114:115], v216 offset:20608
    s_waitcnt lgkmcnt(0)
    ds_read_b64_tr_b16 v[116:117], v216 offset:160
    ds_read_b64_tr_b16 v[118:119], v216 offset:20640
    ds_read_b64_tr_b16 v[120:121], v216 offset:192
    ds_read_b64_tr_b16 v[122:123], v216 offset:20672
    ds_read_b64_tr_b16 v[124:125], v216 offset:224
    ds_read_b64_tr_b16 v[126:127], v216 offset:20704
    ds_read_b64_tr_b16 v[128:129], v216 offset:256
    ds_read_b64_tr_b16 v[130:131], v216 offset:20736
    ds_read_b64_tr_b16 v[132:133], v216 offset:288
    ds_read_b64_tr_b16 v[134:135], v216 offset:20768
    s_waitcnt lgkmcnt(0)
    s_lshr_b32 s68, s2, 7
    s_mul_i32 s68, s68, 40
    s_mul_i32 s69, s28, 10
    s_add_u32 s68, s68, s69
    s_lshl_b32 s68, s68, 7
    s_and_b32 s69, s2, 127
    s_add_u32 s68, s68, s69
    s_lshl_b32 s68, s68, 10
    s_add_u32 s68, s68, 44040192
    buffer_store_dwordx4 v[96:99], v212, s[24:27], s68 offen sc1
    s_add_u32 s68, s68, 131072
    buffer_store_dwordx4 v[100:103], v212, s[24:27], s68 offen sc1
    s_add_u32 s68, s68, 131072
    buffer_store_dwordx4 v[104:107], v212, s[24:27], s68 offen sc1
    s_add_u32 s68, s68, 131072
    buffer_store_dwordx4 v[108:111], v212, s[24:27], s68 offen sc1
    s_add_u32 s68, s68, 131072
    buffer_store_dwordx4 v[112:115], v212, s[24:27], s68 offen sc1
    s_add_u32 s68, s68, 131072
    buffer_store_dwordx4 v[116:119], v212, s[24:27], s68 offen sc1
    s_add_u32 s68, s68, 131072
    buffer_store_dwordx4 v[120:123], v212, s[24:27], s68 offen sc1
    s_add_u32 s68, s68, 131072
    buffer_store_dwordx4 v[124:127], v212, s[24:27], s68 offen sc1
    s_add_u32 s68, s68, 131072
    buffer_store_dwordx4 v[128:131], v212, s[24:27], s68 offen sc1
    s_add_u32 s68, s68, 131072
    buffer_store_dwordx4 v[132:135], v212, s[24:27], s68 offen sc1
    s_add_u32 s68, s68, 131072
    s_barrier
L1_done:
    s_endpgm
.globl mha_oproj_kernel
.p2align 8
.type mha_oproj_kernel,@function
mha_oproj_kernel:
    s_cmp_ge_u32 s2, 256
    s_cbranch_scc1 L2_done
    s_load_dwordx2 s[30:31], s[0:1], 80
    s_load_dwordx2 s[32:33], s[0:1], 96
    v_lshrrev_b32 v1, 6, v0
    v_and_b32 v2, 63, v0
    v_readfirstlane_b32 s20, v1
    s_and_b32 s3, s2, 7
    s_lshr_b32 s34, s2, 3
    s_and_b32 s35, s34, 7
    s_lshr_b32 s34, s34, 3
    s_lshl_b32 s36, s3, 2
    s_add_u32 s36, s36, s34
    s_lshr_b32 s37, s36, 4
    s_and_b32 s38, s36, 15
    s_lshr_b32 s21, s20, 1
    s_and_b32 s22, s20, 1
    s_waitcnt lgkmcnt(0)
    s_mov_b32 s12, s32
    s_and_b32 s13, s33, 0xffff
    s_mov_b32 s14, 54525952
    s_mov_b32 s15, 0x20000
    s_mov_b32 s16, s30
    s_and_b32 s17, s31, 0xffff
    s_mov_b32 s18, 6553600
    s_mov_b32 s19, 0x20000
    s_mul_i32 s27, s37, 40
    s_mul_i32 s28, s35, 5
    s_add_u32 s27, s27, s28
    s_lshl_b32 s27, s27, 7
    s_add_u32 s27, s27, s20
    s_lshl_b32 s27, s27, 10
    s_add_u32 s23, s27, 44040192
    s_mul_i32 s25, s20, 5120
    s_mul_i32 s27, s36, 10
    s_mul_i32 s28, s22, 5
    s_add_u32 s27, s27, s28
    s_lshl_b32 s27, s27, 7
    s_add_u32 s27, s27, s21
    s_lshl_b32 s24, s27, 10
    v_and_b32 v3, 15, v2
    v_lshrrev_b32 v4, 4, v2
    v_lshlrev_b32 v5, 4, v2
    v_add_u32 v13, 0, v5
    v_add_u32 v8, 0, v5
    v_add_u32 v14, 131072, v5
    v_add_u32 v9, 130048, v5
    v_add_u32 v15, 262144, v5
    v_add_u32 v10, 260096, v5
    v_add_u32 v16, 393216, v5
    v_add_u32 v11, 390144, v5
    v_add_u32 v17, 524288, v5
    v_add_u32 v12, 524288, v5
    s_mov_b32 m0, s25
    s_nop 0
    buffer_load_dwordx4 v8, s[12:15], s23 offen lds
    buffer_load_dwordx4 v9, s[12:15], s23 offen offset:1024 lds
    buffer_load_dwordx4 v10, s[12:15], s23 offen offset:2048 lds
    buffer_load_dwordx4 v11, s[12:15], s23 offen offset:3072 lds
    s_add_u32 m0, s25, 4096
    s_nop 0
    buffer_load_dwordx4 v12, s[12:15], s23 offen lds
    s_add_u32 s23, s23, 4096
    buffer_load_dwordx4 v[32:35], v13, s[12:15], s24 offen
    buffer_load_dwordx4 v[36:39], v14, s[12:15], s24 offen
    buffer_load_dwordx4 v[40:43], v15, s[12:15], s24 offen
    buffer_load_dwordx4 v[44:47], v16, s[12:15], s24 offen
    buffer_load_dwordx4 v[48:51], v17, s[12:15], s24 offen
    buffer_load_dwordx4 v[52:55], v13, s[12:15], s24 offen offset:2048
    buffer_load_dwordx4 v[56:59], v14, s[12:15], s24 offen offset:2048
    buffer_load_dwordx4 v[60:63], v15, s[12:15], s24 offen offset:2048
    buffer_load_dwordx4 v[64:67], v16, s[12:15], s24 offen offset:2048
    buffer_load_dwordx4 v[68:71], v17, s[12:15], s24 offen offset:2048
    s_add_u32 s24, s24, 4096
    s_add_u32 m0, s25, 20480
    s_nop 0
    buffer_load_dwordx4 v8, s[12:15], s23 offen lds
    buffer_load_dwordx4 v9, s[12:15], s23 offen offset:1024 lds
    buffer_load_dwordx4 v10, s[12:15], s23 offen offset:2048 lds
    buffer_load_dwordx4 v11, s[12:15], s23 offen offset:3072 lds
    s_add_u32 m0, s25, 24576
    s_nop 0
    buffer_load_dwordx4 v12, s[12:15], s23 offen lds
    s_add_u32 s23, s23, 4096
    buffer_load_dwordx4 v[72:75], v13, s[12:15], s24 offen
    buffer_load_dwordx4 v[76:79], v14, s[12:15], s24 offen
    buffer_load_dwordx4 v[80:83], v15, s[12:15], s24 offen
    buffer_load_dwordx4 v[84:87], v16, s[12:15], s24 offen
    buffer_load_dwordx4 v[88:91], v17, s[12:15], s24 offen
    buffer_load_dwordx4 v[92:95], v13, s[12:15], s24 offen offset:2048
    buffer_load_dwordx4 v[96:99], v14, s[12:15], s24 offen offset:2048
    buffer_load_dwordx4 v[100:103], v15, s[12:15], s24 offen offset:2048
    buffer_load_dwordx4 v[104:107], v16, s[12:15], s24 offen offset:2048
    buffer_load_dwordx4 v[108:111], v17, s[12:15], s24 offen offset:2048
    s_add_u32 s24, s24, 4096
    s_add_u32 m0, s25, 40960
    s_nop 0
    buffer_load_dwordx4 v8, s[12:15], s23 offen lds
    buffer_load_dwordx4 v9, s[12:15], s23 offen offset:1024 lds
    buffer_load_dwordx4 v10, s[12:15], s23 offen offset:2048 lds
    buffer_load_dwordx4 v11, s[12:15], s23 offen offset:3072 lds
    s_add_u32 m0, s25, 45056
    s_nop 0
    buffer_load_dwordx4 v12, s[12:15], s23 offen lds
    s_add_u32 s23, s23, 4096
    buffer_load_dwordx4 v[112:115], v13, s[12:15], s24 offen
    buffer_load_dwordx4 v[116:119], v14, s[12:15], s24 offen
    buffer_load_dwordx4 v[120:123], v15, s[12:15], s24 offen
    buffer_load_dwordx4 v[124:127], v16, s[12:15], s24 offen
    buffer_load_dwordx4 v[128:131], v17, s[12:15], s24 offen
    buffer_load_dwordx4 v[132:135], v13, s[12:15], s24 offen offset:2048
    buffer_load_dwordx4 v[136:139], v14, s[12:15], s24 offen offset:2048
    buffer_load_dwordx4 v[140:143], v15, s[12:15], s24 offen offset:2048
    buffer_load_dwordx4 v[144:147], v16, s[12:15], s24 offen offset:2048
    buffer_load_dwordx4 v[148:151], v17, s[12:15], s24 offen offset:2048
    s_add_u32 s24, s24, 4096
    s_mul_i32 s27, s38, 160
    s_mul_i32 s28, s22, 80
    s_add_u32 s27, s27, s28
    s_mul_i32 s29, s27, 2560
    s_mul_i32 s27, s37, 1280
    s_add_u32 s29, s29, s27
    s_mul_i32 s27, s35, 160
    s_add_u32 s29, s29, s27
    s_mul_i32 s27, s21, 5120
    v_add_u32 v18, s27, v5
    v_add_u32 v21, 40960, v18
    v_mul_u32_u24 v6, 2560, v3
    v_lshl_add_u32 v19, v4, 3, v6
    s_mul_i32 s27, s22, 26624
    v_add_u32 v20, s27, v5
    s_waitcnt lgkmcnt(0)
    s_waitcnt vmcnt(30)
    s_barrier
    ds_read_b128 v[192:195], v18 offset:0
    ds_read_b128 v[196:199], v18 offset:1024
    ds_read_b128 v[200:203], v18 offset:2048
    ds_read_b128 v[204:207], v18 offset:3072
    ds_read_b128 v[208:211], v18 offset:4096
    s_waitcnt lgkmcnt(0)
    v_mfma_f32_16x16x32_bf16 a[0:3], v[192:195], v[32:35], 0
    ds_read_b128 v[212:215], v18 offset:10240
    s_add_u32 m0, s25, 61440
    v_mfma_f32_16x16x32_bf16 a[4:7], v[192:195], v[36:39], 0
    buffer_load_dwordx4 v[152:155], v13, s[12:15], s24 offen
    v_mfma_f32_16x16x32_bf16 a[8:11], v[192:195], v[40:43], 0
    ds_read_b128 v[216:219], v18 offset:11264
    v_mfma_f32_16x16x32_bf16 a[12:15], v[192:195], v[44:47], 0
    v_mfma_f32_16x16x32_bf16 a[16:19], v[192:195], v[48:51], 0
    ds_read_b128 v[220:223], v18 offset:12288
    v_mfma_f32_16x16x32_bf16 a[20:23], v[196:199], v[32:35], 0
    buffer_load_dwordx4 v[156:159], v14, s[12:15], s24 offen
    v_mfma_f32_16x16x32_bf16 a[24:27], v[196:199], v[36:39], 0
    ds_read_b128 v[224:227], v18 offset:13312
    v_mfma_f32_16x16x32_bf16 a[28:31], v[196:199], v[40:43], 0
    v_mfma_f32_16x16x32_bf16 a[32:35], v[196:199], v[44:47], 0
    ds_read_b128 v[228:231], v18 offset:14336
    v_mfma_f32_16x16x32_bf16 a[36:39], v[196:199], v[48:51], 0
    buffer_load_dwordx4 v8, s[12:15], s23 offen lds
    v_mfma_f32_16x16x32_bf16 a[40:43], v[200:203], v[32:35], 0
    v_mfma_f32_16x16x32_bf16 a[44:47], v[200:203], v[36:39], 0
    v_mfma_f32_16x16x32_bf16 a[48:51], v[200:203], v[40:43], 0
    buffer_load_dwordx4 v[160:163], v15, s[12:15], s24 offen
    v_mfma_f32_16x16x32_bf16 a[52:55], v[200:203], v[44:47], 0
    v_mfma_f32_16x16x32_bf16 a[56:59], v[200:203], v[48:51], 0
    v_mfma_f32_16x16x32_bf16 a[60:63], v[204:207], v[32:35], 0
    buffer_load_dwordx4 v[164:167], v16, s[12:15], s24 offen
    v_mfma_f32_16x16x32_bf16 a[64:67], v[204:207], v[36:39], 0
    v_mfma_f32_16x16x32_bf16 a[68:71], v[204:207], v[40:43], 0
    v_mfma_f32_16x16x32_bf16 a[72:75], v[204:207], v[44:47], 0
    buffer_load_dwordx4 v9, s[12:15], s23 offen offset:1024 lds
    v_mfma_f32_16x16x32_bf16 a[76:79], v[204:207], v[48:51], 0
    v_mfma_f32_16x16x32_bf16 a[80:83], v[208:211], v[32:35], 0
    v_mfma_f32_16x16x32_bf16 a[84:87], v[208:211], v[36:39], 0
    buffer_load_dwordx4 v[168:171], v17, s[12:15], s24 offen
    v_mfma_f32_16x16x32_bf16 a[88:91], v[208:211], v[40:43], 0
    v_mfma_f32_16x16x32_bf16 a[92:95], v[208:211], v[44:47], 0
    v_mfma_f32_16x16x32_bf16 a[96:99], v[208:211], v[48:51], 0
    buffer_load_dwordx4 v[172:175], v13, s[12:15], s24 offen offset:2048
    s_waitcnt lgkmcnt(0)
    v_mfma_f32_16x16x32_bf16 a[0:3], v[212:215], v[52:55], a[0:3]
    v_mfma_f32_16x16x32_bf16 a[4:7], v[212:215], v[56:59], a[4:7]
    v_mfma_f32_16x16x32_bf16 a[8:11], v[212:215], v[60:63], a[8:11]
    buffer_load_dwordx4 v10, s[12:15], s23 offen offset:2048 lds
    v_mfma_f32_16x16x32_bf16 a[12:15], v[212:215], v[64:67], a[12:15]
    v_mfma_f32_16x16x32_bf16 a[16:19], v[212:215], v[68:71], a[16:19]
    v_mfma_f32_16x16x32_bf16 a[20:23], v[216:219], v[52:55], a[20:23]
    buffer_load_dwordx4 v[176:179], v14, s[12:15], s24 offen offset:2048
    v_mfma_f32_16x16x32_bf16 a[24:27], v[216:219], v[56:59], a[24:27]
    v_mfma_f32_16x16x32_bf16 a[28:31], v[216:219], v[60:63], a[28:31]
    v_mfma_f32_16x16x32_bf16 a[32:35], v[216:219], v[64:67], a[32:35]
    buffer_load_dwordx4 v[180:183], v15, s[12:15], s24 offen offset:2048
    v_mfma_f32_16x16x32_bf16 a[36:39], v[216:219], v[68:71], a[36:39]
    v_mfma_f32_16x16x32_bf16 a[40:43], v[220:223], v[52:55], a[40:43]
    v_mfma_f32_16x16x32_bf16 a[44:47], v[220:223], v[56:59], a[44:47]
    s_waitcnt lgkmcnt(0)
    v_mfma_f32_16x16x32_bf16 a[48:51], v[220:223], v[60:63], a[48:51]
    s_waitcnt vmcnt(26)
    v_mfma_f32_16x16x32_bf16 a[52:55], v[220:223], v[64:67], a[52:55]
    s_barrier
    v_mfma_f32_16x16x32_bf16 a[56:59], v[220:223], v[68:71], a[56:59]
    ds_read_b128 v[192:195], v18 offset:20480
    v_mfma_f32_16x16x32_bf16 a[60:63], v[224:227], v[52:55], a[60:63]
    buffer_load_dwordx4 v11, s[12:15], s23 offen offset:3072 lds
    v_mfma_f32_16x16x32_bf16 a[64:67], v[224:227], v[56:59], a[64:67]
    ds_read_b128 v[196:199], v18 offset:21504
    v_mfma_f32_16x16x32_bf16 a[68:71], v[224:227], v[60:63], a[68:71]
    buffer_load_dwordx4 v[184:187], v16, s[12:15], s24 offen offset:2048
    v_mfma_f32_16x16x32_bf16 a[72:75], v[224:227], v[64:67], a[72:75]
    ds_read_b128 v[200:203], v18 offset:22528
    v_mfma_f32_16x16x32_bf16 a[76:79], v[224:227], v[68:71], a[76:79]
    buffer_load_dwordx4 v[188:191], v17, s[12:15], s24 offen offset:2048
    v_mfma_f32_16x16x32_bf16 a[80:83], v[228:231], v[52:55], a[80:83]
    ds_read_b128 v[204:207], v18 offset:23552
    s_add_u32 m0, s25, 65536
    v_mfma_f32_16x16x32_bf16 a[84:87], v[228:231], v[56:59], a[84:87]
    buffer_load_dwordx4 v12, s[12:15], s23 offen lds
    v_mfma_f32_16x16x32_bf16 a[88:91], v[228:231], v[60:63], a[88:91]
    ds_read_b128 v[208:211], v18 offset:24576
    v_mfma_f32_16x16x32_bf16 a[92:95], v[228:231], v[64:67], a[92:95]
    s_add_u32 s23, s23, 4096
    s_add_u32 s24, s24, 4096
    v_mfma_f32_16x16x32_bf16 a[96:99], v[228:231], v[68:71], a[96:99]
    s_waitcnt lgkmcnt(2)
    v_mfma_f32_16x16x32_bf16 a[0:3], v[192:195], v[72:75], a[0:3]
    ds_read_b128 v[212:215], v18 offset:30720
    s_mov_b32 m0, s25
    v_mfma_f32_16x16x32_bf16 a[4:7], v[192:195], v[76:79], a[4:7]
    buffer_load_dwordx4 v[32:35], v13, s[12:15], s24 offen
    v_mfma_f32_16x16x32_bf16 a[8:11], v[192:195], v[80:83], a[8:11]
    ds_read_b128 v[216:219], v18 offset:31744
    v_mfma_f32_16x16x32_bf16 a[12:15], v[192:195], v[84:87], a[12:15]
    v_mfma_f32_16x16x32_bf16 a[16:19], v[192:195], v[88:91], a[16:19]
    ds_read_b128 v[220:223], v18 offset:32768
    v_mfma_f32_16x16x32_bf16 a[20:23], v[196:199], v[72:75], a[20:23]
    buffer_load_dwordx4 v[36:39], v14, s[12:15], s24 offen
    v_mfma_f32_16x16x32_bf16 a[24:27], v[196:199], v[76:79], a[24:27]
    ds_read_b128 v[224:227], v18 offset:33792
    v_mfma_f32_16x16x32_bf16 a[28:31], v[196:199], v[80:83], a[28:31]
    v_mfma_f32_16x16x32_bf16 a[32:35], v[196:199], v[84:87], a[32:35]
    ds_read_b128 v[228:231], v18 offset:34816
    v_mfma_f32_16x16x32_bf16 a[36:39], v[196:199], v[88:91], a[36:39]
    buffer_load_dwordx4 v8, s[12:15], s23 offen lds
    v_mfma_f32_16x16x32_bf16 a[40:43], v[200:203], v[72:75], a[40:43]
    v_mfma_f32_16x16x32_bf16 a[44:47], v[200:203], v[76:79], a[44:47]
    v_mfma_f32_16x16x32_bf16 a[48:51], v[200:203], v[80:83], a[48:51]
    buffer_load_dwordx4 v[40:43], v15, s[12:15], s24 offen
    v_mfma_f32_16x16x32_bf16 a[52:55], v[200:203], v[84:87], a[52:55]
    v_mfma_f32_16x16x32_bf16 a[56:59], v[200:203], v[88:91], a[56:59]
    s_waitcnt lgkmcnt(0)
    v_mfma_f32_16x16x32_bf16 a[60:63], v[204:207], v[72:75], a[60:63]
    buffer_load_dwordx4 v[44:47], v16, s[12:15], s24 offen
    v_mfma_f32_16x16x32_bf16 a[64:67], v[204:207], v[76:79], a[64:67]
    v_mfma_f32_16x16x32_bf16 a[68:71], v[204:207], v[80:83], a[68:71]
    v_mfma_f32_16x16x32_bf16 a[72:75], v[204:207], v[84:87], a[72:75]
    buffer_load_dwordx4 v9, s[12:15], s23 offen offset:1024 lds
    v_mfma_f32_16x16x32_bf16 a[76:79], v[204:207], v[88:91], a[76:79]
    v_mfma_f32_16x16x32_bf16 a[80:83], v[208:211], v[72:75], a[80:83]
    v_mfma_f32_16x16x32_bf16 a[84:87], v[208:211], v[76:79], a[84:87]
    buffer_load_dwordx4 v[48:51], v17, s[12:15], s24 offen
    v_mfma_f32_16x16x32_bf16 a[88:91], v[208:211], v[80:83], a[88:91]
    v_mfma_f32_16x16x32_bf16 a[92:95], v[208:211], v[84:87], a[92:95]
    v_mfma_f32_16x16x32_bf16 a[96:99], v[208:211], v[88:91], a[96:99]
    buffer_load_dwordx4 v[52:55], v13, s[12:15], s24 offen offset:2048
    v_mfma_f32_16x16x32_bf16 a[0:3], v[212:215], v[92:95], a[0:3]
    v_mfma_f32_16x16x32_bf16 a[4:7], v[212:215], v[96:99], a[4:7]
    v_mfma_f32_16x16x32_bf16 a[8:11], v[212:215], v[100:103], a[8:11]
    buffer_load_dwordx4 v10, s[12:15], s23 offen offset:2048 lds
    v_mfma_f32_16x16x32_bf16 a[12:15], v[212:215], v[104:107], a[12:15]
    v_mfma_f32_16x16x32_bf16 a[16:19], v[212:215], v[108:111], a[16:19]
    v_mfma_f32_16x16x32_bf16 a[20:23], v[216:219], v[92:95], a[20:23]
    buffer_load_dwordx4 v[56:59], v14, s[12:15], s24 offen offset:2048
    v_mfma_f32_16x16x32_bf16 a[24:27], v[216:219], v[96:99], a[24:27]
    v_mfma_f32_16x16x32_bf16 a[28:31], v[216:219], v[100:103], a[28:31]
    v_mfma_f32_16x16x32_bf16 a[32:35], v[216:219], v[104:107], a[32:35]
    buffer_load_dwordx4 v[60:63], v15, s[12:15], s24 offen offset:2048
    v_mfma_f32_16x16x32_bf16 a[36:39], v[216:219], v[108:111], a[36:39]
    v_mfma_f32_16x16x32_bf16 a[40:43], v[220:223], v[92:95], a[40:43]
    v_mfma_f32_16x16x32_bf16 a[44:47], v[220:223], v[96:99], a[44:47]
    s_waitcnt lgkmcnt(0)
    v_mfma_f32_16x16x32_bf16 a[48:51], v[220:223], v[100:103], a[48:51]
    s_waitcnt vmcnt(26)
    v_mfma_f32_16x16x32_bf16 a[52:55], v[220:223], v[104:107], a[52:55]
    s_barrier
    v_mfma_f32_16x16x32_bf16 a[56:59], v[220:223], v[108:111], a[56:59]
    ds_read_b128 v[192:195], v21 offset:0
    v_mfma_f32_16x16x32_bf16 a[60:63], v[224:227], v[92:95], a[60:63]
    buffer_load_dwordx4 v11, s[12:15], s23 offen offset:3072 lds
    v_mfma_f32_16x16x32_bf16 a[64:67], v[224:227], v[96:99], a[64:67]
    ds_read_b128 v[196:199], v21 offset:1024
    v_mfma_f32_16x16x32_bf16 a[68:71], v[224:227], v[100:103], a[68:71]
    buffer_load_dwordx4 v[64:67], v16, s[12:15], s24 offen offset:2048
    v_mfma_f32_16x16x32_bf16 a[72:75], v[224:227], v[104:107], a[72:75]
    ds_read_b128 v[200:203], v21 offset:2048
    v_mfma_f32_16x16x32_bf16 a[76:79], v[224:227], v[108:111], a[76:79]
    buffer_load_dwordx4 v[68:71], v17, s[12:15], s24 offen offset:2048
    v_mfma_f32_16x16x32_bf16 a[80:83], v[228:231], v[92:95], a[80:83]
    ds_read_b128 v[204:207], v21 offset:3072
    s_add_u32 m0, s25, 4096
    v_mfma_f32_16x16x32_bf16 a[84:87], v[228:231], v[96:99], a[84:87]
    buffer_load_dwordx4 v12, s[12:15], s23 offen lds
    v_mfma_f32_16x16x32_bf16 a[88:91], v[228:231], v[100:103], a[88:91]
    ds_read_b128 v[208:211], v21 offset:4096
    v_mfma_f32_16x16x32_bf16 a[92:95], v[228:231], v[104:107], a[92:95]
    s_add_u32 s23, s23, 4096
    s_add_u32 s24, s24, 4096
    v_mfma_f32_16x16x32_bf16 a[96:99], v[228:231], v[108:111], a[96:99]
    s_waitcnt lgkmcnt(2)
    v_mfma_f32_16x16x32_bf16 a[0:3], v[192:195], v[112:115], a[0:3]
    ds_read_b128 v[212:215], v21 offset:10240
    s_add_u32 m0, s25, 20480
    v_mfma_f32_16x16x32_bf16 a[4:7], v[192:195], v[116:119], a[4:7]
    buffer_load_dwordx4 v[72:75], v13, s[12:15], s24 offen
    v_mfma_f32_16x16x32_bf16 a[8:11], v[192:195], v[120:123], a[8:11]
    ds_read_b128 v[216:219], v21 offset:11264
    v_mfma_f32_16x16x32_bf16 a[12:15], v[192:195], v[124:127], a[12:15]
    v_mfma_f32_16x16x32_bf16 a[16:19], v[192:195], v[128:131], a[16:19]
    ds_read_b128 v[220:223], v21 offset:12288
    v_mfma_f32_16x16x32_bf16 a[20:23], v[196:199], v[112:115], a[20:23]
    buffer_load_dwordx4 v[76:79], v14, s[12:15], s24 offen
    v_mfma_f32_16x16x32_bf16 a[24:27], v[196:199], v[116:119], a[24:27]
    ds_read_b128 v[224:227], v21 offset:13312
    v_mfma_f32_16x16x32_bf16 a[28:31], v[196:199], v[120:123], a[28:31]
    v_mfma_f32_16x16x32_bf16 a[32:35], v[196:199], v[124:127], a[32:35]
    ds_read_b128 v[228:231], v21 offset:14336
    v_mfma_f32_16x16x32_bf16 a[36:39], v[196:199], v[128:131], a[36:39]
    buffer_load_dwordx4 v8, s[12:15], s23 offen lds
    v_mfma_f32_16x16x32_bf16 a[40:43], v[200:203], v[112:115], a[40:43]
    v_mfma_f32_16x16x32_bf16 a[44:47], v[200:203], v[116:119], a[44:47]
    v_mfma_f32_16x16x32_bf16 a[48:51], v[200:203], v[120:123], a[48:51]
    buffer_load_dwordx4 v[80:83], v15, s[12:15], s24 offen
    v_mfma_f32_16x16x32_bf16 a[52:55], v[200:203], v[124:127], a[52:55]
    v_mfma_f32_16x16x32_bf16 a[56:59], v[200:203], v[128:131], a[56:59]
    s_waitcnt lgkmcnt(0)
    v_mfma_f32_16x16x32_bf16 a[60:63], v[204:207], v[112:115], a[60:63]
    buffer_load_dwordx4 v[84:87], v16, s[12:15], s24 offen
    v_mfma_f32_16x16x32_bf16 a[64:67], v[204:207], v[116:119], a[64:67]
    v_mfma_f32_16x16x32_bf16 a[68:71], v[204:207], v[120:123], a[68:71]
    v_mfma_f32_16x16x32_bf16 a[72:75], v[204:207], v[124:127], a[72:75]
    buffer_load_dwordx4 v9, s[12:15], s23 offen offset:1024 lds
    v_mfma_f32_16x16x32_bf16 a[76:79], v[204:207], v[128:131], a[76:79]
    v_mfma_f32_16x16x32_bf16 a[80:83], v[208:211], v[112:115], a[80:83]
    v_mfma_f32_16x16x32_bf16 a[84:87], v[208:211], v[116:119], a[84:87]
    buffer_load_dwordx4 v[88:91], v17, s[12:15], s24 offen
    v_mfma_f32_16x16x32_bf16 a[88:91], v[208:211], v[120:123], a[88:91]
    v_mfma_f32_16x16x32_bf16 a[92:95], v[208:211], v[124:127], a[92:95]
    v_mfma_f32_16x16x32_bf16 a[96:99], v[208:211], v[128:131], a[96:99]
    buffer_load_dwordx4 v[92:95], v13, s[12:15], s24 offen offset:2048
    v_mfma_f32_16x16x32_bf16 a[0:3], v[212:215], v[132:135], a[0:3]
    v_mfma_f32_16x16x32_bf16 a[4:7], v[212:215], v[136:139], a[4:7]
    v_mfma_f32_16x16x32_bf16 a[8:11], v[212:215], v[140:143], a[8:11]
    buffer_load_dwordx4 v10, s[12:15], s23 offen offset:2048 lds
    v_mfma_f32_16x16x32_bf16 a[12:15], v[212:215], v[144:147], a[12:15]
    v_mfma_f32_16x16x32_bf16 a[16:19], v[212:215], v[148:151], a[16:19]
    v_mfma_f32_16x16x32_bf16 a[20:23], v[216:219], v[132:135], a[20:23]
    buffer_load_dwordx4 v[96:99], v14, s[12:15], s24 offen offset:2048
    v_mfma_f32_16x16x32_bf16 a[24:27], v[216:219], v[136:139], a[24:27]
    v_mfma_f32_16x16x32_bf16 a[28:31], v[216:219], v[140:143], a[28:31]
    v_mfma_f32_16x16x32_bf16 a[32:35], v[216:219], v[144:147], a[32:35]
    buffer_load_dwordx4 v[100:103], v15, s[12:15], s24 offen offset:2048
    v_mfma_f32_16x16x32_bf16 a[36:39], v[216:219], v[148:151], a[36:39]
    v_mfma_f32_16x16x32_bf16 a[40:43], v[220:223], v[132:135], a[40:43]
    v_mfma_f32_16x16x32_bf16 a[44:47], v[220:223], v[136:139], a[44:47]
    s_waitcnt lgkmcnt(0)
    v_mfma_f32_16x16x32_bf16 a[48:51], v[220:223], v[140:143], a[48:51]
    s_waitcnt vmcnt(26)
    v_mfma_f32_16x16x32_bf16 a[52:55], v[220:223], v[144:147], a[52:55]
    s_barrier
    v_mfma_f32_16x16x32_bf16 a[56:59], v[220:223], v[148:151], a[56:59]
    ds_read_b128 v[192:195], v21 offset:20480
    v_mfma_f32_16x16x32_bf16 a[60:63], v[224:227], v[132:135], a[60:63]
    buffer_load_dwordx4 v11, s[12:15], s23 offen offset:3072 lds
    v_mfma_f32_16x16x32_bf16 a[64:67], v[224:227], v[136:139], a[64:67]
    ds_read_b128 v[196:199], v21 offset:21504
    v_mfma_f32_16x16x32_bf16 a[68:71], v[224:227], v[140:143], a[68:71]
    buffer_load_dwordx4 v[104:107], v16, s[12:15], s24 offen offset:2048
    v_mfma_f32_16x16x32_bf16 a[72:75], v[224:227], v[144:147], a[72:75]
    ds_read_b128 v[200:203], v21 offset:22528
    v_mfma_f32_16x16x32_bf16 a[76:79], v[224:227], v[148:151], a[76:79]
    buffer_load_dwordx4 v[108:111], v17, s[12:15], s24 offen offset:2048
    v_mfma_f32_16x16x32_bf16 a[80:83], v[228:231], v[132:135], a[80:83]
    ds_read_b128 v[204:207], v21 offset:23552
    s_add_u32 m0, s25, 24576
    v_mfma_f32_16x16x32_bf16 a[84:87], v[228:231], v[136:139], a[84:87]
    buffer_load_dwordx4 v12, s[12:15], s23 offen lds
    v_mfma_f32_16x16x32_bf16 a[88:91], v[228:231], v[140:143], a[88:91]
    ds_read_b128 v[208:211], v21 offset:24576
    v_mfma_f32_16x16x32_bf16 a[92:95], v[228:231], v[144:147], a[92:95]
    s_add_u32 s23, s23, 4096
    s_add_u32 s24, s24, 4096
    v_mfma_f32_16x16x32_bf16 a[96:99], v[228:231], v[148:151], a[96:99]
    s_waitcnt lgkmcnt(2)
    v_mfma_f32_16x16x32_bf16 a[0:3], v[192:195], v[152:155], a[0:3]
    ds_read_b128 v[212:215], v21 offset:30720
    s_add_u32 m0, s25, 40960
    v_mfma_f32_16x16x32_bf16 a[4:7], v[192:195], v[156:159], a[4:7]
    buffer_load_dwordx4 v[112:115], v13, s[12:15], s24 offen
    v_mfma_f32_16x16x32_bf16 a[8:11], v[192:195], v[160:163], a[8:11]
    ds_read_b128 v[216:219], v21 offset:31744
    v_mfma_f32_16x16x32_bf16 a[12:15], v[192:195], v[164:167], a[12:15]
    v_mfma_f32_16x16x32_bf16 a[16:19], v[192:195], v[168:171], a[16:19]
    ds_read_b128 v[220:223], v21 offset:32768
    v_mfma_f32_16x16x32_bf16 a[20:23], v[196:199], v[152:155], a[20:23]
    buffer_load_dwordx4 v[116:119], v14, s[12:15], s24 offen
    v_mfma_f32_16x16x32_bf16 a[24:27], v[196:199], v[156:159], a[24:27]
    ds_read_b128 v[224:227], v21 offset:33792
    v_mfma_f32_16x16x32_bf16 a[28:31], v[196:199], v[160:163], a[28:31]
    v_mfma_f32_16x16x32_bf16 a[32:35], v[196:199], v[164:167], a[32:35]
    ds_read_b128 v[228:231], v21 offset:34816
    v_mfma_f32_16x16x32_bf16 a[36:39], v[196:199], v[168:171], a[36:39]
    buffer_load_dwordx4 v8, s[12:15], s23 offen lds
    v_mfma_f32_16x16x32_bf16 a[40:43], v[200:203], v[152:155], a[40:43]
    v_mfma_f32_16x16x32_bf16 a[44:47], v[200:203], v[156:159], a[44:47]
    v_mfma_f32_16x16x32_bf16 a[48:51], v[200:203], v[160:163], a[48:51]
    buffer_load_dwordx4 v[120:123], v15, s[12:15], s24 offen
    v_mfma_f32_16x16x32_bf16 a[52:55], v[200:203], v[164:167], a[52:55]
    v_mfma_f32_16x16x32_bf16 a[56:59], v[200:203], v[168:171], a[56:59]
    s_waitcnt lgkmcnt(0)
    v_mfma_f32_16x16x32_bf16 a[60:63], v[204:207], v[152:155], a[60:63]
    buffer_load_dwordx4 v[124:127], v16, s[12:15], s24 offen
    v_mfma_f32_16x16x32_bf16 a[64:67], v[204:207], v[156:159], a[64:67]
    v_mfma_f32_16x16x32_bf16 a[68:71], v[204:207], v[160:163], a[68:71]
    v_mfma_f32_16x16x32_bf16 a[72:75], v[204:207], v[164:167], a[72:75]
    buffer_load_dwordx4 v9, s[12:15], s23 offen offset:1024 lds
    v_mfma_f32_16x16x32_bf16 a[76:79], v[204:207], v[168:171], a[76:79]
    v_mfma_f32_16x16x32_bf16 a[80:83], v[208:211], v[152:155], a[80:83]
    v_mfma_f32_16x16x32_bf16 a[84:87], v[208:211], v[156:159], a[84:87]
    buffer_load_dwordx4 v[128:131], v17, s[12:15], s24 offen
    v_mfma_f32_16x16x32_bf16 a[88:91], v[208:211], v[160:163], a[88:91]
    v_mfma_f32_16x16x32_bf16 a[92:95], v[208:211], v[164:167], a[92:95]
    v_mfma_f32_16x16x32_bf16 a[96:99], v[208:211], v[168:171], a[96:99]
    buffer_load_dwordx4 v[132:135], v13, s[12:15], s24 offen offset:2048
    v_mfma_f32_16x16x32_bf16 a[0:3], v[212:215], v[172:175], a[0:3]
    v_mfma_f32_16x16x32_bf16 a[4:7], v[212:215], v[176:179], a[4:7]
    v_mfma_f32_16x16x32_bf16 a[8:11], v[212:215], v[180:183], a[8:11]
    buffer_load_dwordx4 v10, s[12:15], s23 offen offset:2048 lds
    v_mfma_f32_16x16x32_bf16 a[12:15], v[212:215], v[184:187], a[12:15]
    v_mfma_f32_16x16x32_bf16 a[16:19], v[212:215], v[188:191], a[16:19]
    v_mfma_f32_16x16x32_bf16 a[20:23], v[216:219], v[172:175], a[20:23]
    buffer_load_dwordx4 v[136:139], v14, s[12:15], s24 offen offset:2048
    v_mfma_f32_16x16x32_bf16 a[24:27], v[216:219], v[176:179], a[24:27]
    v_mfma_f32_16x16x32_bf16 a[28:31], v[216:219], v[180:183], a[28:31]
    v_mfma_f32_16x16x32_bf16 a[32:35], v[216:219], v[184:187], a[32:35]
    buffer_load_dwordx4 v[140:143], v15, s[12:15], s24 offen offset:2048
    v_mfma_f32_16x16x32_bf16 a[36:39], v[216:219], v[188:191], a[36:39]
    v_mfma_f32_16x16x32_bf16 a[40:43], v[220:223], v[172:175], a[40:43]
    v_mfma_f32_16x16x32_bf16 a[44:47], v[220:223], v[176:179], a[44:47]
    s_waitcnt lgkmcnt(0)
    v_mfma_f32_16x16x32_bf16 a[48:51], v[220:223], v[180:183], a[48:51]
    s_waitcnt vmcnt(26)
    v_mfma_f32_16x16x32_bf16 a[52:55], v[220:223], v[184:187], a[52:55]
    s_barrier
    v_mfma_f32_16x16x32_bf16 a[56:59], v[220:223], v[188:191], a[56:59]
    ds_read_b128 v[192:195], v18 offset:0
    v_mfma_f32_16x16x32_bf16 a[60:63], v[224:227], v[172:175], a[60:63]
    buffer_load_dwordx4 v11, s[12:15], s23 offen offset:3072 lds
    v_mfma_f32_16x16x32_bf16 a[64:67], v[224:227], v[176:179], a[64:67]
    ds_read_b128 v[196:199], v18 offset:1024
    v_mfma_f32_16x16x32_bf16 a[68:71], v[224:227], v[180:183], a[68:71]
    buffer_load_dwordx4 v[144:147], v16, s[12:15], s24 offen offset:2048
    v_mfma_f32_16x16x32_bf16 a[72:75], v[224:227], v[184:187], a[72:75]
    ds_read_b128 v[200:203], v18 offset:2048
    v_mfma_f32_16x16x32_bf16 a[76:79], v[224:227], v[188:191], a[76:79]
    buffer_load_dwordx4 v[148:151], v17, s[12:15], s24 offen offset:2048
    v_mfma_f32_16x16x32_bf16 a[80:83], v[228:231], v[172:175], a[80:83]
    ds_read_b128 v[204:207], v18 offset:3072
    s_add_u32 m0, s25, 45056
    v_mfma_f32_16x16x32_bf16 a[84:87], v[228:231], v[176:179], a[84:87]
    buffer_load_dwordx4 v12, s[12:15], s23 offen lds
    v_mfma_f32_16x16x32_bf16 a[88:91], v[228:231], v[180:183], a[88:91]
    ds_read_b128 v[208:211], v18 offset:4096
    v_mfma_f32_16x16x32_bf16 a[92:95], v[228:231], v[184:187], a[92:95]
    s_add_u32 s23, s23, 4096
    s_add_u32 s24, s24, 4096
    v_mfma_f32_16x16x32_bf16 a[96:99], v[228:231], v[188:191], a[96:99]
    s_mov_b32 s26, 6
.p2align 6
L2_loop:
    s_waitcnt lgkmcnt(2)
    v_mfma_f32_16x16x32_bf16 a[0:3], v[192:195], v[32:35], a[0:3]
    ds_read_b128 v[212:215], v18 offset:10240
    s_add_u32 m0, s25, 61440
    v_mfma_f32_16x16x32_bf16 a[4:7], v[192:195], v[36:39], a[4:7]
    buffer_load_dwordx4 v[152:155], v13, s[12:15], s24 offen
    v_mfma_f32_16x16x32_bf16 a[8:11], v[192:195], v[40:43], a[8:11]
    ds_read_b128 v[216:219], v18 offset:11264
    v_mfma_f32_16x16x32_bf16 a[12:15], v[192:195], v[44:47], a[12:15]
    v_mfma_f32_16x16x32_bf16 a[16:19], v[192:195], v[48:51], a[16:19]
    ds_read_b128 v[220:223], v18 offset:12288
    v_mfma_f32_16x16x32_bf16 a[20:23], v[196:199], v[32:35], a[20:23]
    buffer_load_dwordx4 v[156:159], v14, s[12:15], s24 offen
    v_mfma_f32_16x16x32_bf16 a[24:27], v[196:199], v[36:39], a[24:27]
    ds_read_b128 v[224:227], v18 offset:13312
    v_mfma_f32_16x16x32_bf16 a[28:31], v[196:199], v[40:43], a[28:31]
    v_mfma_f32_16x16x32_bf16 a[32:35], v[196:199], v[44:47], a[32:35]
    ds_read_b128 v[228:231], v18 offset:14336
    v_mfma_f32_16x16x32_bf16 a[36:39], v[196:199], v[48:51], a[36:39]
    buffer_load_dwordx4 v8, s[12:15], s23 offen lds
    v_mfma_f32_16x16x32_bf16 a[40:43], v[200:203], v[32:35], a[40:43]
    v_mfma_f32_16x16x32_bf16 a[44:47], v[200:203], v[36:39], a[44:47]
    v_mfma_f32_16x16x32_bf16 a[48:51], v[200:203], v[40:43], a[48:51]
    buffer_load_dwordx4 v[160:163], v15, s[12:15], s24 offen
    v_mfma_f32_16x16x32_bf16 a[52:55], v[200:203], v[44:47], a[52:55]
    v_mfma_f32_16x16x32_bf16 a[56:59], v[200:203], v[48:51], a[56:59]
    s_waitcnt lgkmcnt(0)
    v_mfma_f32_16x16x32_bf16 a[60:63], v[204:207], v[32:35], a[60:63]
    buffer_load_dwordx4 v[164:167], v16, s[12:15], s24 offen
    v_mfma_f32_16x16x32_bf16 a[64:67], v[204:207], v[36:39], a[64:67]
    v_mfma_f32_16x16x32_bf16 a[68:71], v[204:207], v[40:43], a[68:71]
    v_mfma_f32_16x16x32_bf16 a[72:75], v[204:207], v[44:47], a[72:75]
    buffer_load_dwordx4 v9, s[12:15], s23 offen offset:1024 lds
    v_mfma_f32_16x16x32_bf16 a[76:79], v[204:207], v[48:51], a[76:79]
    v_mfma_f32_16x16x32_bf16 a[80:83], v[208:211], v[32:35], a[80:83]
    v_mfma_f32_16x16x32_bf16 a[84:87], v[208:211], v[36:39], a[84:87]
    buffer_load_dwordx4 v[168:171], v17, s[12:15], s24 offen
    v_mfma_f32_16x16x32_bf16 a[88:91], v[208:211], v[40:43], a[88:91]
    v_mfma_f32_16x16x32_bf16 a[92:95], v[208:211], v[44:47], a[92:95]
    v_mfma_f32_16x16x32_bf16 a[96:99], v[208:211], v[48:51], a[96:99]
    buffer_load_dwordx4 v[172:175], v13, s[12:15], s24 offen offset:2048
    v_mfma_f32_16x16x32_bf16 a[0:3], v[212:215], v[52:55], a[0:3]
    v_mfma_f32_16x16x32_bf16 a[4:7], v[212:215], v[56:59], a[4:7]
    v_mfma_f32_16x16x32_bf16 a[8:11], v[212:215], v[60:63], a[8:11]
    buffer_load_dwordx4 v10, s[12:15], s23 offen offset:2048 lds
    v_mfma_f32_16x16x32_bf16 a[12:15], v[212:215], v[64:67], a[12:15]
    v_mfma_f32_16x16x32_bf16 a[16:19], v[212:215], v[68:71], a[16:19]
    v_mfma_f32_16x16x32_bf16 a[20:23], v[216:219], v[52:55], a[20:23]
    buffer_load_dwordx4 v[176:179], v14, s[12:15], s24 offen offset:2048
    v_mfma_f32_16x16x32_bf16 a[24:27], v[216:219], v[56:59], a[24:27]
    v_mfma_f32_16x16x32_bf16 a[28:31], v[216:219], v[60:63], a[28:31]
    v_mfma_f32_16x16x32_bf16 a[32:35], v[216:219], v[64:67], a[32:35]
    buffer_load_dwordx4 v[180:183], v15, s[12:15], s24 offen offset:2048
    v_mfma_f32_16x16x32_bf16 a[36:39], v[216:219], v[68:71], a[36:39]
    v_mfma_f32_16x16x32_bf16 a[40:43], v[220:223], v[52:55], a[40:43]
    v_mfma_f32_16x16x32_bf16 a[44:47], v[220:223], v[56:59], a[44:47]
    s_waitcnt lgkmcnt(0)
    v_mfma_f32_16x16x32_bf16 a[48:51], v[220:223], v[60:63], a[48:51]
    s_waitcnt vmcnt(26)
    v_mfma_f32_16x16x32_bf16 a[52:55], v[220:223], v[64:67], a[52:55]
    s_barrier
    v_mfma_f32_16x16x32_bf16 a[56:59], v[220:223], v[68:71], a[56:59]
    ds_read_b128 v[192:195], v18 offset:20480
    v_mfma_f32_16x16x32_bf16 a[60:63], v[224:227], v[52:55], a[60:63]
    buffer_load_dwordx4 v11, s[12:15], s23 offen offset:3072 lds
    v_mfma_f32_16x16x32_bf16 a[64:67], v[224:227], v[56:59], a[64:67]
    ds_read_b128 v[196:199], v18 offset:21504
    v_mfma_f32_16x16x32_bf16 a[68:71], v[224:227], v[60:63], a[68:71]
    buffer_load_dwordx4 v[184:187], v16, s[12:15], s24 offen offset:2048
    v_mfma_f32_16x16x32_bf16 a[72:75], v[224:227], v[64:67], a[72:75]
    ds_read_b128 v[200:203], v18 offset:22528
    v_mfma_f32_16x16x32_bf16 a[76:79], v[224:227], v[68:71], a[76:79]
    buffer_load_dwordx4 v[188:191], v17, s[12:15], s24 offen offset:2048
    v_mfma_f32_16x16x32_bf16 a[80:83], v[228:231], v[52:55], a[80:83]
    ds_read_b128 v[204:207], v18 offset:23552
    s_add_u32 m0, s25, 65536
    v_mfma_f32_16x16x32_bf16 a[84:87], v[228:231], v[56:59], a[84:87]
    buffer_load_dwordx4 v12, s[12:15], s23 offen lds
    v_mfma_f32_16x16x32_bf16 a[88:91], v[228:231], v[60:63], a[88:91]
    ds_read_b128 v[208:211], v18 offset:24576
    v_mfma_f32_16x16x32_bf16 a[92:95], v[228:231], v[64:67], a[92:95]
    s_add_u32 s23, s23, 4096
    s_add_u32 s24, s24, 4096
    v_mfma_f32_16x16x32_bf16 a[96:99], v[228:231], v[68:71], a[96:99]
    s_waitcnt lgkmcnt(2)
    v_mfma_f32_16x16x32_bf16 a[0:3], v[192:195], v[72:75], a[0:3]
    ds_read_b128 v[212:215], v18 offset:30720
    s_mov_b32 m0, s25
    v_mfma_f32_16x16x32_bf16 a[4:7], v[192:195], v[76:79], a[4:7]
    buffer_load_dwordx4 v[32:35], v13, s[12:15], s24 offen
    v_mfma_f32_16x16x32_bf16 a[8:11], v[192:195], v[80:83], a[8:11]
    ds_read_b128 v[216:219], v18 offset:31744
    v_mfma_f32_16x16x32_bf16 a[12:15], v[192:195], v[84:87], a[12:15]
    v_mfma_f32_16x16x32_bf16 a[16:19], v[192:195], v[88:91], a[16:19]
    ds_read_b128 v[220:223], v18 offset:32768
    v_mfma_f32_16x16x32_bf16 a[20:23], v[196:199], v[72:75], a[20:23]
    buffer_load_dwordx4 v[36:39], v14, s[12:15], s24 offen
    v_mfma_f32_16x16x32_bf16 a[24:27], v[196:199], v[76:79], a[24:27]
    ds_read_b128 v[224:227], v18 offset:33792
    v_mfma_f32_16x16x32_bf16 a[28:31], v[196:199], v[80:83], a[28:31]
    v_mfma_f32_16x16x32_bf16 a[32:35], v[196:199], v[84:87], a[32:35]
    ds_read_b128 v[228:231], v18 offset:34816
    v_mfma_f32_16x16x32_bf16 a[36:39], v[196:199], v[88:91], a[36:39]
    buffer_load_dwordx4 v8, s[12:15], s23 offen lds
    v_mfma_f32_16x16x32_bf16 a[40:43], v[200:203], v[72:75], a[40:43]
    v_mfma_f32_16x16x32_bf16 a[44:47], v[200:203], v[76:79], a[44:47]
    v_mfma_f32_16x16x32_bf16 a[48:51], v[200:203], v[80:83], a[48:51]
    buffer_load_dwordx4 v[40:43], v15, s[12:15], s24 offen
    v_mfma_f32_16x16x32_bf16 a[52:55], v[200:203], v[84:87], a[52:55]
    v_mfma_f32_16x16x32_bf16 a[56:59], v[200:203], v[88:91], a[56:59]
    s_waitcnt lgkmcnt(0)
    v_mfma_f32_16x16x32_bf16 a[60:63], v[204:207], v[72:75], a[60:63]
    buffer_load_dwordx4 v[44:47], v16, s[12:15], s24 offen
    v_mfma_f32_16x16x32_bf16 a[64:67], v[204:207], v[76:79], a[64:67]
    v_mfma_f32_16x16x32_bf16 a[68:71], v[204:207], v[80:83], a[68:71]
    v_mfma_f32_16x16x32_bf16 a[72:75], v[204:207], v[84:87], a[72:75]
    buffer_load_dwordx4 v9, s[12:15], s23 offen offset:1024 lds
    v_mfma_f32_16x16x32_bf16 a[76:79], v[204:207], v[88:91], a[76:79]
    v_mfma_f32_16x16x32_bf16 a[80:83], v[208:211], v[72:75], a[80:83]
    v_mfma_f32_16x16x32_bf16 a[84:87], v[208:211], v[76:79], a[84:87]
    buffer_load_dwordx4 v[48:51], v17, s[12:15], s24 offen
    v_mfma_f32_16x16x32_bf16 a[88:91], v[208:211], v[80:83], a[88:91]
    v_mfma_f32_16x16x32_bf16 a[92:95], v[208:211], v[84:87], a[92:95]
    v_mfma_f32_16x16x32_bf16 a[96:99], v[208:211], v[88:91], a[96:99]
    buffer_load_dwordx4 v[52:55], v13, s[12:15], s24 offen offset:2048
    v_mfma_f32_16x16x32_bf16 a[0:3], v[212:215], v[92:95], a[0:3]
    v_mfma_f32_16x16x32_bf16 a[4:7], v[212:215], v[96:99], a[4:7]
    v_mfma_f32_16x16x32_bf16 a[8:11], v[212:215], v[100:103], a[8:11]
    buffer_load_dwordx4 v10, s[12:15], s23 offen offset:2048 lds
    v_mfma_f32_16x16x32_bf16 a[12:15], v[212:215], v[104:107], a[12:15]
    v_mfma_f32_16x16x32_bf16 a[16:19], v[212:215], v[108:111], a[16:19]
    v_mfma_f32_16x16x32_bf16 a[20:23], v[216:219], v[92:95], a[20:23]
    buffer_load_dwordx4 v[56:59], v14, s[12:15], s24 offen offset:2048
    v_mfma_f32_16x16x32_bf16 a[24:27], v[216:219], v[96:99], a[24:27]
    v_mfma_f32_16x16x32_bf16 a[28:31], v[216:219], v[100:103], a[28:31]
    v_mfma_f32_16x16x32_bf16 a[32:35], v[216:219], v[104:107], a[32:35]
    buffer_load_dwordx4 v[60:63], v15, s[12:15], s24 offen offset:2048
    v_mfma_f32_16x16x32_bf16 a[36:39], v[216:219], v[108:111], a[36:39]
    v_mfma_f32_16x16x32_bf16 a[40:43], v[220:223], v[92:95], a[40:43]
    v_mfma_f32_16x16x32_bf16 a[44:47], v[220:223], v[96:99], a[44:47]
    s_waitcnt lgkmcnt(0)
    v_mfma_f32_16x16x32_bf16 a[48:51], v[220:223], v[100:103], a[48:51]
    s_waitcnt vmcnt(26)
    v_mfma_f32_16x16x32_bf16 a[52:55], v[220:223], v[104:107], a[52:55]
    s_barrier
    v_mfma_f32_16x16x32_bf16 a[56:59], v[220:223], v[108:111], a[56:59]
    ds_read_b128 v[192:195], v21 offset:0
    v_mfma_f32_16x16x32_bf16 a[60:63], v[224:227], v[92:95], a[60:63]
    buffer_load_dwordx4 v11, s[12:15], s23 offen offset:3072 lds
    v_mfma_f32_16x16x32_bf16 a[64:67], v[224:227], v[96:99], a[64:67]
    ds_read_b128 v[196:199], v21 offset:1024
    v_mfma_f32_16x16x32_bf16 a[68:71], v[224:227], v[100:103], a[68:71]
    buffer_load_dwordx4 v[64:67], v16, s[12:15], s24 offen offset:2048
    v_mfma_f32_16x16x32_bf16 a[72:75], v[224:227], v[104:107], a[72:75]
    ds_read_b128 v[200:203], v21 offset:2048
    v_mfma_f32_16x16x32_bf16 a[76:79], v[224:227], v[108:111], a[76:79]
    buffer_load_dwordx4 v[68:71], v17, s[12:15], s24 offen offset:2048
    v_mfma_f32_16x16x32_bf16 a[80:83], v[228:231], v[92:95], a[80:83]
    ds_read_b128 v[204:207], v21 offset:3072
    s_add_u32 m0, s25, 4096
    v_mfma_f32_16x16x32_bf16 a[84:87], v[228:231], v[96:99], a[84:87]
    buffer_load_dwordx4 v12, s[12:15], s23 offen lds
    v_mfma_f32_16x16x32_bf16 a[88:91], v[228:231], v[100:103], a[88:91]
    ds_read_b128 v[208:211], v21 offset:4096
    v_mfma_f32_16x16x32_bf16 a[92:95], v[228:231], v[104:107], a[92:95]
    s_add_u32 s23, s23, 4096
    s_add_u32 s24, s24, 4096
    v_mfma_f32_16x16x32_bf16 a[96:99], v[228:231], v[108:111], a[96:99]
    s_waitcnt lgkmcnt(2)
    v_mfma_f32_16x16x32_bf16 a[0:3], v[192:195], v[112:115], a[0:3]
    ds_read_b128 v[212:215], v21 offset:10240
    s_add_u32 m0, s25, 20480
    v_mfma_f32_16x16x32_bf16 a[4:7], v[192:195], v[116:119], a[4:7]
    buffer_load_dwordx4 v[72:75], v13, s[12:15], s24 offen
    v_mfma_f32_16x16x32_bf16 a[8:11], v[192:195], v[120:123], a[8:11]
    ds_read_b128 v[216:219], v21 offset:11264
    v_mfma_f32_16x16x32_bf16 a[12:15], v[192:195], v[124:127], a[12:15]
    v_mfma_f32_16x16x32_bf16 a[16:19], v[192:195], v[128:131], a[16:19]
    ds_read_b128 v[220:223], v21 offset:12288
    v_mfma_f32_16x16x32_bf16 a[20:23], v[196:199], v[112:115], a[20:23]
    buffer_load_dwordx4 v[76:79], v14, s[12:15], s24 offen
    v_mfma_f32_16x16x32_bf16 a[24:27], v[196:199], v[116:119], a[24:27]
    ds_read_b128 v[224:227], v21 offset:13312
    v_mfma_f32_16x16x32_bf16 a[28:31], v[196:199], v[120:123], a[28:31]
    v_mfma_f32_16x16x32_bf16 a[32:35], v[196:199], v[124:127], a[32:35]
    ds_read_b128 v[228:231], v21 offset:14336
    v_mfma_f32_16x16x32_bf16 a[36:39], v[196:199], v[128:131], a[36:39]
    buffer_load_dwordx4 v8, s[12:15], s23 offen lds
    v_mfma_f32_16x16x32_bf16 a[40:43], v[200:203], v[112:115], a[40:43]
    v_mfma_f32_16x16x32_bf16 a[44:47], v[200:203], v[116:119], a[44:47]
    v_mfma_f32_16x16x32_bf16 a[48:51], v[200:203], v[120:123], a[48:51]
    buffer_load_dwordx4 v[80:83], v15, s[12:15], s24 offen
    v_mfma_f32_16x16x32_bf16 a[52:55], v[200:203], v[124:127], a[52:55]
    v_mfma_f32_16x16x32_bf16 a[56:59], v[200:203], v[128:131], a[56:59]
    s_waitcnt lgkmcnt(0)
    v_mfma_f32_16x16x32_bf16 a[60:63], v[204:207], v[112:115], a[60:63]
    buffer_load_dwordx4 v[84:87], v16, s[12:15], s24 offen
    v_mfma_f32_16x16x32_bf16 a[64:67], v[204:207], v[116:119], a[64:67]
    v_mfma_f32_16x16x32_bf16 a[68:71], v[204:207], v[120:123], a[68:71]
    v_mfma_f32_16x16x32_bf16 a[72:75], v[204:207], v[124:127], a[72:75]
    buffer_load_dwordx4 v9, s[12:15], s23 offen offset:1024 lds
    v_mfma_f32_16x16x32_bf16 a[76:79], v[204:207], v[128:131], a[76:79]
    v_mfma_f32_16x16x32_bf16 a[80:83], v[208:211], v[112:115], a[80:83]
    v_mfma_f32_16x16x32_bf16 a[84:87], v[208:211], v[116:119], a[84:87]
    buffer_load_dwordx4 v[88:91], v17, s[12:15], s24 offen
    v_mfma_f32_16x16x32_bf16 a[88:91], v[208:211], v[120:123], a[88:91]
    v_mfma_f32_16x16x32_bf16 a[92:95], v[208:211], v[124:127], a[92:95]
    v_mfma_f32_16x16x32_bf16 a[96:99], v[208:211], v[128:131], a[96:99]
    buffer_load_dwordx4 v[92:95], v13, s[12:15], s24 offen offset:2048
    v_mfma_f32_16x16x32_bf16 a[0:3], v[212:215], v[132:135], a[0:3]
    v_mfma_f32_16x16x32_bf16 a[4:7], v[212:215], v[136:139], a[4:7]
    v_mfma_f32_16x16x32_bf16 a[8:11], v[212:215], v[140:143], a[8:11]
    buffer_load_dwordx4 v10, s[12:15], s23 offen offset:2048 lds
    v_mfma_f32_16x16x32_bf16 a[12:15], v[212:215], v[144:147], a[12:15]
    v_mfma_f32_16x16x32_bf16 a[16:19], v[212:215], v[148:151], a[16:19]
    v_mfma_f32_16x16x32_bf16 a[20:23], v[216:219], v[132:135], a[20:23]
    buffer_load_dwordx4 v[96:99], v14, s[12:15], s24 offen offset:2048
    v_mfma_f32_16x16x32_bf16 a[24:27], v[216:219], v[136:139], a[24:27]
    v_mfma_f32_16x16x32_bf16 a[28:31], v[216:219], v[140:143], a[28:31]
    v_mfma_f32_16x16x32_bf16 a[32:35], v[216:219], v[144:147], a[32:35]
    buffer_load_dwordx4 v[100:103], v15, s[12:15], s24 offen offset:2048
    v_mfma_f32_16x16x32_bf16 a[36:39], v[216:219], v[148:151], a[36:39]
    v_mfma_f32_16x16x32_bf16 a[40:43], v[220:223], v[132:135], a[40:43]
    v_mfma_f32_16x16x32_bf16 a[44:47], v[220:223], v[136:139], a[44:47]
    s_waitcnt lgkmcnt(0)
    v_mfma_f32_16x16x32_bf16 a[48:51], v[220:223], v[140:143], a[48:51]
    s_waitcnt vmcnt(26)
    v_mfma_f32_16x16x32_bf16 a[52:55], v[220:223], v[144:147], a[52:55]
    s_barrier
    v_mfma_f32_16x16x32_bf16 a[56:59], v[220:223], v[148:151], a[56:59]
    ds_read_b128 v[192:195], v21 offset:20480
    v_mfma_f32_16x16x32_bf16 a[60:63], v[224:227], v[132:135], a[60:63]
    buffer_load_dwordx4 v11, s[12:15], s23 offen offset:3072 lds
    v_mfma_f32_16x16x32_bf16 a[64:67], v[224:227], v[136:139], a[64:67]
    ds_read_b128 v[196:199], v21 offset:21504
    v_mfma_f32_16x16x32_bf16 a[68:71], v[224:227], v[140:143], a[68:71]
    buffer_load_dwordx4 v[104:107], v16, s[12:15], s24 offen offset:2048
    v_mfma_f32_16x16x32_bf16 a[72:75], v[224:227], v[144:147], a[72:75]
    ds_read_b128 v[200:203], v21 offset:22528
    v_mfma_f32_16x16x32_bf16 a[76:79], v[224:227], v[148:151], a[76:79]
    buffer_load_dwordx4 v[108:111], v17, s[12:15], s24 offen offset:2048
    v_mfma_f32_16x16x32_bf16 a[80:83], v[228:231], v[132:135], a[80:83]
    ds_read_b128 v[204:207], v21 offset:23552
    s_add_u32 m0, s25, 24576
    v_mfma_f32_16x16x32_bf16 a[84:87], v[228:231], v[136:139], a[84:87]
    buffer_load_dwordx4 v12, s[12:15], s23 offen lds
    v_mfma_f32_16x16x32_bf16 a[88:91], v[228:231], v[140:143], a[88:91]
    ds_read_b128 v[208:211], v21 offset:24576
    v_mfma_f32_16x16x32_bf16 a[92:95], v[228:231], v[144:147], a[92:95]
    s_add_u32 s23, s23, 4096
    s_add_u32 s24, s24, 4096
    v_mfma_f32_16x16x32_bf16 a[96:99], v[228:231], v[148:151], a[96:99]
    s_waitcnt lgkmcnt(2)
    v_mfma_f32_16x16x32_bf16 a[0:3], v[192:195], v[152:155], a[0:3]
    ds_read_b128 v[212:215], v21 offset:30720
    s_add_u32 m0, s25, 40960
    v_mfma_f32_16x16x32_bf16 a[4:7], v[192:195], v[156:159], a[4:7]
    buffer_load_dwordx4 v[112:115], v13, s[12:15], s24 offen
    v_mfma_f32_16x16x32_bf16 a[8:11], v[192:195], v[160:163], a[8:11]
    ds_read_b128 v[216:219], v21 offset:31744
    v_mfma_f32_16x16x32_bf16 a[12:15], v[192:195], v[164:167], a[12:15]
    v_mfma_f32_16x16x32_bf16 a[16:19], v[192:195], v[168:171], a[16:19]
    ds_read_b128 v[220:223], v21 offset:32768
    v_mfma_f32_16x16x32_bf16 a[20:23], v[196:199], v[152:155], a[20:23]
    buffer_load_dwordx4 v[116:119], v14, s[12:15], s24 offen
    v_mfma_f32_16x16x32_bf16 a[24:27], v[196:199], v[156:159], a[24:27]
    ds_read_b128 v[224:227], v21 offset:33792
    v_mfma_f32_16x16x32_bf16 a[28:31], v[196:199], v[160:163], a[28:31]
    v_mfma_f32_16x16x32_bf16 a[32:35], v[196:199], v[164:167], a[32:35]
    ds_read_b128 v[228:231], v21 offset:34816
    v_mfma_f32_16x16x32_bf16 a[36:39], v[196:199], v[168:171], a[36:39]
    buffer_load_dwordx4 v8, s[12:15], s23 offen lds
    v_mfma_f32_16x16x32_bf16 a[40:43], v[200:203], v[152:155], a[40:43]
    v_mfma_f32_16x16x32_bf16 a[44:47], v[200:203], v[156:159], a[44:47]
    v_mfma_f32_16x16x32_bf16 a[48:51], v[200:203], v[160:163], a[48:51]
    buffer_load_dwordx4 v[120:123], v15, s[12:15], s24 offen
    v_mfma_f32_16x16x32_bf16 a[52:55], v[200:203], v[164:167], a[52:55]
    v_mfma_f32_16x16x32_bf16 a[56:59], v[200:203], v[168:171], a[56:59]
    s_waitcnt lgkmcnt(0)
    v_mfma_f32_16x16x32_bf16 a[60:63], v[204:207], v[152:155], a[60:63]
    buffer_load_dwordx4 v[124:127], v16, s[12:15], s24 offen
    v_mfma_f32_16x16x32_bf16 a[64:67], v[204:207], v[156:159], a[64:67]
    v_mfma_f32_16x16x32_bf16 a[68:71], v[204:207], v[160:163], a[68:71]
    v_mfma_f32_16x16x32_bf16 a[72:75], v[204:207], v[164:167], a[72:75]
    buffer_load_dwordx4 v9, s[12:15], s23 offen offset:1024 lds
    v_mfma_f32_16x16x32_bf16 a[76:79], v[204:207], v[168:171], a[76:79]
    v_mfma_f32_16x16x32_bf16 a[80:83], v[208:211], v[152:155], a[80:83]
    v_mfma_f32_16x16x32_bf16 a[84:87], v[208:211], v[156:159], a[84:87]
    buffer_load_dwordx4 v[128:131], v17, s[12:15], s24 offen
    v_mfma_f32_16x16x32_bf16 a[88:91], v[208:211], v[160:163], a[88:91]
    v_mfma_f32_16x16x32_bf16 a[92:95], v[208:211], v[164:167], a[92:95]
    v_mfma_f32_16x16x32_bf16 a[96:99], v[208:211], v[168:171], a[96:99]
    buffer_load_dwordx4 v[132:135], v13, s[12:15], s24 offen offset:2048
    v_mfma_f32_16x16x32_bf16 a[0:3], v[212:215], v[172:175], a[0:3]
    v_mfma_f32_16x16x32_bf16 a[4:7], v[212:215], v[176:179], a[4:7]
    v_mfma_f32_16x16x32_bf16 a[8:11], v[212:215], v[180:183], a[8:11]
    buffer_load_dwordx4 v10, s[12:15], s23 offen offset:2048 lds
    v_mfma_f32_16x16x32_bf16 a[12:15], v[212:215], v[184:187], a[12:15]
    v_mfma_f32_16x16x32_bf16 a[16:19], v[212:215], v[188:191], a[16:19]
    v_mfma_f32_16x16x32_bf16 a[20:23], v[216:219], v[172:175], a[20:23]
    buffer_load_dwordx4 v[136:139], v14, s[12:15], s24 offen offset:2048
    v_mfma_f32_16x16x32_bf16 a[24:27], v[216:219], v[176:179], a[24:27]
    v_mfma_f32_16x16x32_bf16 a[28:31], v[216:219], v[180:183], a[28:31]
    v_mfma_f32_16x16x32_bf16 a[32:35], v[216:219], v[184:187], a[32:35]
    buffer_load_dwordx4 v[140:143], v15, s[12:15], s24 offen offset:2048
    v_mfma_f32_16x16x32_bf16 a[36:39], v[216:219], v[188:191], a[36:39]
    v_mfma_f32_16x16x32_bf16 a[40:43], v[220:223], v[172:175], a[40:43]
    v_mfma_f32_16x16x32_bf16 a[44:47], v[220:223], v[176:179], a[44:47]
    s_waitcnt lgkmcnt(0)
    v_mfma_f32_16x16x32_bf16 a[48:51], v[220:223], v[180:183], a[48:51]
    s_waitcnt vmcnt(26)
    v_mfma_f32_16x16x32_bf16 a[52:55], v[220:223], v[184:187], a[52:55]
    s_barrier
    v_mfma_f32_16x16x32_bf16 a[56:59], v[220:223], v[188:191], a[56:59]
    ds_read_b128 v[192:195], v18 offset:0
    v_mfma_f32_16x16x32_bf16 a[60:63], v[224:227], v[172:175], a[60:63]
    buffer_load_dwordx4 v11, s[12:15], s23 offen offset:3072 lds
    v_mfma_f32_16x16x32_bf16 a[64:67], v[224:227], v[176:179], a[64:67]
    ds_read_b128 v[196:199], v18 offset:1024
    v_mfma_f32_16x16x32_bf16 a[68:71], v[224:227], v[180:183], a[68:71]
    buffer_load_dwordx4 v[144:147], v16, s[12:15], s24 offen offset:2048
    v_mfma_f32_16x16x32_bf16 a[72:75], v[224:227], v[184:187], a[72:75]
    ds_read_b128 v[200:203], v18 offset:2048
    v_mfma_f32_16x16x32_bf16 a[76:79], v[224:227], v[188:191], a[76:79]
    buffer_load_dwordx4 v[148:151], v17, s[12:15], s24 offen offset:2048
    v_mfma_f32_16x16x32_bf16 a[80:83], v[228:231], v[172:175], a[80:83]
    ds_read_b128 v[204:207], v18 offset:3072
    s_add_u32 m0, s25, 45056
    v_mfma_f32_16x16x32_bf16 a[84:87], v[228:231], v[176:179], a[84:87]
    buffer_load_dwordx4 v12, s[12:15], s23 offen lds
    v_mfma_f32_16x16x32_bf16 a[88:91], v[228:231], v[180:183], a[88:91]
    ds_read_b128 v[208:211], v18 offset:4096
    v_mfma_f32_16x16x32_bf16 a[92:95], v[228:231], v[184:187], a[92:95]
    s_add_u32 s23, s23, 4096
    s_add_u32 s24, s24, 4096
    v_mfma_f32_16x16x32_bf16 a[96:99], v[228:231], v[188:191], a[96:99]
    s_sub_u32 s26, s26, 1
    s_cmp_lg_u32 s26, 0
    s_cbranch_scc1 L2_loop
    s_waitcnt lgkmcnt(2)
    v_mfma_f32_16x16x32_bf16 a[0:3], v[192:195], v[32:35], a[0:3]
    ds_read_b128 v[212:215], v18 offset:10240
    s_add_u32 m0, s25, 61440
    v_mfma_f32_16x16x32_bf16 a[4:7], v[192:195], v[36:39], a[4:7]
    buffer_load_dwordx4 v[152:155], v13, s[12:15], s24 offen
    v_mfma_f32_16x16x32_bf16 a[8:11], v[192:195], v[40:43], a[8:11]
    ds_read_b128 v[216:219], v18 offset:11264
    v_mfma_f32_16x16x32_bf16 a[12:15], v[192:195], v[44:47], a[12:15]
    v_mfma_f32_16x16x32_bf16 a[16:19], v[192:195], v[48:51], a[16:19]
    ds_read_b128 v[220:223], v18 offset:12288
    v_mfma_f32_16x16x32_bf16 a[20:23], v[196:199], v[32:35], a[20:23]
    buffer_load_dwordx4 v[156:159], v14, s[12:15], s24 offen
    v_mfma_f32_16x16x32_bf16 a[24:27], v[196:199], v[36:39], a[24:27]
    ds_read_b128 v[224:227], v18 offset:13312
    v_mfma_f32_16x16x32_bf16 a[28:31], v[196:199], v[40:43], a[28:31]
    v_mfma_f32_16x16x32_bf16 a[32:35], v[196:199], v[44:47], a[32:35]
    ds_read_b128 v[228:231], v18 offset:14336
    v_mfma_f32_16x16x32_bf16 a[36:39], v[196:199], v[48:51], a[36:39]
    buffer_load_dwordx4 v8, s[12:15], s23 offen lds
    v_mfma_f32_16x16x32_bf16 a[40:43], v[200:203], v[32:35], a[40:43]
    v_mfma_f32_16x16x32_bf16 a[44:47], v[200:203], v[36:39], a[44:47]
    v_mfma_f32_16x16x32_bf16 a[48:51], v[200:203], v[40:43], a[48:51]
    buffer_load_dwordx4 v[160:163], v15, s[12:15], s24 offen
    v_mfma_f32_16x16x32_bf16 a[52:55], v[200:203], v[44:47], a[52:55]
    v_mfma_f32_16x16x32_bf16 a[56:59], v[200:203], v[48:51], a[56:59]
    s_waitcnt lgkmcnt(0)
    v_mfma_f32_16x16x32_bf16 a[60:63], v[204:207], v[32:35], a[60:63]
    buffer_load_dwordx4 v[164:167], v16, s[12:15], s24 offen
    v_mfma_f32_16x16x32_bf16 a[64:67], v[204:207], v[36:39], a[64:67]
    v_mfma_f32_16x16x32_bf16 a[68:71], v[204:207], v[40:43], a[68:71]
    v_mfma_f32_16x16x32_bf16 a[72:75], v[204:207], v[44:47], a[72:75]
    buffer_load_dwordx4 v9, s[12:15], s23 offen offset:1024 lds
    v_mfma_f32_16x16x32_bf16 a[76:79], v[204:207], v[48:51], a[76:79]
    v_mfma_f32_16x16x32_bf16 a[80:83], v[208:211], v[32:35], a[80:83]
    v_mfma_f32_16x16x32_bf16 a[84:87], v[208:211], v[36:39], a[84:87]
    buffer_load_dwordx4 v[168:171], v17, s[12:15], s24 offen
    v_mfma_f32_16x16x32_bf16 a[88:91], v[208:211], v[40:43], a[88:91]
    v_mfma_f32_16x16x32_bf16 a[92:95], v[208:211], v[44:47], a[92:95]
    v_mfma_f32_16x16x32_bf16 a[96:99], v[208:211], v[48:51], a[96:99]
    buffer_load_dwordx4 v[172:175], v13, s[12:15], s24 offen offset:2048
    v_mfma_f32_16x16x32_bf16 a[0:3], v[212:215], v[52:55], a[0:3]
    v_mfma_f32_16x16x32_bf16 a[4:7], v[212:215], v[56:59], a[4:7]
    v_mfma_f32_16x16x32_bf16 a[8:11], v[212:215], v[60:63], a[8:11]
    buffer_load_dwordx4 v10, s[12:15], s23 offen offset:2048 lds
    v_mfma_f32_16x16x32_bf16 a[12:15], v[212:215], v[64:67], a[12:15]
    v_mfma_f32_16x16x32_bf16 a[16:19], v[212:215], v[68:71], a[16:19]
    v_mfma_f32_16x16x32_bf16 a[20:23], v[216:219], v[52:55], a[20:23]
    buffer_load_dwordx4 v[176:179], v14, s[12:15], s24 offen offset:2048
    v_mfma_f32_16x16x32_bf16 a[24:27], v[216:219], v[56:59], a[24:27]
    v_mfma_f32_16x16x32_bf16 a[28:31], v[216:219], v[60:63], a[28:31]
    v_mfma_f32_16x16x32_bf16 a[32:35], v[216:219], v[64:67], a[32:35]
    buffer_load_dwordx4 v[180:183], v15, s[12:15], s24 offen offset:2048
    v_mfma_f32_16x16x32_bf16 a[36:39], v[216:219], v[68:71], a[36:39]
    v_mfma_f32_16x16x32_bf16 a[40:43], v[220:223], v[52:55], a[40:43]
    v_mfma_f32_16x16x32_bf16 a[44:47], v[220:223], v[56:59], a[44:47]
    s_waitcnt lgkmcnt(0)
    v_mfma_f32_16x16x32_bf16 a[48:51], v[220:223], v[60:63], a[48:51]
    s_waitcnt vmcnt(26)
    v_mfma_f32_16x16x32_bf16 a[52:55], v[220:223], v[64:67], a[52:55]
    s_barrier
    v_mfma_f32_16x16x32_bf16 a[56:59], v[220:223], v[68:71], a[56:59]
    ds_read_b128 v[192:195], v18 offset:20480
    v_mfma_f32_16x16x32_bf16 a[60:63], v[224:227], v[52:55], a[60:63]
    buffer_load_dwordx4 v11, s[12:15], s23 offen offset:3072 lds
    v_mfma_f32_16x16x32_bf16 a[64:67], v[224:227], v[56:59], a[64:67]
    ds_read_b128 v[196:199], v18 offset:21504
    v_mfma_f32_16x16x32_bf16 a[68:71], v[224:227], v[60:63], a[68:71]
    buffer_load_dwordx4 v[184:187], v16, s[12:15], s24 offen offset:2048
    v_mfma_f32_16x16x32_bf16 a[72:75], v[224:227], v[64:67], a[72:75]
    ds_read_b128 v[200:203], v18 offset:22528
    v_mfma_f32_16x16x32_bf16 a[76:79], v[224:227], v[68:71], a[76:79]
    buffer_load_dwordx4 v[188:191], v17, s[12:15], s24 offen offset:2048
    v_mfma_f32_16x16x32_bf16 a[80:83], v[228:231], v[52:55], a[80:83]
    ds_read_b128 v[204:207], v18 offset:23552
    s_add_u32 m0, s25, 65536
    v_mfma_f32_16x16x32_bf16 a[84:87], v[228:231], v[56:59], a[84:87]
    buffer_load_dwordx4 v12, s[12:15], s23 offen lds
    v_mfma_f32_16x16x32_bf16 a[88:91], v[228:231], v[60:63], a[88:91]
    ds_read_b128 v[208:211], v18 offset:24576
    v_mfma_f32_16x16x32_bf16 a[92:95], v[228:231], v[64:67], a[92:95]
    s_add_u32 s23, s23, 4096
    s_add_u32 s24, s24, 4096
    v_mfma_f32_16x16x32_bf16 a[96:99], v[228:231], v[68:71], a[96:99]
    s_waitcnt lgkmcnt(2)
    v_mfma_f32_16x16x32_bf16 a[0:3], v[192:195], v[72:75], a[0:3]
    ds_read_b128 v[212:215], v18 offset:30720
    v_mfma_f32_16x16x32_bf16 a[4:7], v[192:195], v[76:79], a[4:7]
    v_mfma_f32_16x16x32_bf16 a[8:11], v[192:195], v[80:83], a[8:11]
    ds_read_b128 v[216:219], v18 offset:31744
    v_mfma_f32_16x16x32_bf16 a[12:15], v[192:195], v[84:87], a[12:15]
    v_mfma_f32_16x16x32_bf16 a[16:19], v[192:195], v[88:91], a[16:19]
    ds_read_b128 v[220:223], v18 offset:32768
    v_mfma_f32_16x16x32_bf16 a[20:23], v[196:199], v[72:75], a[20:23]
    v_mfma_f32_16x16x32_bf16 a[24:27], v[196:199], v[76:79], a[24:27]
    ds_read_b128 v[224:227], v18 offset:33792
    v_mfma_f32_16x16x32_bf16 a[28:31], v[196:199], v[80:83], a[28:31]
    v_mfma_f32_16x16x32_bf16 a[32:35], v[196:199], v[84:87], a[32:35]
    ds_read_b128 v[228:231], v18 offset:34816
    v_mfma_f32_16x16x32_bf16 a[36:39], v[196:199], v[88:91], a[36:39]
    v_mfma_f32_16x16x32_bf16 a[40:43], v[200:203], v[72:75], a[40:43]
    v_mfma_f32_16x16x32_bf16 a[44:47], v[200:203], v[76:79], a[44:47]
    v_mfma_f32_16x16x32_bf16 a[48:51], v[200:203], v[80:83], a[48:51]
    v_mfma_f32_16x16x32_bf16 a[52:55], v[200:203], v[84:87], a[52:55]
    v_mfma_f32_16x16x32_bf16 a[56:59], v[200:203], v[88:91], a[56:59]
    s_waitcnt lgkmcnt(0)
    v_mfma_f32_16x16x32_bf16 a[60:63], v[204:207], v[72:75], a[60:63]
    v_mfma_f32_16x16x32_bf16 a[64:67], v[204:207], v[76:79], a[64:67]
    v_mfma_f32_16x16x32_bf16 a[68:71], v[204:207], v[80:83], a[68:71]
    v_mfma_f32_16x16x32_bf16 a[72:75], v[204:207], v[84:87], a[72:75]
    v_mfma_f32_16x16x32_bf16 a[76:79], v[204:207], v[88:91], a[76:79]
    v_mfma_f32_16x16x32_bf16 a[80:83], v[208:211], v[72:75], a[80:83]
    v_mfma_f32_16x16x32_bf16 a[84:87], v[208:211], v[76:79], a[84:87]
    v_mfma_f32_16x16x32_bf16 a[88:91], v[208:211], v[80:83], a[88:91]
    v_mfma_f32_16x16x32_bf16 a[92:95], v[208:211], v[84:87], a[92:95]
    v_mfma_f32_16x16x32_bf16 a[96:99], v[208:211], v[88:91], a[96:99]
    v_mfma_f32_16x16x32_bf16 a[0:3], v[212:215], v[92:95], a[0:3]
    v_mfma_f32_16x16x32_bf16 a[4:7], v[212:215], v[96:99], a[4:7]
    v_mfma_f32_16x16x32_bf16 a[8:11], v[212:215], v[100:103], a[8:11]
    v_mfma_f32_16x16x32_bf16 a[12:15], v[212:215], v[104:107], a[12:15]
    v_mfma_f32_16x16x32_bf16 a[16:19], v[212:215], v[108:111], a[16:19]
    v_mfma_f32_16x16x32_bf16 a[20:23], v[216:219], v[92:95], a[20:23]
    v_mfma_f32_16x16x32_bf16 a[24:27], v[216:219], v[96:99], a[24:27]
    v_mfma_f32_16x16x32_bf16 a[28:31], v[216:219], v[100:103], a[28:31]
    v_mfma_f32_16x16x32_bf16 a[32:35], v[216:219], v[104:107], a[32:35]
    v_mfma_f32_16x16x32_bf16 a[36:39], v[216:219], v[108:111], a[36:39]
    v_mfma_f32_16x16x32_bf16 a[40:43], v[220:223], v[92:95], a[40:43]
    v_mfma_f32_16x16x32_bf16 a[44:47], v[220:223], v[96:99], a[44:47]
    s_waitcnt lgkmcnt(0)
    v_mfma_f32_16x16x32_bf16 a[48:51], v[220:223], v[100:103], a[48:51]
    s_waitcnt vmcnt(15)
    v_mfma_f32_16x16x32_bf16 a[52:55], v[220:223], v[104:107], a[52:55]
    s_barrier
    v_mfma_f32_16x16x32_bf16 a[56:59], v[220:223], v[108:111], a[56:59]
    ds_read_b128 v[192:195], v21 offset:0
    v_mfma_f32_16x16x32_bf16 a[60:63], v[224:227], v[92:95], a[60:63]
    v_mfma_f32_16x16x32_bf16 a[64:67], v[224:227], v[96:99], a[64:67]
    ds_read_b128 v[196:199], v21 offset:1024
    v_mfma_f32_16x16x32_bf16 a[68:71], v[224:227], v[100:103], a[68:71]
    v_mfma_f32_16x16x32_bf16 a[72:75], v[224:227], v[104:107], a[72:75]
    ds_read_b128 v[200:203], v21 offset:2048
    v_mfma_f32_16x16x32_bf16 a[76:79], v[224:227], v[108:111], a[76:79]
    v_mfma_f32_16x16x32_bf16 a[80:83], v[228:231], v[92:95], a[80:83]
    ds_read_b128 v[204:207], v21 offset:3072
    v_mfma_f32_16x16x32_bf16 a[84:87], v[228:231], v[96:99], a[84:87]
    v_mfma_f32_16x16x32_bf16 a[88:91], v[228:231], v[100:103], a[88:91]
    ds_read_b128 v[208:211], v21 offset:4096
    v_mfma_f32_16x16x32_bf16 a[92:95], v[228:231], v[104:107], a[92:95]
    v_mfma_f32_16x16x32_bf16 a[96:99], v[228:231], v[108:111], a[96:99]
    s_waitcnt lgkmcnt(2)
    v_mfma_f32_16x16x32_bf16 a[0:3], v[192:195], v[112:115], a[0:3]
    ds_read_b128 v[212:215], v21 offset:10240
    v_mfma_f32_16x16x32_bf16 a[4:7], v[192:195], v[116:119], a[4:7]
    v_mfma_f32_16x16x32_bf16 a[8:11], v[192:195], v[120:123], a[8:11]
    ds_read_b128 v[216:219], v21 offset:11264
    v_mfma_f32_16x16x32_bf16 a[12:15], v[192:195], v[124:127], a[12:15]
    v_mfma_f32_16x16x32_bf16 a[16:19], v[192:195], v[128:131], a[16:19]
    ds_read_b128 v[220:223], v21 offset:12288
    v_mfma_f32_16x16x32_bf16 a[20:23], v[196:199], v[112:115], a[20:23]
    v_mfma_f32_16x16x32_bf16 a[24:27], v[196:199], v[116:119], a[24:27]
    ds_read_b128 v[224:227], v21 offset:13312
    v_mfma_f32_16x16x32_bf16 a[28:31], v[196:199], v[120:123], a[28:31]
    v_mfma_f32_16x16x32_bf16 a[32:35], v[196:199], v[124:127], a[32:35]
    ds_read_b128 v[228:231], v21 offset:14336
    v_mfma_f32_16x16x32_bf16 a[36:39], v[196:199], v[128:131], a[36:39]
    v_mfma_f32_16x16x32_bf16 a[40:43], v[200:203], v[112:115], a[40:43]
    v_mfma_f32_16x16x32_bf16 a[44:47], v[200:203], v[116:119], a[44:47]
    v_mfma_f32_16x16x32_bf16 a[48:51], v[200:203], v[120:123], a[48:51]
    v_mfma_f32_16x16x32_bf16 a[52:55], v[200:203], v[124:127], a[52:55]
    v_mfma_f32_16x16x32_bf16 a[56:59], v[200:203], v[128:131], a[56:59]
    s_waitcnt lgkmcnt(0)
    v_mfma_f32_16x16x32_bf16 a[60:63], v[204:207], v[112:115], a[60:63]
    v_mfma_f32_16x16x32_bf16 a[64:67], v[204:207], v[116:119], a[64:67]
    v_mfma_f32_16x16x32_bf16 a[68:71], v[204:207], v[120:123], a[68:71]
    v_mfma_f32_16x16x32_bf16 a[72:75], v[204:207], v[124:127], a[72:75]
    v_mfma_f32_16x16x32_bf16 a[76:79], v[204:207], v[128:131], a[76:79]
    v_mfma_f32_16x16x32_bf16 a[80:83], v[208:211], v[112:115], a[80:83]
    v_mfma_f32_16x16x32_bf16 a[84:87], v[208:211], v[116:119], a[84:87]
    v_mfma_f32_16x16x32_bf16 a[88:91], v[208:211], v[120:123], a[88:91]
    v_mfma_f32_16x16x32_bf16 a[92:95], v[208:211], v[124:127], a[92:95]
    v_mfma_f32_16x16x32_bf16 a[96:99], v[208:211], v[128:131], a[96:99]
    v_mfma_f32_16x16x32_bf16 a[0:3], v[212:215], v[132:135], a[0:3]
    v_mfma_f32_16x16x32_bf16 a[4:7], v[212:215], v[136:139], a[4:7]
    v_mfma_f32_16x16x32_bf16 a[8:11], v[212:215], v[140:143], a[8:11]
    v_mfma_f32_16x16x32_bf16 a[12:15], v[212:215], v[144:147], a[12:15]
    v_mfma_f32_16x16x32_bf16 a[16:19], v[212:215], v[148:151], a[16:19]
    v_mfma_f32_16x16x32_bf16 a[20:23], v[216:219], v[132:135], a[20:23]
    v_mfma_f32_16x16x32_bf16 a[24:27], v[216:219], v[136:139], a[24:27]
    v_mfma_f32_16x16x32_bf16 a[28:31], v[216:219], v[140:143], a[28:31]
    v_mfma_f32_16x16x32_bf16 a[32:35], v[216:219], v[144:147], a[32:35]
    v_mfma_f32_16x16x32_bf16 a[36:39], v[216:219], v[148:151], a[36:39]
    v_mfma_f32_16x16x32_bf16 a[40:43], v[220:223], v[132:135], a[40:43]
    v_mfma_f32_16x16x32_bf16 a[44:47], v[220:223], v[136:139], a[44:47]
    s_waitcnt lgkmcnt(0)
    v_mfma_f32_16x16x32_bf16 a[48:51], v[220:223], v[140:143], a[48:51]
    s_waitcnt vmcnt(0)
    v_mfma_f32_16x16x32_bf16 a[52:55], v[220:223], v[144:147], a[52:55]
    s_barrier
    v_mfma_f32_16x16x32_bf16 a[56:59], v[220:223], v[148:151], a[56:59]
    ds_read_b128 v[192:195], v21 offset:20480
    v_mfma_f32_16x16x32_bf16 a[60:63], v[224:227], v[132:135], a[60:63]
    v_mfma_f32_16x16x32_bf16 a[64:67], v[224:227], v[136:139], a[64:67]
    ds_read_b128 v[196:199], v21 offset:21504
    v_mfma_f32_16x16x32_bf16 a[68:71], v[224:227], v[140:143], a[68:71]
    v_mfma_f32_16x16x32_bf16 a[72:75], v[224:227], v[144:147], a[72:75]
    ds_read_b128 v[200:203], v21 offset:22528
    v_mfma_f32_16x16x32_bf16 a[76:79], v[224:227], v[148:151], a[76:79]
    v_mfma_f32_16x16x32_bf16 a[80:83], v[228:231], v[132:135], a[80:83]
    ds_read_b128 v[204:207], v21 offset:23552
    v_mfma_f32_16x16x32_bf16 a[84:87], v[228:231], v[136:139], a[84:87]
    v_mfma_f32_16x16x32_bf16 a[88:91], v[228:231], v[140:143], a[88:91]
    ds_read_b128 v[208:211], v21 offset:24576
    v_mfma_f32_16x16x32_bf16 a[92:95], v[228:231], v[144:147], a[92:95]
    v_mfma_f32_16x16x32_bf16 a[96:99], v[228:231], v[148:151], a[96:99]
    s_waitcnt lgkmcnt(2)
    v_mfma_f32_16x16x32_bf16 a[0:3], v[192:195], v[152:155], a[0:3]
    ds_read_b128 v[212:215], v21 offset:30720
    v_mfma_f32_16x16x32_bf16 a[4:7], v[192:195], v[156:159], a[4:7]
    v_mfma_f32_16x16x32_bf16 a[8:11], v[192:195], v[160:163], a[8:11]
    ds_read_b128 v[216:219], v21 offset:31744
    v_mfma_f32_16x16x32_bf16 a[12:15], v[192:195], v[164:167], a[12:15]
    v_mfma_f32_16x16x32_bf16 a[16:19], v[192:195], v[168:171], a[16:19]
    ds_read_b128 v[220:223], v21 offset:32768
    v_mfma_f32_16x16x32_bf16 a[20:23], v[196:199], v[152:155], a[20:23]
    v_mfma_f32_16x16x32_bf16 a[24:27], v[196:199], v[156:159], a[24:27]
    ds_read_b128 v[224:227], v21 offset:33792
    v_mfma_f32_16x16x32_bf16 a[28:31], v[196:199], v[160:163], a[28:31]
    v_mfma_f32_16x16x32_bf16 a[32:35], v[196:199], v[164:167], a[32:35]
    ds_read_b128 v[228:231], v21 offset:34816
    v_mfma_f32_16x16x32_bf16 a[36:39], v[196:199], v[168:171], a[36:39]
    v_mfma_f32_16x16x32_bf16 a[40:43], v[200:203], v[152:155], a[40:43]
    v_mfma_f32_16x16x32_bf16 a[44:47], v[200:203], v[156:159], a[44:47]
    v_mfma_f32_16x16x32_bf16 a[48:51], v[200:203], v[160:163], a[48:51]
    v_mfma_f32_16x16x32_bf16 a[52:55], v[200:203], v[164:167], a[52:55]
    v_mfma_f32_16x16x32_bf16 a[56:59], v[200:203], v[168:171], a[56:59]
    s_waitcnt lgkmcnt(0)
    v_mfma_f32_16x16x32_bf16 a[60:63], v[204:207], v[152:155], a[60:63]
    v_mfma_f32_16x16x32_bf16 a[64:67], v[204:207], v[156:159], a[64:67]
    v_mfma_f32_16x16x32_bf16 a[68:71], v[204:207], v[160:163], a[68:71]
    v_mfma_f32_16x16x32_bf16 a[72:75], v[204:207], v[164:167], a[72:75]
    v_mfma_f32_16x16x32_bf16 a[76:79], v[204:207], v[168:171], a[76:79]
    v_mfma_f32_16x16x32_bf16 a[80:83], v[208:211], v[152:155], a[80:83]
    v_mfma_f32_16x16x32_bf16 a[84:87], v[208:211], v[156:159], a[84:87]
    v_mfma_f32_16x16x32_bf16 a[88:91], v[208:211], v[160:163], a[88:91]
    v_mfma_f32_16x16x32_bf16 a[92:95], v[208:211], v[164:167], a[92:95]
    v_mfma_f32_16x16x32_bf16 a[96:99], v[208:211], v[168:171], a[96:99]
    v_mfma_f32_16x16x32_bf16 a[0:3], v[212:215], v[172:175], a[0:3]
    v_mfma_f32_16x16x32_bf16 a[4:7], v[212:215], v[176:179], a[4:7]
    v_mfma_f32_16x16x32_bf16 a[8:11], v[212:215], v[180:183], a[8:11]
    v_mfma_f32_16x16x32_bf16 a[12:15], v[212:215], v[184:187], a[12:15]
    v_mfma_f32_16x16x32_bf16 a[16:19], v[212:215], v[188:191], a[16:19]
    v_mfma_f32_16x16x32_bf16 a[20:23], v[216:219], v[172:175], a[20:23]
    v_mfma_f32_16x16x32_bf16 a[24:27], v[216:219], v[176:179], a[24:27]
    v_mfma_f32_16x16x32_bf16 a[28:31], v[216:219], v[180:183], a[28:31]
    v_mfma_f32_16x16x32_bf16 a[32:35], v[216:219], v[184:187], a[32:35]
    v_mfma_f32_16x16x32_bf16 a[36:39], v[216:219], v[188:191], a[36:39]
    v_mfma_f32_16x16x32_bf16 a[40:43], v[220:223], v[172:175], a[40:43]
    v_mfma_f32_16x16x32_bf16 a[44:47], v[220:223], v[176:179], a[44:47]
    v_mfma_f32_16x16x32_bf16 a[48:51], v[220:223], v[180:183], a[48:51]
    v_mfma_f32_16x16x32_bf16 a[52:55], v[220:223], v[184:187], a[52:55]
    v_mfma_f32_16x16x32_bf16 a[56:59], v[220:223], v[188:191], a[56:59]
    v_mfma_f32_16x16x32_bf16 a[60:63], v[224:227], v[172:175], a[60:63]
    v_mfma_f32_16x16x32_bf16 a[64:67], v[224:227], v[176:179], a[64:67]
    v_mfma_f32_16x16x32_bf16 a[68:71], v[224:227], v[180:183], a[68:71]
    v_mfma_f32_16x16x32_bf16 a[72:75], v[224:227], v[184:187], a[72:75]
    v_mfma_f32_16x16x32_bf16 a[76:79], v[224:227], v[188:191], a[76:79]
    v_mfma_f32_16x16x32_bf16 a[80:83], v[228:231], v[172:175], a[80:83]
    v_mfma_f32_16x16x32_bf16 a[84:87], v[228:231], v[176:179], a[84:87]
    v_mfma_f32_16x16x32_bf16 a[88:91], v[228:231], v[180:183], a[88:91]
    v_mfma_f32_16x16x32_bf16 a[92:95], v[228:231], v[184:187], a[92:95]
    v_mfma_f32_16x16x32_bf16 a[96:99], v[228:231], v[188:191], a[96:99]
    s_waitcnt vmcnt(0) lgkmcnt(0)
    s_nop 7
    s_barrier
    s_cmp_eq_u32 s21, 0
    s_cbranch_scc0 L2_fin1
    ds_write_b128 v20, a[52:55] offset:0
    ds_write_b128 v20, a[56:59] offset:1024
    ds_write_b128 v20, a[60:63] offset:2048
    ds_write_b128 v20, a[64:67] offset:3072
    ds_write_b128 v20, a[68:71] offset:4096
    ds_write_b128 v20, a[72:75] offset:5120
    ds_write_b128 v20, a[76:79] offset:6144
    ds_write_b128 v20, a[80:83] offset:7168
    ds_write_b128 v20, a[84:87] offset:8192
    ds_write_b128 v20, a[88:91] offset:9216
    ds_write_b128 v20, a[92:95] offset:10240
    ds_write_b128 v20, a[96:99] offset:11264
    s_waitcnt lgkmcnt(0)
    s_barrier
    ds_read_b128 v[32:35], v20 offset:13312
    ds_read_b128 v[36:39], v20 offset:14336
    ds_read_b128 v[40:43], v20 offset:15360
    ds_read_b128 v[44:47], v20 offset:16384
    ds_read_b128 v[48:51], v20 offset:17408
    ds_read_b128 v[52:55], v20 offset:18432
    ds_read_b128 v[56:59], v20 offset:19456
    ds_read_b128 v[60:63], v20 offset:20480
    ds_read_b128 v[64:67], v20 offset:21504
    ds_read_b128 v[68:71], v20 offset:22528
    ds_read_b128 v[72:75], v20 offset:23552
    ds_read_b128 v[76:79], v20 offset:24576
    ds_read_b128 v[80:83], v20 offset:25600
    v_accvgpr_read_b32 v192, a0
    v_accvgpr_read_b32 v193, a1
    v_accvgpr_read_b32 v194, a2
    v_accvgpr_read_b32 v195, a3
    s_waitcnt lgkmcnt(12)
    v_pk_add_f32 v[32:33], v[32:33], v[192:193]
    v_pk_add_f32 v[34:35], v[34:35], v[194:195]
    s_add_u32 s27, s29, 0
    v_cvt_pk_bf16_f32 v32, v32, v33
    v_cvt_pk_bf16_f32 v33, v34, v35
    buffer_store_dwordx2 v[32:33], v19, s[16:19], s27 offen offset:0
    v_accvgpr_read_b32 v196, a4
    v_accvgpr_read_b32 v197, a5
    v_accvgpr_read_b32 v198, a6
    v_accvgpr_read_b32 v199, a7
    s_waitcnt lgkmcnt(11)
    v_pk_add_f32 v[36:37], v[36:37], v[196:197]
    v_pk_add_f32 v[38:39], v[38:39], v[198:199]
    s_add_u32 s27, s29, 40960
    v_cvt_pk_bf16_f32 v36, v36, v37
    v_cvt_pk_bf16_f32 v37, v38, v39
    buffer_store_dwordx2 v[36:37], v19, s[16:19], s27 offen offset:0
    v_accvgpr_read_b32 v200, a8
    v_accvgpr_read_b32 v201, a9
    v_accvgpr_read_b32 v202, a10
    v_accvgpr_read_b32 v203, a11
    s_waitcnt lgkmcnt(10)
    v_pk_add_f32 v[40:41], v[40:41], v[200:201]
    v_pk_add_f32 v[42:43], v[42:43], v[202:203]
    s_add_u32 s27, s29, 81920
    v_cvt_pk_bf16_f32 v40, v40, v41
    v_cvt_pk_bf16_f32 v41, v42, v43
    buffer_store_dwordx2 v[40:41], v19, s[16:19], s27 offen offset:0
    v_accvgpr_read_b32 v204, a12
    v_accvgpr_read_b32 v205, a13
    v_accvgpr_read_b32 v206, a14
    v_accvgpr_read_b32 v207, a15
    s_waitcnt lgkmcnt(9)
    v_pk_add_f32 v[44:45], v[44:45], v[204:205]
    v_pk_add_f32 v[46:47], v[46:47], v[206:207]
    s_add_u32 s27, s29, 122880
    v_cvt_pk_bf16_f32 v44, v44, v45
    v_cvt_pk_bf16_f32 v45, v46, v47
    buffer_store_dwordx2 v[44:45], v19, s[16:19], s27 offen offset:0
    v_accvgpr_read_b32 v192, a16
    v_accvgpr_read_b32 v193, a17
    v_accvgpr_read_b32 v194, a18
    v_accvgpr_read_b32 v195, a19
    s_waitcnt lgkmcnt(8)
    v_pk_add_f32 v[48:49], v[48:49], v[192:193]
    v_pk_add_f32 v[50:51], v[50:51], v[194:195]
    s_add_u32 s27, s29, 163840
    v_cvt_pk_bf16_f32 v48, v48, v49
    v_cvt_pk_bf16_f32 v49, v50, v51
    buffer_store_dwordx2 v[48:49], v19, s[16:19], s27 offen offset:0
    v_accvgpr_read_b32 v196, a20
    v_accvgpr_read_b32 v197, a21
    v_accvgpr_read_b32 v198, a22
    v_accvgpr_read_b32 v199, a23
    s_waitcnt lgkmcnt(7)
    v_pk_add_f32 v[52:53], v[52:53], v[196:197]
    v_pk_add_f32 v[54:55], v[54:55], v[198:199]
    s_add_u32 s27, s29, 0
    v_cvt_pk_bf16_f32 v52, v52, v53
    v_cvt_pk_bf16_f32 v53, v54, v55
    buffer_store_dwordx2 v[52:53], v19, s[16:19], s27 offen offset:32
    v_accvgpr_read_b32 v200, a24
    v_accvgpr_read_b32 v201, a25
    v_accvgpr_read_b32 v202, a26
    v_accvgpr_read_b32 v203, a27
    s_waitcnt lgkmcnt(6)
    v_pk_add_f32 v[56:57], v[56:57], v[200:201]
    v_pk_add_f32 v[58:59], v[58:59], v[202:203]
    s_add_u32 s27, s29, 40960
    v_cvt_pk_bf16_f32 v56, v56, v57
    v_cvt_pk_bf16_f32 v57, v58, v59
    buffer_store_dwordx2 v[56:57], v19, s[16:19], s27 offen offset:32
    v_accvgpr_read_b32 v204, a28
    v_accvgpr_read_b32 v205, a29
    v_accvgpr_read_b32 v206, a30
    v_accvgpr_read_b32 v207, a31
    s_waitcnt lgkmcnt(5)
    v_pk_add_f32 v[60:61], v[60:61], v[204:205]
    v_pk_add_f32 v[62:63], v[62:63], v[206:207]
    s_add_u32 s27, s29, 81920
    v_cvt_pk_bf16_f32 v60, v60, v61
    v_cvt_pk_bf16_f32 v61, v62, v63
    buffer_store_dwordx2 v[60:61], v19, s[16:19], s27 offen offset:32
    v_accvgpr_read_b32 v192, a32
    v_accvgpr_read_b32 v193, a33
    v_accvgpr_read_b32 v194, a34
    v_accvgpr_read_b32 v195, a35
    s_waitcnt lgkmcnt(4)
    v_pk_add_f32 v[64:65], v[64:65], v[192:193]
    v_pk_add_f32 v[66:67], v[66:67], v[194:195]
    s_add_u32 s27, s29, 122880
    v_cvt_pk_bf16_f32 v64, v64, v65
    v_cvt_pk_bf16_f32 v65, v66, v67
    buffer_store_dwordx2 v[64:65], v19, s[16:19], s27 offen offset:32
    v_accvgpr_read_b32 v196, a36
    v_accvgpr_read_b32 v197, a37
    v_accvgpr_read_b32 v198, a38
    v_accvgpr_read_b32 v199, a39
    s_waitcnt lgkmcnt(3)
    v_pk_add_f32 v[68:69], v[68:69], v[196:197]
    v_pk_add_f32 v[70:71], v[70:71], v[198:199]
    s_add_u32 s27, s29, 163840
    v_cvt_pk_bf16_f32 v68, v68, v69
    v_cvt_pk_bf16_f32 v69, v70, v71
    buffer_store_dwordx2 v[68:69], v19, s[16:19], s27 offen offset:32
    v_accvgpr_read_b32 v200, a40
    v_accvgpr_read_b32 v201, a41
    v_accvgpr_read_b32 v202, a42
    v_accvgpr_read_b32 v203, a43
    s_waitcnt lgkmcnt(2)
    v_pk_add_f32 v[72:73], v[72:73], v[200:201]
    v_pk_add_f32 v[74:75], v[74:75], v[202:203]
    s_add_u32 s27, s29, 0
    v_cvt_pk_bf16_f32 v72, v72, v73
    v_cvt_pk_bf16_f32 v73, v74, v75
    buffer_store_dwordx2 v[72:73], v19, s[16:19], s27 offen offset:64
    v_accvgpr_read_b32 v204, a44
    v_accvgpr_read_b32 v205, a45
    v_accvgpr_read_b32 v206, a46
    v_accvgpr_read_b32 v207, a47
    s_waitcnt lgkmcnt(1)
    v_pk_add_f32 v[76:77], v[76:77], v[204:205]
    v_pk_add_f32 v[78:79], v[78:79], v[206:207]
    s_add_u32 s27, s29, 40960
    v_cvt_pk_bf16_f32 v76, v76, v77
    v_cvt_pk_bf16_f32 v77, v78, v79
    buffer_store_dwordx2 v[76:77], v19, s[16:19], s27 offen offset:64
    v_accvgpr_read_b32 v192, a48
    v_accvgpr_read_b32 v193, a49
    v_accvgpr_read_b32 v194, a50
    v_accvgpr_read_b32 v195, a51
    s_waitcnt lgkmcnt(0)
    v_pk_add_f32 v[80:81], v[80:81], v[192:193]
    v_pk_add_f32 v[82:83], v[82:83], v[194:195]
    s_add_u32 s27, s29, 81920
    v_cvt_pk_bf16_f32 v80, v80, v81
    v_cvt_pk_bf16_f32 v81, v82, v83
    buffer_store_dwordx2 v[80:81], v19, s[16:19], s27 offen offset:64
    s_branch L2_fin
L2_fin1:
    ds_write_b128 v20, a[0:3] offset:13312
    ds_write_b128 v20, a[4:7] offset:14336
    ds_write_b128 v20, a[8:11] offset:15360
    ds_write_b128 v20, a[12:15] offset:16384
    ds_write_b128 v20, a[16:19] offset:17408
    ds_write_b128 v20, a[20:23] offset:18432
    ds_write_b128 v20, a[24:27] offset:19456
    ds_write_b128 v20, a[28:31] offset:20480
    ds_write_b128 v20, a[32:35] offset:21504
    ds_write_b128 v20, a[36:39] offset:22528
    ds_write_b128 v20, a[40:43] offset:23552
    ds_write_b128 v20, a[44:47] offset:24576
    ds_write_b128 v20, a[48:51] offset:25600
    s_waitcnt lgkmcnt(0)
    s_barrier
    ds_read_b128 v[32:35], v20 offset:0
    ds_read_b128 v[36:39], v20 offset:1024
    ds_read_b128 v[40:43], v20 offset:2048
    ds_read_b128 v[44:47], v20 offset:3072
    ds_read_b128 v[48:51], v20 offset:4096
    ds_read_b128 v[52:55], v20 offset:5120
    ds_read_b128 v[56:59], v20 offset:6144
    ds_read_b128 v[60:63], v20 offset:7168
    ds_read_b128 v[64:67], v20 offset:8192
    ds_read_b128 v[68:71], v20 offset:9216
    ds_read_b128 v[72:75], v20 offset:10240
    ds_read_b128 v[76:79], v20 offset:11264
    v_accvgpr_read_b32 v192, a52
    v_accvgpr_read_b32 v193, a53
    v_accvgpr_read_b32 v194, a54
    v_accvgpr_read_b32 v195, a55
    s_waitcnt lgkmcnt(11)
    v_pk_add_f32 v[32:33], v[32:33], v[192:193]
    v_pk_add_f32 v[34:35], v[34:35], v[194:195]
    s_add_u32 s27, s29, 122880
    v_cvt_pk_bf16_f32 v32, v32, v33
    v_cvt_pk_bf16_f32 v33, v34, v35
    buffer_store_dwordx2 v[32:33], v19, s[16:19], s27 offen offset:64
    v_accvgpr_read_b32 v196, a56
    v_accvgpr_read_b32 v197, a57
    v_accvgpr_read_b32 v198, a58
    v_accvgpr_read_b32 v199, a59
    s_waitcnt lgkmcnt(10)
    v_pk_add_f32 v[36:37], v[36:37], v[196:197]
    v_pk_add_f32 v[38:39], v[38:39], v[198:199]
    s_add_u32 s27, s29, 163840
    v_cvt_pk_bf16_f32 v36, v36, v37
    v_cvt_pk_bf16_f32 v37, v38, v39
    buffer_store_dwordx2 v[36:37], v19, s[16:19], s27 offen offset:64
    v_accvgpr_read_b32 v200, a60
    v_accvgpr_read_b32 v201, a61
    v_accvgpr_read_b32 v202, a62
    v_accvgpr_read_b32 v203, a63
    s_waitcnt lgkmcnt(9)
    v_pk_add_f32 v[40:41], v[40:41], v[200:201]
    v_pk_add_f32 v[42:43], v[42:43], v[202:203]
    s_add_u32 s27, s29, 0
    v_cvt_pk_bf16_f32 v40, v40, v41
    v_cvt_pk_bf16_f32 v41, v42, v43
    buffer_store_dwordx2 v[40:41], v19, s[16:19], s27 offen offset:96
    v_accvgpr_read_b32 v204, a64
    v_accvgpr_read_b32 v205, a65
    v_accvgpr_read_b32 v206, a66
    v_accvgpr_read_b32 v207, a67
    s_waitcnt lgkmcnt(8)
    v_pk_add_f32 v[44:45], v[44:45], v[204:205]
    v_pk_add_f32 v[46:47], v[46:47], v[206:207]
    s_add_u32 s27, s29, 40960
    v_cvt_pk_bf16_f32 v44, v44, v45
    v_cvt_pk_bf16_f32 v45, v46, v47
    buffer_store_dwordx2 v[44:45], v19, s[16:19], s27 offen offset:96
    v_accvgpr_read_b32 v192, a68
    v_accvgpr_read_b32 v193, a69
    v_accvgpr_read_b32 v194, a70
    v_accvgpr_read_b32 v195, a71
    s_waitcnt lgkmcnt(7)
    v_pk_add_f32 v[48:49], v[48:49], v[192:193]
    v_pk_add_f32 v[50:51], v[50:51], v[194:195]
    s_add_u32 s27, s29, 81920
    v_cvt_pk_bf16_f32 v48, v48, v49
    v_cvt_pk_bf16_f32 v49, v50, v51
    buffer_store_dwordx2 v[48:49], v19, s[16:19], s27 offen offset:96
    v_accvgpr_read_b32 v196, a72
    v_accvgpr_read_b32 v197, a73
    v_accvgpr_read_b32 v198, a74
    v_accvgpr_read_b32 v199, a75
    s_waitcnt lgkmcnt(6)
    v_pk_add_f32 v[52:53], v[52:53], v[196:197]
    v_pk_add_f32 v[54:55], v[54:55], v[198:199]
    s_add_u32 s27, s29, 122880
    v_cvt_pk_bf16_f32 v52, v52, v53
    v_cvt_pk_bf16_f32 v53, v54, v55
    buffer_store_dwordx2 v[52:53], v19, s[16:19], s27 offen offset:96
    v_accvgpr_read_b32 v200, a76
    v_accvgpr_read_b32 v201, a77
    v_accvgpr_read_b32 v202, a78
    v_accvgpr_read_b32 v203, a79
    s_waitcnt lgkmcnt(5)
    v_pk_add_f32 v[56:57], v[56:57], v[200:201]
    v_pk_add_f32 v[58:59], v[58:59], v[202:203]
    s_add_u32 s27, s29, 163840
    v_cvt_pk_bf16_f32 v56, v56, v57
    v_cvt_pk_bf16_f32 v57, v58, v59
    buffer_store_dwordx2 v[56:57], v19, s[16:19], s27 offen offset:96
    v_accvgpr_read_b32 v204, a80
    v_accvgpr_read_b32 v205, a81
    v_accvgpr_read_b32 v206, a82
    v_accvgpr_read_b32 v207, a83
    s_waitcnt lgkmcnt(4)
    v_pk_add_f32 v[60:61], v[60:61], v[204:205]
    v_pk_add_f32 v[62:63], v[62:63], v[206:207]
    s_add_u32 s27, s29, 0
    v_cvt_pk_bf16_f32 v60, v60, v61
    v_cvt_pk_bf16_f32 v61, v62, v63
    buffer_store_dwordx2 v[60:61], v19, s[16:19], s27 offen offset:128
    v_accvgpr_read_b32 v192, a84
    v_accvgpr_read_b32 v193, a85
    v_accvgpr_read_b32 v194, a86
    v_accvgpr_read_b32 v195, a87
    s_waitcnt lgkmcnt(3)
    v_pk_add_f32 v[64:65], v[64:65], v[192:193]
    v_pk_add_f32 v[66:67], v[66:67], v[194:195]
    s_add_u32 s27, s29, 40960
    v_cvt_pk_bf16_f32 v64, v64, v65
    v_cvt_pk_bf16_f32 v65, v66, v67
    buffer_store_dwordx2 v[64:65], v19, s[16:19], s27 offen offset:128
    v_accvgpr_read_b32 v196, a88
    v_accvgpr_read_b32 v197, a89
    v_accvgpr_read_b32 v198, a90
    v_accvgpr_read_b32 v199, a91
    s_waitcnt lgkmcnt(2)
    v_pk_add_f32 v[68:69], v[68:69], v[196:197]
    v_pk_add_f32 v[70:71], v[70:71], v[198:199]
    s_add_u32 s27, s29, 81920
    v_cvt_pk_bf16_f32 v68, v68, v69
    v_cvt_pk_bf16_f32 v69, v70, v71
    buffer_store_dwordx2 v[68:69], v19, s[16:19], s27 offen offset:128
    v_accvgpr_read_b32 v200, a92
    v_accvgpr_read_b32 v201, a93
    v_accvgpr_read_b32 v202, a94
    v_accvgpr_read_b32 v203, a95
    s_waitcnt lgkmcnt(1)
    v_pk_add_f32 v[72:73], v[72:73], v[200:201]
    v_pk_add_f32 v[74:75], v[74:75], v[202:203]
    s_add_u32 s27, s29, 122880
    v_cvt_pk_bf16_f32 v72, v72, v73
    v_cvt_pk_bf16_f32 v73, v74, v75
    buffer_store_dwordx2 v[72:73], v19, s[16:19], s27 offen offset:128
    v_accvgpr_read_b32 v204, a96
    v_accvgpr_read_b32 v205, a97
    v_accvgpr_read_b32 v206, a98
    v_accvgpr_read_b32 v207, a99
    s_waitcnt lgkmcnt(0)
    v_pk_add_f32 v[76:77], v[76:77], v[204:205]
    v_pk_add_f32 v[78:79], v[78:79], v[206:207]
    s_add_u32 s27, s29, 163840
    v_cvt_pk_bf16_f32 v76, v76, v77
    v_cvt_pk_bf16_f32 v77, v78, v79
    buffer_store_dwordx2 v[76:77], v19, s[16:19], s27 offen offset:128
L2_fin:
L2_done:
    s_endpgm
.section .rodata,"a"
.p2align 6
.amdhsa_kernel mha_attn_kernel
  .amdhsa_next_free_vgpr 512
  .amdhsa_next_free_sgpr 102
  .amdhsa_accum_offset 256
  .amdhsa_group_segment_fixed_size 0
  .amdhsa_kernarg_size 104
  .amdhsa_user_sgpr_count 2
  .amdhsa_user_sgpr_kernarg_segment_ptr 1
  .amdhsa_system_sgpr_workgroup_id_x 1
  .amdhsa_float_denorm_mode_32 3
.end_amdhsa_kernel
.p2align 6
.amdhsa_kernel mha_oproj_kernel
  .amdhsa_next_free_vgpr 336
  .amdhsa_next_free_sgpr 102
  .amdhsa_accum_offset 232
  .amdhsa_group_segment_fixed_size 0
  .amdhsa_kernarg_size 104
  .amdhsa_user_sgpr_count 2
  .amdhsa_user_sgpr_kernarg_segment_ptr 1
  .amdhsa_system_sgpr_workgroup_id_x 1
  .amdhsa_float_denorm_mode_32 3
.end_amdhsa_kernel
```
